```python
import torch

def _softmax(x, axis=-1):
    return torch.softmax(x, dim=axis)
def _gelu(x):
    return torch.nn.functional.gelu(x, approximate="tanh")
def _silu(x):
    return torch.nn.functional.silu(x)
def _sigmoid(x):
    return torch.sigmoid(x)
def _layernorm(x, axis=-1, eps=1e-5):
    m = x.mean(dim=axis, keepdim=True)
    v = x.var(dim=axis, keepdim=True, unbiased=False)
    return (x - m) / torch.sqrt(v + eps)
def _scatter_add(tgt, idx, src, axis=0):
    return tgt.clone().index_add_(axis, idx, src)
def _segment_sum(src, seg, n):
    out = torch.zeros((n,) + src.shape[1:], dtype=src.dtype)
    return out.index_add_(0, seg, src)
def _pad(x, pw):
    flat = tuple(v for pair in reversed(pw) for v in pair)
    return torch.nn.functional.pad(x, flat)

kernel_name = 'gated_mix__sliding_block_cached__geglu_ffn__decode'

def setup_inputs():

    _w = (lambda a: (lambda t: t.to(torch.bfloat16) if t.is_floating_point() else t)(torch.as_tensor(a)))
    def _A_setup():
        B, Sq, D = 8, 1, 640
        Hq, Hkv, Sk, Dh = 32, 32, 4096, 192
        assert Hq % Hkv == 0, (Hq, Hkv)
        return {
            "x": _w((lambda *s: torch.randn(*s, dtype=torch.bfloat16) * 0.05)(B, Sq, D)),
            "k_cache": _w((lambda *s: torch.randn(*s, dtype=torch.bfloat16) * 6.4)(B, Hkv, Sk, Dh)),
            "v_cache": _w((lambda *s: torch.randn(*s, dtype=torch.bfloat16) * 0.2)(B, Hkv, Sk, Dh)),
            "wq": _w((lambda *s: torch.randn(*s, dtype=torch.bfloat16) * 6.4)(D, Hq * Dh) * (D ** -0.5)),
            "wo": _w((lambda *s: torch.randn(*s, dtype=torch.bfloat16) * 0.2)(Hq * Dh, D) * ((Hq * Dh) ** -0.5)),
        }
    _A_in = _A_setup()

    def _B_setup():
        B, S, D, F = 8, 1, 640, 1536
        return {
            "x": _w((lambda *s: torch.randn(*s, dtype=torch.bfloat16) * 0.05)(B, S, D)),
            "w_gate": _w((lambda *s: torch.randn(*s, dtype=torch.bfloat16) * 0.05)(D, F)),
            "w_up": _w((lambda *s: torch.randn(*s, dtype=torch.bfloat16) * 0.05)(D, F)),
            "w_down": _w((lambda *s: torch.randn(*s, dtype=torch.bfloat16) * 0.05)(F, D)),
        }
    _B_in = _B_setup()

    return {
        "A_x": _A_in["x"],
        "A_k_cache": _A_in["k_cache"],
        "A_v_cache": _A_in["v_cache"],
        "A_wq": _A_in["wq"],
        "A_wo": _A_in["wo"],
        "B_x": _B_in["x"],
        "B_w_gate": _B_in["w_gate"],
        "B_w_up": _B_in["w_up"],
        "B_w_down": _B_in["w_down"],
        "gate_w": _w((lambda *s: torch.randn(*s, dtype=torch.bfloat16) * 0.05)(640) * 16.0),
    }

def reference(A_x, A_k_cache, A_v_cache, A_wq, A_wo, B_x, B_w_gate, B_w_up, B_w_down, gate_w):
    def _A_ref(x, k_cache, v_cache, wq, wo):
        B, Sq, D = x.shape
        Hq, Dh = 32, 192
        Hkv, Sk = k_cache.shape[1], k_cache.shape[2]
        W = min(4096, max(256, Sk // 4))
        rep = Hq // Hkv
        q = (lambda x, *d: x.permute(*d))((x @ wq).reshape(B, Sq, Hq, Dh), 0, 2, 1, 3)
        k = (lambda x, n, axis: torch.repeat_interleave(x, n, dim=axis))(k_cache[:, :, Sk - W:, :], rep, axis=1)
        v = (lambda x, n, axis: torch.repeat_interleave(x, n, dim=axis))(v_cache[:, :, Sk - W:, :], rep, axis=1)
        scores = torch.einsum("bhqd,bhkd->bhqk", q, k) * (Dh ** -0.5)
        p = _softmax(scores, axis=-1)
        o = torch.einsum("bhqk,bhkd->bhqd", p, v)
        return (lambda x, *d: x.permute(*d))(o, 0, 2, 1, 3).reshape(B, Sq, Hq * Dh) @ wo

    def _B_ref(x, w_gate, w_up, w_down):
        return (_gelu(x @ w_gate) * (x @ w_up)) @ w_down

    x = A_x
    g = _sigmoid((x * gate_w).sum(-1, keepdims=True))
    a = _A_ref(x, A_k_cache, A_v_cache, A_wq, A_wo)
    b = _B_ref(x, B_w_gate, B_w_up, B_w_down)
    return g * a + (1 - g) * b
```

```asm
; @launch kernel=gated_mix__sliding_block_cached__geglu_ffn__decode_kernel grid=(448,1,1) block=(256,1,1) lds=8192
; @launch kernel=gm_final_kernel grid=(40,1,1) block=(256,1,1) lds=8192
.amdgcn_target "amdgcn-amd-amdhsa--gfx950"
.text
.globl gated_mix__sliding_block_cached__geglu_ffn__decode_kernel
.p2align 8
.type gated_mix__sliding_block_cached__geglu_ffn__decode_kernel,@function
gated_mix__sliding_block_cached__geglu_ffn__decode_kernel:
  s_load_dwordx16 s[4:19], s[0:1], 0
  s_load_dwordx8 s[20:27], s[0:1], 64
  s_load_dwordx2 s[28:29], s[0:1], 96
  s_cmp_ge_u32 s2, 448
  s_cbranch_scc1 L_end
  v_and_b32 v80, 63, v0
  v_lshrrev_b32 v3, 6, v0
  v_lshrrev_b32 v1, 3, v80
  v_and_b32 v2, 7, v80
  s_mov_b32 s49, 0x3d93cd3a
  s_mov_b32 s50, 0x3fb8aa3b
  v_mul_u32_u24 v81, 160, v3
  v_add_u32 v81, v81, v1
  v_lshlrev_b32 v7, 1, v81
  v_lshlrev_b32 v82, 4, v2
  v_lshlrev_b32 v9, 5, v2
  v_lshlrev_b32 v10, 2, v1
  v_mul_u32_u24 v6, 1280, v1
  v_add_u32 v6, v6, v82
  v_lshlrev_b32 v83, 7, v3
  v_add_u32 v6, v6, v83
  v_mov_b32 v16, 0
  v_mov_b32 v17, 0
  v_mov_b32 v18, 0
  v_mov_b32 v19, 0
  v_mov_b32 v20, 0
  v_mov_b32 v21, 0
  v_mov_b32 v22, 0
  v_mov_b32 v23, 0
  v_mov_b32 v24, 0
  v_mov_b32 v25, 0
  v_mov_b32 v26, 0
  v_mov_b32 v27, 0
  v_mov_b32 v28, 0
  v_mov_b32 v29, 0
  v_mov_b32 v30, 0
  v_mov_b32 v31, 0
  v_mov_b32 v32, 0
  v_mov_b32 v33, 0
  v_mov_b32 v34, 0
  v_mov_b32 v35, 0
  v_mov_b32 v36, 0
  v_mov_b32 v37, 0
  v_mov_b32 v38, 0
  v_mov_b32 v39, 0
  s_waitcnt lgkmcnt(0)
  s_cmp_ge_u32 s2, 256
  s_cbranch_scc1 L_ffn
  s_setprio 3
  s_lshr_b32 s30, s2, 5
  s_and_b32 s31, s2, 31
  s_mul_i32 s32, s30, 1280
  s_add_u32 s44, s4, s32
  s_addc_u32 s45, s5, 0
  s_mul_i32 s32, s31, 384
  s_add_u32 s34, s10, s32
  s_addc_u32 s35, s11, 0
  s_mul_i32 s32, s2, 1572864
  s_add_u32 s32, s32, 1179648
  s_add_u32 s38, s6, s32
  s_addc_u32 s39, s7, 0
  s_add_u32 s40, s8, s32
  s_addc_u32 s41, s9, 0
  s_mul_i32 s32, s31, 245760
  s_add_u32 s42, s12, s32
  s_addc_u32 s43, s13, 0
  v_mul_u32_u24 v4, 12288, v81
  v_add_u32 v4, v4, v82
  v_mul_u32_u24 v5, 98304, v3
  v_mul_u32_u24 v83, 384, v1
  v_add_u32 v5, v5, v83
  v_add_u32 v5, v5, v82
  v_mul_u32_u24 v8, 768, v3
  v_add_u32 v8, v8, v9
  global_load_ushort v56, v7, s[44:45] offset:0
  global_load_ushort v57, v7, s[44:45] offset:16
  global_load_ushort v58, v7, s[44:45] offset:32
  global_load_ushort v59, v7, s[44:45] offset:48
  global_load_ushort v60, v7, s[44:45] offset:64
  global_load_ushort v61, v7, s[44:45] offset:80
  global_load_ushort v62, v7, s[44:45] offset:96
  global_load_ushort v63, v7, s[44:45] offset:112
  global_load_ushort v64, v7, s[44:45] offset:128
  global_load_ushort v65, v7, s[44:45] offset:144
  global_load_ushort v66, v7, s[44:45] offset:160
  global_load_ushort v67, v7, s[44:45] offset:176
  global_load_ushort v68, v7, s[44:45] offset:192
  global_load_ushort v69, v7, s[44:45] offset:208
  global_load_ushort v70, v7, s[44:45] offset:224
  global_load_ushort v71, v7, s[44:45] offset:240
  global_load_ushort v72, v7, s[44:45] offset:256
  global_load_ushort v73, v7, s[44:45] offset:272
  global_load_ushort v74, v7, s[44:45] offset:288
  global_load_ushort v75, v7, s[44:45] offset:304
  global_load_dwordx4 v[96:99], v4, s[34:35] offset:0
  global_load_dwordx4 v[100:103], v4, s[34:35] offset:128
  global_load_dwordx4 v[104:107], v4, s[34:35] offset:256
  s_add_u32 s34, s34, 98304
  s_addc_u32 s35, s35, 0
  global_load_dwordx4 v[108:111], v4, s[34:35] offset:0
  global_load_dwordx4 v[112:115], v4, s[34:35] offset:128
  global_load_dwordx4 v[116:119], v4, s[34:35] offset:256
  s_add_u32 s34, s34, 98304
  s_addc_u32 s35, s35, 0
  global_load_dwordx4 v[120:123], v4, s[34:35] offset:0
  global_load_dwordx4 v[124:127], v4, s[34:35] offset:128
  global_load_dwordx4 v[128:131], v4, s[34:35] offset:256
  s_add_u32 s34, s34, 98304
  s_addc_u32 s35, s35, 0
  global_load_dwordx4 v[132:135], v4, s[34:35] offset:0
  global_load_dwordx4 v[136:139], v4, s[34:35] offset:128
  global_load_dwordx4 v[140:143], v4, s[34:35] offset:256
  s_add_u32 s34, s34, 98304
  s_addc_u32 s35, s35, 0
  global_load_dwordx4 v[144:147], v4, s[34:35] offset:0
  global_load_dwordx4 v[148:151], v4, s[34:35] offset:128
  global_load_dwordx4 v[152:155], v4, s[34:35] offset:256
  s_add_u32 s34, s34, 98304
  s_addc_u32 s35, s35, 0
  global_load_dwordx4 v[156:159], v4, s[34:35] offset:0
  global_load_dwordx4 v[160:163], v4, s[34:35] offset:128
  global_load_dwordx4 v[164:167], v4, s[34:35] offset:256
  s_add_u32 s34, s34, 98304
  s_addc_u32 s35, s35, 0
  global_load_dwordx4 v[168:171], v4, s[34:35] offset:0
  global_load_dwordx4 v[172:175], v4, s[34:35] offset:128
  global_load_dwordx4 v[176:179], v4, s[34:35] offset:256
  s_add_u32 s34, s34, 98304
  s_addc_u32 s35, s35, 0
  global_load_dwordx4 v[180:183], v4, s[34:35] offset:0
  global_load_dwordx4 v[184:187], v4, s[34:35] offset:128
  global_load_dwordx4 v[188:191], v4, s[34:35] offset:256
  s_add_u32 s34, s34, 98304
  s_addc_u32 s35, s35, 0
  global_load_dwordx4 v[192:195], v5, s[38:39] offset:0 nt
  global_load_dwordx4 v[196:199], v5, s[38:39] offset:128 nt
  global_load_dwordx4 v[200:203], v5, s[38:39] offset:256 nt
  global_load_dwordx4 v[204:207], v5, s[38:39] offset:3072 nt
  global_load_dwordx4 v[208:211], v5, s[38:39] offset:3200 nt
  global_load_dwordx4 v[212:215], v5, s[38:39] offset:3328 nt
  s_add_u32 s38, s38, 6144
  s_addc_u32 s39, s39, 0
  global_load_dwordx4 v[216:219], v5, s[38:39] offset:0 nt
  global_load_dwordx4 v[220:223], v5, s[38:39] offset:128 nt
  global_load_dwordx4 v[224:227], v5, s[38:39] offset:256 nt
  global_load_dwordx4 v[228:231], v5, s[38:39] offset:3072 nt
  global_load_dwordx4 v[232:235], v5, s[38:39] offset:3200 nt
  global_load_dwordx4 v[236:239], v5, s[38:39] offset:3328 nt
  s_add_u32 s38, s38, 6144
  s_addc_u32 s39, s39, 0
  s_waitcnt vmcnt(30)
  v_lshlrev_b32 v80, 16, v56
  v_dot2c_f32_bf16 v16, v96, v56
  v_dot2c_f32_bf16 v17, v96, v80
  v_dot2c_f32_bf16 v18, v97, v56
  v_dot2c_f32_bf16 v19, v97, v80
  v_dot2c_f32_bf16 v20, v98, v56
  v_dot2c_f32_bf16 v21, v98, v80
  v_dot2c_f32_bf16 v22, v99, v56
  v_dot2c_f32_bf16 v23, v99, v80
  v_dot2c_f32_bf16 v24, v100, v56
  v_dot2c_f32_bf16 v25, v100, v80
  v_dot2c_f32_bf16 v26, v101, v56
  v_dot2c_f32_bf16 v27, v101, v80
  v_dot2c_f32_bf16 v28, v102, v56
  v_dot2c_f32_bf16 v29, v102, v80
  v_dot2c_f32_bf16 v30, v103, v56
  v_dot2c_f32_bf16 v31, v103, v80
  v_dot2c_f32_bf16 v32, v104, v56
  v_dot2c_f32_bf16 v33, v104, v80
  v_dot2c_f32_bf16 v34, v105, v56
  v_dot2c_f32_bf16 v35, v105, v80
  v_dot2c_f32_bf16 v36, v106, v56
  v_dot2c_f32_bf16 v37, v106, v80
  v_dot2c_f32_bf16 v38, v107, v56
  v_dot2c_f32_bf16 v39, v107, v80
  v_lshlrev_b32 v80, 16, v57
  v_dot2c_f32_bf16 v16, v108, v57
  v_dot2c_f32_bf16 v17, v108, v80
  v_dot2c_f32_bf16 v18, v109, v57
  v_dot2c_f32_bf16 v19, v109, v80
  v_dot2c_f32_bf16 v20, v110, v57
  v_dot2c_f32_bf16 v21, v110, v80
  v_dot2c_f32_bf16 v22, v111, v57
  v_dot2c_f32_bf16 v23, v111, v80
  v_dot2c_f32_bf16 v24, v112, v57
  v_dot2c_f32_bf16 v25, v112, v80
  v_dot2c_f32_bf16 v26, v113, v57
  v_dot2c_f32_bf16 v27, v113, v80
  v_dot2c_f32_bf16 v28, v114, v57
  v_dot2c_f32_bf16 v29, v114, v80
  v_dot2c_f32_bf16 v30, v115, v57
  v_dot2c_f32_bf16 v31, v115, v80
  v_dot2c_f32_bf16 v32, v116, v57
  v_dot2c_f32_bf16 v33, v116, v80
  v_dot2c_f32_bf16 v34, v117, v57
  v_dot2c_f32_bf16 v35, v117, v80
  v_dot2c_f32_bf16 v36, v118, v57
  v_dot2c_f32_bf16 v37, v118, v80
  v_dot2c_f32_bf16 v38, v119, v57
  v_dot2c_f32_bf16 v39, v119, v80
  global_load_dwordx4 v[96:99], v4, s[34:35] offset:0
  global_load_dwordx4 v[100:103], v4, s[34:35] offset:128
  global_load_dwordx4 v[104:107], v4, s[34:35] offset:256
  s_add_u32 s34, s34, 98304
  s_addc_u32 s35, s35, 0
  global_load_dwordx4 v[108:111], v4, s[34:35] offset:0
  global_load_dwordx4 v[112:115], v4, s[34:35] offset:128
  global_load_dwordx4 v[116:119], v4, s[34:35] offset:256
  s_add_u32 s34, s34, 98304
  s_addc_u32 s35, s35, 0
  s_waitcnt vmcnt(30)
  v_lshlrev_b32 v80, 16, v58
  v_dot2c_f32_bf16 v16, v120, v58
  v_dot2c_f32_bf16 v17, v120, v80
  v_dot2c_f32_bf16 v18, v121, v58
  v_dot2c_f32_bf16 v19, v121, v80
  v_dot2c_f32_bf16 v20, v122, v58
  v_dot2c_f32_bf16 v21, v122, v80
  v_dot2c_f32_bf16 v22, v123, v58
  v_dot2c_f32_bf16 v23, v123, v80
  v_dot2c_f32_bf16 v24, v124, v58
  v_dot2c_f32_bf16 v25, v124, v80
  v_dot2c_f32_bf16 v26, v125, v58
  v_dot2c_f32_bf16 v27, v125, v80
  v_dot2c_f32_bf16 v28, v126, v58
  v_dot2c_f32_bf16 v29, v126, v80
  v_dot2c_f32_bf16 v30, v127, v58
  v_dot2c_f32_bf16 v31, v127, v80
  v_dot2c_f32_bf16 v32, v128, v58
  v_dot2c_f32_bf16 v33, v128, v80
  v_dot2c_f32_bf16 v34, v129, v58
  v_dot2c_f32_bf16 v35, v129, v80
  v_dot2c_f32_bf16 v36, v130, v58
  v_dot2c_f32_bf16 v37, v130, v80
  v_dot2c_f32_bf16 v38, v131, v58
  v_dot2c_f32_bf16 v39, v131, v80
  v_lshlrev_b32 v80, 16, v59
  v_dot2c_f32_bf16 v16, v132, v59
  v_dot2c_f32_bf16 v17, v132, v80
  v_dot2c_f32_bf16 v18, v133, v59
  v_dot2c_f32_bf16 v19, v133, v80
  v_dot2c_f32_bf16 v20, v134, v59
  v_dot2c_f32_bf16 v21, v134, v80
  v_dot2c_f32_bf16 v22, v135, v59
  v_dot2c_f32_bf16 v23, v135, v80
  v_dot2c_f32_bf16 v24, v136, v59
  v_dot2c_f32_bf16 v25, v136, v80
  v_dot2c_f32_bf16 v26, v137, v59
  v_dot2c_f32_bf16 v27, v137, v80
  v_dot2c_f32_bf16 v28, v138, v59
  v_dot2c_f32_bf16 v29, v138, v80
  v_dot2c_f32_bf16 v30, v139, v59
  v_dot2c_f32_bf16 v31, v139, v80
  v_dot2c_f32_bf16 v32, v140, v59
  v_dot2c_f32_bf16 v33, v140, v80
  v_dot2c_f32_bf16 v34, v141, v59
  v_dot2c_f32_bf16 v35, v141, v80
  v_dot2c_f32_bf16 v36, v142, v59
  v_dot2c_f32_bf16 v37, v142, v80
  v_dot2c_f32_bf16 v38, v143, v59
  v_dot2c_f32_bf16 v39, v143, v80
  global_load_dwordx4 v[120:123], v4, s[34:35] offset:0
  global_load_dwordx4 v[124:127], v4, s[34:35] offset:128
  global_load_dwordx4 v[128:131], v4, s[34:35] offset:256
  s_add_u32 s34, s34, 98304
  s_addc_u32 s35, s35, 0
  global_load_dwordx4 v[132:135], v4, s[34:35] offset:0
  global_load_dwordx4 v[136:139], v4, s[34:35] offset:128
  global_load_dwordx4 v[140:143], v4, s[34:35] offset:256
  s_add_u32 s34, s34, 98304
  s_addc_u32 s35, s35, 0
  s_waitcnt vmcnt(30)
  v_lshlrev_b32 v80, 16, v60
  v_dot2c_f32_bf16 v16, v144, v60
  v_dot2c_f32_bf16 v17, v144, v80
  v_dot2c_f32_bf16 v18, v145, v60
  v_dot2c_f32_bf16 v19, v145, v80
  v_dot2c_f32_bf16 v20, v146, v60
  v_dot2c_f32_bf16 v21, v146, v80
  v_dot2c_f32_bf16 v22, v147, v60
  v_dot2c_f32_bf16 v23, v147, v80
  v_dot2c_f32_bf16 v24, v148, v60
  v_dot2c_f32_bf16 v25, v148, v80
  v_dot2c_f32_bf16 v26, v149, v60
  v_dot2c_f32_bf16 v27, v149, v80
  v_dot2c_f32_bf16 v28, v150, v60
  v_dot2c_f32_bf16 v29, v150, v80
  v_dot2c_f32_bf16 v30, v151, v60
  v_dot2c_f32_bf16 v31, v151, v80
  v_dot2c_f32_bf16 v32, v152, v60
  v_dot2c_f32_bf16 v33, v152, v80
  v_dot2c_f32_bf16 v34, v153, v60
  v_dot2c_f32_bf16 v35, v153, v80
  v_dot2c_f32_bf16 v36, v154, v60
  v_dot2c_f32_bf16 v37, v154, v80
  v_dot2c_f32_bf16 v38, v155, v60
  v_dot2c_f32_bf16 v39, v155, v80
  v_lshlrev_b32 v80, 16, v61
  v_dot2c_f32_bf16 v16, v156, v61
  v_dot2c_f32_bf16 v17, v156, v80
  v_dot2c_f32_bf16 v18, v157, v61
  v_dot2c_f32_bf16 v19, v157, v80
  v_dot2c_f32_bf16 v20, v158, v61
  v_dot2c_f32_bf16 v21, v158, v80
  v_dot2c_f32_bf16 v22, v159, v61
  v_dot2c_f32_bf16 v23, v159, v80
  v_dot2c_f32_bf16 v24, v160, v61
  v_dot2c_f32_bf16 v25, v160, v80
  v_dot2c_f32_bf16 v26, v161, v61
  v_dot2c_f32_bf16 v27, v161, v80
  v_dot2c_f32_bf16 v28, v162, v61
  v_dot2c_f32_bf16 v29, v162, v80
  v_dot2c_f32_bf16 v30, v163, v61
  v_dot2c_f32_bf16 v31, v163, v80
  v_dot2c_f32_bf16 v32, v164, v61
  v_dot2c_f32_bf16 v33, v164, v80
  v_dot2c_f32_bf16 v34, v165, v61
  v_dot2c_f32_bf16 v35, v165, v80
  v_dot2c_f32_bf16 v36, v166, v61
  v_dot2c_f32_bf16 v37, v166, v80
  v_dot2c_f32_bf16 v38, v167, v61
  v_dot2c_f32_bf16 v39, v167, v80
  global_load_dwordx4 v[144:147], v4, s[34:35] offset:0
  global_load_dwordx4 v[148:151], v4, s[34:35] offset:128
  global_load_dwordx4 v[152:155], v4, s[34:35] offset:256
  s_add_u32 s34, s34, 98304
  s_addc_u32 s35, s35, 0
  global_load_dwordx4 v[156:159], v4, s[34:35] offset:0
  global_load_dwordx4 v[160:163], v4, s[34:35] offset:128
  global_load_dwordx4 v[164:167], v4, s[34:35] offset:256
  s_add_u32 s34, s34, 98304
  s_addc_u32 s35, s35, 0
  s_waitcnt vmcnt(30)
  v_lshlrev_b32 v80, 16, v62
  v_dot2c_f32_bf16 v16, v168, v62
  v_dot2c_f32_bf16 v17, v168, v80
  v_dot2c_f32_bf16 v18, v169, v62
  v_dot2c_f32_bf16 v19, v169, v80
  v_dot2c_f32_bf16 v20, v170, v62
  v_dot2c_f32_bf16 v21, v170, v80
  v_dot2c_f32_bf16 v22, v171, v62
  v_dot2c_f32_bf16 v23, v171, v80
  v_dot2c_f32_bf16 v24, v172, v62
  v_dot2c_f32_bf16 v25, v172, v80
  v_dot2c_f32_bf16 v26, v173, v62
  v_dot2c_f32_bf16 v27, v173, v80
  v_dot2c_f32_bf16 v28, v174, v62
  v_dot2c_f32_bf16 v29, v174, v80
  v_dot2c_f32_bf16 v30, v175, v62
  v_dot2c_f32_bf16 v31, v175, v80
  v_dot2c_f32_bf16 v32, v176, v62
  v_dot2c_f32_bf16 v33, v176, v80
  v_dot2c_f32_bf16 v34, v177, v62
  v_dot2c_f32_bf16 v35, v177, v80
  v_dot2c_f32_bf16 v36, v178, v62
  v_dot2c_f32_bf16 v37, v178, v80
  v_dot2c_f32_bf16 v38, v179, v62
  v_dot2c_f32_bf16 v39, v179, v80
  v_lshlrev_b32 v80, 16, v63
  v_dot2c_f32_bf16 v16, v180, v63
  v_dot2c_f32_bf16 v17, v180, v80
  v_dot2c_f32_bf16 v18, v181, v63
  v_dot2c_f32_bf16 v19, v181, v80
  v_dot2c_f32_bf16 v20, v182, v63
  v_dot2c_f32_bf16 v21, v182, v80
  v_dot2c_f32_bf16 v22, v183, v63
  v_dot2c_f32_bf16 v23, v183, v80
  v_dot2c_f32_bf16 v24, v184, v63
  v_dot2c_f32_bf16 v25, v184, v80
  v_dot2c_f32_bf16 v26, v185, v63
  v_dot2c_f32_bf16 v27, v185, v80
  v_dot2c_f32_bf16 v28, v186, v63
  v_dot2c_f32_bf16 v29, v186, v80
  v_dot2c_f32_bf16 v30, v187, v63
  v_dot2c_f32_bf16 v31, v187, v80
  v_dot2c_f32_bf16 v32, v188, v63
  v_dot2c_f32_bf16 v33, v188, v80
  v_dot2c_f32_bf16 v34, v189, v63
  v_dot2c_f32_bf16 v35, v189, v80
  v_dot2c_f32_bf16 v36, v190, v63
  v_dot2c_f32_bf16 v37, v190, v80
  v_dot2c_f32_bf16 v38, v191, v63
  v_dot2c_f32_bf16 v39, v191, v80
  global_load_dwordx4 v[168:171], v4, s[34:35] offset:0
  global_load_dwordx4 v[172:175], v4, s[34:35] offset:128
  global_load_dwordx4 v[176:179], v4, s[34:35] offset:256
  s_add_u32 s34, s34, 98304
  s_addc_u32 s35, s35, 0
  global_load_dwordx4 v[180:183], v4, s[34:35] offset:0
  global_load_dwordx4 v[184:187], v4, s[34:35] offset:128
  global_load_dwordx4 v[188:191], v4, s[34:35] offset:256
  s_add_u32 s34, s34, 98304
  s_addc_u32 s35, s35, 0
  s_waitcnt vmcnt(18)
  v_lshlrev_b32 v80, 16, v64
  v_dot2c_f32_bf16 v16, v96, v64
  v_dot2c_f32_bf16 v17, v96, v80
  v_dot2c_f32_bf16 v18, v97, v64
  v_dot2c_f32_bf16 v19, v97, v80
  v_dot2c_f32_bf16 v20, v98, v64
  v_dot2c_f32_bf16 v21, v98, v80
  v_dot2c_f32_bf16 v22, v99, v64
  v_dot2c_f32_bf16 v23, v99, v80
  v_dot2c_f32_bf16 v24, v100, v64
  v_dot2c_f32_bf16 v25, v100, v80
  v_dot2c_f32_bf16 v26, v101, v64
  v_dot2c_f32_bf16 v27, v101, v80
  v_dot2c_f32_bf16 v28, v102, v64
  v_dot2c_f32_bf16 v29, v102, v80
  v_dot2c_f32_bf16 v30, v103, v64
  v_dot2c_f32_bf16 v31, v103, v80
  v_dot2c_f32_bf16 v32, v104, v64
  v_dot2c_f32_bf16 v33, v104, v80
  v_dot2c_f32_bf16 v34, v105, v64
  v_dot2c_f32_bf16 v35, v105, v80
  v_dot2c_f32_bf16 v36, v106, v64
  v_dot2c_f32_bf16 v37, v106, v80
  v_dot2c_f32_bf16 v38, v107, v64
  v_dot2c_f32_bf16 v39, v107, v80
  v_lshlrev_b32 v80, 16, v65
  v_dot2c_f32_bf16 v16, v108, v65
  v_dot2c_f32_bf16 v17, v108, v80
  v_dot2c_f32_bf16 v18, v109, v65
  v_dot2c_f32_bf16 v19, v109, v80
  v_dot2c_f32_bf16 v20, v110, v65
  v_dot2c_f32_bf16 v21, v110, v80
  v_dot2c_f32_bf16 v22, v111, v65
  v_dot2c_f32_bf16 v23, v111, v80
  v_dot2c_f32_bf16 v24, v112, v65
  v_dot2c_f32_bf16 v25, v112, v80
  v_dot2c_f32_bf16 v26, v113, v65
  v_dot2c_f32_bf16 v27, v113, v80
  v_dot2c_f32_bf16 v28, v114, v65
  v_dot2c_f32_bf16 v29, v114, v80
  v_dot2c_f32_bf16 v30, v115, v65
  v_dot2c_f32_bf16 v31, v115, v80
  v_dot2c_f32_bf16 v32, v116, v65
  v_dot2c_f32_bf16 v33, v116, v80
  v_dot2c_f32_bf16 v34, v117, v65
  v_dot2c_f32_bf16 v35, v117, v80
  v_dot2c_f32_bf16 v36, v118, v65
  v_dot2c_f32_bf16 v37, v118, v80
  v_dot2c_f32_bf16 v38, v119, v65
  v_dot2c_f32_bf16 v39, v119, v80
  global_load_dwordx4 v[96:99], v4, s[34:35] offset:0
  global_load_dwordx4 v[100:103], v4, s[34:35] offset:128
  global_load_dwordx4 v[104:107], v4, s[34:35] offset:256
  s_add_u32 s34, s34, 98304
  s_addc_u32 s35, s35, 0
  global_load_dwordx4 v[108:111], v4, s[34:35] offset:0
  global_load_dwordx4 v[112:115], v4, s[34:35] offset:128
  global_load_dwordx4 v[116:119], v4, s[34:35] offset:256
  s_add_u32 s34, s34, 98304
  s_addc_u32 s35, s35, 0
  s_waitcnt vmcnt(18)
  v_lshlrev_b32 v80, 16, v66
  v_dot2c_f32_bf16 v16, v120, v66
  v_dot2c_f32_bf16 v17, v120, v80
  v_dot2c_f32_bf16 v18, v121, v66
  v_dot2c_f32_bf16 v19, v121, v80
  v_dot2c_f32_bf16 v20, v122, v66
  v_dot2c_f32_bf16 v21, v122, v80
  v_dot2c_f32_bf16 v22, v123, v66
  v_dot2c_f32_bf16 v23, v123, v80
  v_dot2c_f32_bf16 v24, v124, v66
  v_dot2c_f32_bf16 v25, v124, v80
  v_dot2c_f32_bf16 v26, v125, v66
  v_dot2c_f32_bf16 v27, v125, v80
  v_dot2c_f32_bf16 v28, v126, v66
  v_dot2c_f32_bf16 v29, v126, v80
  v_dot2c_f32_bf16 v30, v127, v66
  v_dot2c_f32_bf16 v31, v127, v80
  v_dot2c_f32_bf16 v32, v128, v66
  v_dot2c_f32_bf16 v33, v128, v80
  v_dot2c_f32_bf16 v34, v129, v66
  v_dot2c_f32_bf16 v35, v129, v80
  v_dot2c_f32_bf16 v36, v130, v66
  v_dot2c_f32_bf16 v37, v130, v80
  v_dot2c_f32_bf16 v38, v131, v66
  v_dot2c_f32_bf16 v39, v131, v80
  v_lshlrev_b32 v80, 16, v67
  v_dot2c_f32_bf16 v16, v132, v67
  v_dot2c_f32_bf16 v17, v132, v80
  v_dot2c_f32_bf16 v18, v133, v67
  v_dot2c_f32_bf16 v19, v133, v80
  v_dot2c_f32_bf16 v20, v134, v67
  v_dot2c_f32_bf16 v21, v134, v80
  v_dot2c_f32_bf16 v22, v135, v67
  v_dot2c_f32_bf16 v23, v135, v80
  v_dot2c_f32_bf16 v24, v136, v67
  v_dot2c_f32_bf16 v25, v136, v80
  v_dot2c_f32_bf16 v26, v137, v67
  v_dot2c_f32_bf16 v27, v137, v80
  v_dot2c_f32_bf16 v28, v138, v67
  v_dot2c_f32_bf16 v29, v138, v80
  v_dot2c_f32_bf16 v30, v139, v67
  v_dot2c_f32_bf16 v31, v139, v80
  v_dot2c_f32_bf16 v32, v140, v67
  v_dot2c_f32_bf16 v33, v140, v80
  v_dot2c_f32_bf16 v34, v141, v67
  v_dot2c_f32_bf16 v35, v141, v80
  v_dot2c_f32_bf16 v36, v142, v67
  v_dot2c_f32_bf16 v37, v142, v80
  v_dot2c_f32_bf16 v38, v143, v67
  v_dot2c_f32_bf16 v39, v143, v80
  global_load_dwordx4 v[120:123], v4, s[34:35] offset:0
  global_load_dwordx4 v[124:127], v4, s[34:35] offset:128
  global_load_dwordx4 v[128:131], v4, s[34:35] offset:256
  s_add_u32 s34, s34, 98304
  s_addc_u32 s35, s35, 0
  global_load_dwordx4 v[132:135], v4, s[34:35] offset:0
  global_load_dwordx4 v[136:139], v4, s[34:35] offset:128
  global_load_dwordx4 v[140:143], v4, s[34:35] offset:256
  s_add_u32 s34, s34, 98304
  s_addc_u32 s35, s35, 0
  s_waitcnt vmcnt(18)
  v_lshlrev_b32 v80, 16, v68
  v_dot2c_f32_bf16 v16, v144, v68
  v_dot2c_f32_bf16 v17, v144, v80
  v_dot2c_f32_bf16 v18, v145, v68
  v_dot2c_f32_bf16 v19, v145, v80
  v_dot2c_f32_bf16 v20, v146, v68
  v_dot2c_f32_bf16 v21, v146, v80
  v_dot2c_f32_bf16 v22, v147, v68
  v_dot2c_f32_bf16 v23, v147, v80
  v_dot2c_f32_bf16 v24, v148, v68
  v_dot2c_f32_bf16 v25, v148, v80
  v_dot2c_f32_bf16 v26, v149, v68
  v_dot2c_f32_bf16 v27, v149, v80
  v_dot2c_f32_bf16 v28, v150, v68
  v_dot2c_f32_bf16 v29, v150, v80
  v_dot2c_f32_bf16 v30, v151, v68
  v_dot2c_f32_bf16 v31, v151, v80
  v_dot2c_f32_bf16 v32, v152, v68
  v_dot2c_f32_bf16 v33, v152, v80
  v_dot2c_f32_bf16 v34, v153, v68
  v_dot2c_f32_bf16 v35, v153, v80
  v_dot2c_f32_bf16 v36, v154, v68
  v_dot2c_f32_bf16 v37, v154, v80
  v_dot2c_f32_bf16 v38, v155, v68
  v_dot2c_f32_bf16 v39, v155, v80
  v_lshlrev_b32 v80, 16, v69
  v_dot2c_f32_bf16 v16, v156, v69
  v_dot2c_f32_bf16 v17, v156, v80
  v_dot2c_f32_bf16 v18, v157, v69
  v_dot2c_f32_bf16 v19, v157, v80
  v_dot2c_f32_bf16 v20, v158, v69
  v_dot2c_f32_bf16 v21, v158, v80
  v_dot2c_f32_bf16 v22, v159, v69
  v_dot2c_f32_bf16 v23, v159, v80
  v_dot2c_f32_bf16 v24, v160, v69
  v_dot2c_f32_bf16 v25, v160, v80
  v_dot2c_f32_bf16 v26, v161, v69
  v_dot2c_f32_bf16 v27, v161, v80
  v_dot2c_f32_bf16 v28, v162, v69
  v_dot2c_f32_bf16 v29, v162, v80
  v_dot2c_f32_bf16 v30, v163, v69
  v_dot2c_f32_bf16 v31, v163, v80
  v_dot2c_f32_bf16 v32, v164, v69
  v_dot2c_f32_bf16 v33, v164, v80
  v_dot2c_f32_bf16 v34, v165, v69
  v_dot2c_f32_bf16 v35, v165, v80
  v_dot2c_f32_bf16 v36, v166, v69
  v_dot2c_f32_bf16 v37, v166, v80
  v_dot2c_f32_bf16 v38, v167, v69
  v_dot2c_f32_bf16 v39, v167, v80
  global_load_dwordx4 v[144:147], v5, s[38:39] offset:0 nt
  global_load_dwordx4 v[148:151], v5, s[38:39] offset:128 nt
  global_load_dwordx4 v[152:155], v5, s[38:39] offset:256 nt
  global_load_dwordx4 v[156:159], v5, s[38:39] offset:3072 nt
  global_load_dwordx4 v[160:163], v5, s[38:39] offset:3200 nt
  global_load_dwordx4 v[164:167], v5, s[38:39] offset:3328 nt
  s_add_u32 s38, s38, 6144
  s_addc_u32 s39, s39, 0
  s_waitcnt vmcnt(18)
  v_lshlrev_b32 v80, 16, v70
  v_dot2c_f32_bf16 v16, v168, v70
  v_dot2c_f32_bf16 v17, v168, v80
  v_dot2c_f32_bf16 v18, v169, v70
  v_dot2c_f32_bf16 v19, v169, v80
  v_dot2c_f32_bf16 v20, v170, v70
  v_dot2c_f32_bf16 v21, v170, v80
  v_dot2c_f32_bf16 v22, v171, v70
  v_dot2c_f32_bf16 v23, v171, v80
  v_dot2c_f32_bf16 v24, v172, v70
  v_dot2c_f32_bf16 v25, v172, v80
  v_dot2c_f32_bf16 v26, v173, v70
  v_dot2c_f32_bf16 v27, v173, v80
  v_dot2c_f32_bf16 v28, v174, v70
  v_dot2c_f32_bf16 v29, v174, v80
  v_dot2c_f32_bf16 v30, v175, v70
  v_dot2c_f32_bf16 v31, v175, v80
  v_dot2c_f32_bf16 v32, v176, v70
  v_dot2c_f32_bf16 v33, v176, v80
  v_dot2c_f32_bf16 v34, v177, v70
  v_dot2c_f32_bf16 v35, v177, v80
  v_dot2c_f32_bf16 v36, v178, v70
  v_dot2c_f32_bf16 v37, v178, v80
  v_dot2c_f32_bf16 v38, v179, v70
  v_dot2c_f32_bf16 v39, v179, v80
  v_lshlrev_b32 v80, 16, v71
  v_dot2c_f32_bf16 v16, v180, v71
  v_dot2c_f32_bf16 v17, v180, v80
  v_dot2c_f32_bf16 v18, v181, v71
  v_dot2c_f32_bf16 v19, v181, v80
  v_dot2c_f32_bf16 v20, v182, v71
  v_dot2c_f32_bf16 v21, v182, v80
  v_dot2c_f32_bf16 v22, v183, v71
  v_dot2c_f32_bf16 v23, v183, v80
  v_dot2c_f32_bf16 v24, v184, v71
  v_dot2c_f32_bf16 v25, v184, v80
  v_dot2c_f32_bf16 v26, v185, v71
  v_dot2c_f32_bf16 v27, v185, v80
  v_dot2c_f32_bf16 v28, v186, v71
  v_dot2c_f32_bf16 v29, v186, v80
  v_dot2c_f32_bf16 v30, v187, v71
  v_dot2c_f32_bf16 v31, v187, v80
  v_dot2c_f32_bf16 v32, v188, v71
  v_dot2c_f32_bf16 v33, v188, v80
  v_dot2c_f32_bf16 v34, v189, v71
  v_dot2c_f32_bf16 v35, v189, v80
  v_dot2c_f32_bf16 v36, v190, v71
  v_dot2c_f32_bf16 v37, v190, v80
  v_dot2c_f32_bf16 v38, v191, v71
  v_dot2c_f32_bf16 v39, v191, v80
  global_load_dwordx4 v[168:171], v5, s[38:39] offset:0 nt
  global_load_dwordx4 v[172:175], v5, s[38:39] offset:128 nt
  global_load_dwordx4 v[176:179], v5, s[38:39] offset:256 nt
  global_load_dwordx4 v[180:183], v5, s[38:39] offset:3072 nt
  global_load_dwordx4 v[184:187], v5, s[38:39] offset:3200 nt
  global_load_dwordx4 v[188:191], v5, s[38:39] offset:3328 nt
  s_add_u32 s38, s38, 6144
  s_addc_u32 s39, s39, 0
  s_waitcnt vmcnt(18)
  v_lshlrev_b32 v80, 16, v72
  v_dot2c_f32_bf16 v16, v96, v72
  v_dot2c_f32_bf16 v17, v96, v80
  v_dot2c_f32_bf16 v18, v97, v72
  v_dot2c_f32_bf16 v19, v97, v80
  v_dot2c_f32_bf16 v20, v98, v72
  v_dot2c_f32_bf16 v21, v98, v80
  v_dot2c_f32_bf16 v22, v99, v72
  v_dot2c_f32_bf16 v23, v99, v80
  v_dot2c_f32_bf16 v24, v100, v72
  v_dot2c_f32_bf16 v25, v100, v80
  v_dot2c_f32_bf16 v26, v101, v72
  v_dot2c_f32_bf16 v27, v101, v80
  v_dot2c_f32_bf16 v28, v102, v72
  v_dot2c_f32_bf16 v29, v102, v80
  v_dot2c_f32_bf16 v30, v103, v72
  v_dot2c_f32_bf16 v31, v103, v80
  v_dot2c_f32_bf16 v32, v104, v72
  v_dot2c_f32_bf16 v33, v104, v80
  v_dot2c_f32_bf16 v34, v105, v72
  v_dot2c_f32_bf16 v35, v105, v80
  v_dot2c_f32_bf16 v36, v106, v72
  v_dot2c_f32_bf16 v37, v106, v80
  v_dot2c_f32_bf16 v38, v107, v72
  v_dot2c_f32_bf16 v39, v107, v80
  v_lshlrev_b32 v80, 16, v73
  v_dot2c_f32_bf16 v16, v108, v73
  v_dot2c_f32_bf16 v17, v108, v80
  v_dot2c_f32_bf16 v18, v109, v73
  v_dot2c_f32_bf16 v19, v109, v80
  v_dot2c_f32_bf16 v20, v110, v73
  v_dot2c_f32_bf16 v21, v110, v80
  v_dot2c_f32_bf16 v22, v111, v73
  v_dot2c_f32_bf16 v23, v111, v80
  v_dot2c_f32_bf16 v24, v112, v73
  v_dot2c_f32_bf16 v25, v112, v80
  v_dot2c_f32_bf16 v26, v113, v73
  v_dot2c_f32_bf16 v27, v113, v80
  v_dot2c_f32_bf16 v28, v114, v73
  v_dot2c_f32_bf16 v29, v114, v80
  v_dot2c_f32_bf16 v30, v115, v73
  v_dot2c_f32_bf16 v31, v115, v80
  v_dot2c_f32_bf16 v32, v116, v73
  v_dot2c_f32_bf16 v33, v116, v80
  v_dot2c_f32_bf16 v34, v117, v73
  v_dot2c_f32_bf16 v35, v117, v80
  v_dot2c_f32_bf16 v36, v118, v73
  v_dot2c_f32_bf16 v37, v118, v80
  v_dot2c_f32_bf16 v38, v119, v73
  v_dot2c_f32_bf16 v39, v119, v80
  global_load_dwordx4 v[96:99], v5, s[38:39] offset:0 nt
  global_load_dwordx4 v[100:103], v5, s[38:39] offset:128 nt
  global_load_dwordx4 v[104:107], v5, s[38:39] offset:256 nt
  global_load_dwordx4 v[108:111], v5, s[38:39] offset:3072 nt
  global_load_dwordx4 v[112:115], v5, s[38:39] offset:3200 nt
  global_load_dwordx4 v[116:119], v5, s[38:39] offset:3328 nt
  s_add_u32 s38, s38, 6144
  s_addc_u32 s39, s39, 0
  s_waitcnt vmcnt(18)
  v_lshlrev_b32 v80, 16, v74
  v_dot2c_f32_bf16 v16, v120, v74
  v_dot2c_f32_bf16 v17, v120, v80
  v_dot2c_f32_bf16 v18, v121, v74
  v_dot2c_f32_bf16 v19, v121, v80
  v_dot2c_f32_bf16 v20, v122, v74
  v_dot2c_f32_bf16 v21, v122, v80
  v_dot2c_f32_bf16 v22, v123, v74
  v_dot2c_f32_bf16 v23, v123, v80
  v_dot2c_f32_bf16 v24, v124, v74
  v_dot2c_f32_bf16 v25, v124, v80
  v_dot2c_f32_bf16 v26, v125, v74
  v_dot2c_f32_bf16 v27, v125, v80
  v_dot2c_f32_bf16 v28, v126, v74
  v_dot2c_f32_bf16 v29, v126, v80
  v_dot2c_f32_bf16 v30, v127, v74
  v_dot2c_f32_bf16 v31, v127, v80
  v_dot2c_f32_bf16 v32, v128, v74
  v_dot2c_f32_bf16 v33, v128, v80
  v_dot2c_f32_bf16 v34, v129, v74
  v_dot2c_f32_bf16 v35, v129, v80
  v_dot2c_f32_bf16 v36, v130, v74
  v_dot2c_f32_bf16 v37, v130, v80
  v_dot2c_f32_bf16 v38, v131, v74
  v_dot2c_f32_bf16 v39, v131, v80
  v_lshlrev_b32 v80, 16, v75
  v_dot2c_f32_bf16 v16, v132, v75
  v_dot2c_f32_bf16 v17, v132, v80
  v_dot2c_f32_bf16 v18, v133, v75
  v_dot2c_f32_bf16 v19, v133, v80
  v_dot2c_f32_bf16 v20, v134, v75
  v_dot2c_f32_bf16 v21, v134, v80
  v_dot2c_f32_bf16 v22, v135, v75
  v_dot2c_f32_bf16 v23, v135, v80
  v_dot2c_f32_bf16 v24, v136, v75
  v_dot2c_f32_bf16 v25, v136, v80
  v_dot2c_f32_bf16 v26, v137, v75
  v_dot2c_f32_bf16 v27, v137, v80
  v_dot2c_f32_bf16 v28, v138, v75
  v_dot2c_f32_bf16 v29, v138, v80
  v_dot2c_f32_bf16 v30, v139, v75
  v_dot2c_f32_bf16 v31, v139, v80
  v_dot2c_f32_bf16 v32, v140, v75
  v_dot2c_f32_bf16 v33, v140, v80
  v_dot2c_f32_bf16 v34, v141, v75
  v_dot2c_f32_bf16 v35, v141, v80
  v_dot2c_f32_bf16 v36, v142, v75
  v_dot2c_f32_bf16 v37, v142, v80
  v_dot2c_f32_bf16 v38, v143, v75
  v_dot2c_f32_bf16 v39, v143, v80
  global_load_dwordx4 v[120:123], v5, s[38:39] offset:0 nt
  global_load_dwordx4 v[124:127], v5, s[38:39] offset:128 nt
  global_load_dwordx4 v[128:131], v5, s[38:39] offset:256 nt
  global_load_dwordx4 v[132:135], v5, s[38:39] offset:3072 nt
  global_load_dwordx4 v[136:139], v5, s[38:39] offset:3200 nt
  global_load_dwordx4 v[140:143], v5, s[38:39] offset:3328 nt
  s_add_u32 s38, s38, 6144
  s_addc_u32 s39, s39, 0
  s_nop 3
  v_add_f32_dpp v16, v16, v16 row_ror:8 row_mask:0xf bank_mask:0xf
  v_add_f32_dpp v17, v17, v17 row_ror:8 row_mask:0xf bank_mask:0xf
  v_add_f32_dpp v18, v18, v18 row_ror:8 row_mask:0xf bank_mask:0xf
  v_add_f32_dpp v19, v19, v19 row_ror:8 row_mask:0xf bank_mask:0xf
  v_add_f32_dpp v20, v20, v20 row_ror:8 row_mask:0xf bank_mask:0xf
  v_add_f32_dpp v21, v21, v21 row_ror:8 row_mask:0xf bank_mask:0xf
  v_add_f32_dpp v22, v22, v22 row_ror:8 row_mask:0xf bank_mask:0xf
  v_add_f32_dpp v23, v23, v23 row_ror:8 row_mask:0xf bank_mask:0xf
  v_add_f32_dpp v24, v24, v24 row_ror:8 row_mask:0xf bank_mask:0xf
  v_add_f32_dpp v25, v25, v25 row_ror:8 row_mask:0xf bank_mask:0xf
  v_add_f32_dpp v26, v26, v26 row_ror:8 row_mask:0xf bank_mask:0xf
  v_add_f32_dpp v27, v27, v27 row_ror:8 row_mask:0xf bank_mask:0xf
  v_add_f32_dpp v28, v28, v28 row_ror:8 row_mask:0xf bank_mask:0xf
  v_add_f32_dpp v29, v29, v29 row_ror:8 row_mask:0xf bank_mask:0xf
  v_add_f32_dpp v30, v30, v30 row_ror:8 row_mask:0xf bank_mask:0xf
  v_add_f32_dpp v31, v31, v31 row_ror:8 row_mask:0xf bank_mask:0xf
  v_add_f32_dpp v32, v32, v32 row_ror:8 row_mask:0xf bank_mask:0xf
  v_add_f32_dpp v33, v33, v33 row_ror:8 row_mask:0xf bank_mask:0xf
  v_add_f32_dpp v34, v34, v34 row_ror:8 row_mask:0xf bank_mask:0xf
  v_add_f32_dpp v35, v35, v35 row_ror:8 row_mask:0xf bank_mask:0xf
  v_add_f32_dpp v36, v36, v36 row_ror:8 row_mask:0xf bank_mask:0xf
  v_add_f32_dpp v37, v37, v37 row_ror:8 row_mask:0xf bank_mask:0xf
  v_add_f32_dpp v38, v38, v38 row_ror:8 row_mask:0xf bank_mask:0xf
  v_add_f32_dpp v39, v39, v39 row_ror:8 row_mask:0xf bank_mask:0xf
  v_mov_b32 v80, v16
  v_mov_b32 v81, v17
  v_mov_b32 v82, v18
  v_mov_b32 v83, v19
  v_mov_b32 v84, v20
  v_mov_b32 v85, v21
  v_mov_b32 v86, v22
  v_mov_b32 v87, v23
  v_permlane16_swap_b32 v16, v80
  v_permlane16_swap_b32 v17, v81
  v_permlane16_swap_b32 v18, v82
  v_permlane16_swap_b32 v19, v83
  v_permlane16_swap_b32 v20, v84
  v_permlane16_swap_b32 v21, v85
  v_permlane16_swap_b32 v22, v86
  v_permlane16_swap_b32 v23, v87
  v_add_f32 v16, v16, v80
  v_add_f32 v17, v17, v81
  v_add_f32 v18, v18, v82
  v_add_f32 v19, v19, v83
  v_add_f32 v20, v20, v84
  v_add_f32 v21, v21, v85
  v_add_f32 v22, v22, v86
  v_add_f32 v23, v23, v87
  v_mov_b32 v80, v24
  v_mov_b32 v81, v25
  v_mov_b32 v82, v26
  v_mov_b32 v83, v27
  v_mov_b32 v84, v28
  v_mov_b32 v85, v29
  v_mov_b32 v86, v30
  v_mov_b32 v87, v31
  v_permlane16_swap_b32 v24, v80
  v_permlane16_swap_b32 v25, v81
  v_permlane16_swap_b32 v26, v82
  v_permlane16_swap_b32 v27, v83
  v_permlane16_swap_b32 v28, v84
  v_permlane16_swap_b32 v29, v85
  v_permlane16_swap_b32 v30, v86
  v_permlane16_swap_b32 v31, v87
  v_add_f32 v24, v24, v80
  v_add_f32 v25, v25, v81
  v_add_f32 v26, v26, v82
  v_add_f32 v27, v27, v83
  v_add_f32 v28, v28, v84
  v_add_f32 v29, v29, v85
  v_add_f32 v30, v30, v86
  v_add_f32 v31, v31, v87
  v_mov_b32 v80, v32
  v_mov_b32 v81, v33
  v_mov_b32 v82, v34
  v_mov_b32 v83, v35
  v_mov_b32 v84, v36
  v_mov_b32 v85, v37
  v_mov_b32 v86, v38
  v_mov_b32 v87, v39
  v_permlane16_swap_b32 v32, v80
  v_permlane16_swap_b32 v33, v81
  v_permlane16_swap_b32 v34, v82
  v_permlane16_swap_b32 v35, v83
  v_permlane16_swap_b32 v36, v84
  v_permlane16_swap_b32 v37, v85
  v_permlane16_swap_b32 v38, v86
  v_permlane16_swap_b32 v39, v87
  v_add_f32 v32, v32, v80
  v_add_f32 v33, v33, v81
  v_add_f32 v34, v34, v82
  v_add_f32 v35, v35, v83
  v_add_f32 v36, v36, v84
  v_add_f32 v37, v37, v85
  v_add_f32 v38, v38, v86
  v_add_f32 v39, v39, v87
  v_mov_b32 v80, v16
  v_mov_b32 v81, v17
  v_mov_b32 v82, v18
  v_mov_b32 v83, v19
  v_mov_b32 v84, v20
  v_mov_b32 v85, v21
  v_mov_b32 v86, v22
  v_mov_b32 v87, v23
  v_permlane32_swap_b32 v16, v80
  v_permlane32_swap_b32 v17, v81
  v_permlane32_swap_b32 v18, v82
  v_permlane32_swap_b32 v19, v83
  v_permlane32_swap_b32 v20, v84
  v_permlane32_swap_b32 v21, v85
  v_permlane32_swap_b32 v22, v86
  v_permlane32_swap_b32 v23, v87
  v_add_f32 v16, v16, v80
  v_add_f32 v17, v17, v81
  v_add_f32 v18, v18, v82
  v_add_f32 v19, v19, v83
  v_add_f32 v20, v20, v84
  v_add_f32 v21, v21, v85
  v_add_f32 v22, v22, v86
  v_add_f32 v23, v23, v87
  v_mov_b32 v80, v24
  v_mov_b32 v81, v25
  v_mov_b32 v82, v26
  v_mov_b32 v83, v27
  v_mov_b32 v84, v28
  v_mov_b32 v85, v29
  v_mov_b32 v86, v30
  v_mov_b32 v87, v31
  v_permlane32_swap_b32 v24, v80
  v_permlane32_swap_b32 v25, v81
  v_permlane32_swap_b32 v26, v82
  v_permlane32_swap_b32 v27, v83
  v_permlane32_swap_b32 v28, v84
  v_permlane32_swap_b32 v29, v85
  v_permlane32_swap_b32 v30, v86
  v_permlane32_swap_b32 v31, v87
  v_add_f32 v24, v24, v80
  v_add_f32 v25, v25, v81
  v_add_f32 v26, v26, v82
  v_add_f32 v27, v27, v83
  v_add_f32 v28, v28, v84
  v_add_f32 v29, v29, v85
  v_add_f32 v30, v30, v86
  v_add_f32 v31, v31, v87
  v_mov_b32 v80, v32
  v_mov_b32 v81, v33
  v_mov_b32 v82, v34
  v_mov_b32 v83, v35
  v_mov_b32 v84, v36
  v_mov_b32 v85, v37
  v_mov_b32 v86, v38
  v_mov_b32 v87, v39
  v_permlane32_swap_b32 v32, v80
  v_permlane32_swap_b32 v33, v81
  v_permlane32_swap_b32 v34, v82
  v_permlane32_swap_b32 v35, v83
  v_permlane32_swap_b32 v36, v84
  v_permlane32_swap_b32 v37, v85
  v_permlane32_swap_b32 v38, v86
  v_permlane32_swap_b32 v39, v87
  v_add_f32 v32, v32, v80
  v_add_f32 v33, v33, v81
  v_add_f32 v34, v34, v82
  v_add_f32 v35, v35, v83
  v_add_f32 v36, v36, v84
  v_add_f32 v37, v37, v85
  v_add_f32 v38, v38, v86
  v_add_f32 v39, v39, v87
  s_mov_b64 exec, 0xff
  ds_write_b128 v8, v[16:19] offset:0
  ds_write_b128 v8, v[20:23] offset:16
  ds_write_b128 v8, v[24:27] offset:256
  ds_write_b128 v8, v[28:31] offset:272
  ds_write_b128 v8, v[32:35] offset:512
  ds_write_b128 v8, v[36:39] offset:528
  s_mov_b64 exec, -1
  s_waitcnt lgkmcnt(0)
  s_barrier
  ds_read_b128 v[16:19], v9 offset:0
  ds_read_b128 v[20:23], v9 offset:768
  ds_read_b128 v[24:27], v9 offset:1536
  ds_read_b128 v[28:31], v9 offset:2304
  ds_read_b128 v[32:35], v9 offset:16
  ds_read_b128 v[36:39], v9 offset:784
  ds_read_b128 v[80:83], v9 offset:1552
  ds_read_b128 v[84:87], v9 offset:2320
  s_waitcnt lgkmcnt(0)
  v_add_f32 v16, v16, v20
  v_add_f32 v24, v24, v28
  v_add_f32 v17, v17, v21
  v_add_f32 v25, v25, v29
  v_add_f32 v18, v18, v22
  v_add_f32 v26, v26, v30
  v_add_f32 v19, v19, v23
  v_add_f32 v27, v27, v31
  v_add_f32 v16, v16, v24
  v_add_f32 v17, v17, v25
  v_add_f32 v18, v18, v26
  v_add_f32 v19, v19, v27
  v_cvt_pk_bf16_f32 v56, v16, v17
  v_cvt_pk_bf16_f32 v57, v18, v19
  v_add_f32 v32, v32, v36
  v_add_f32 v80, v80, v84
  v_add_f32 v33, v33, v37
  v_add_f32 v81, v81, v85
  v_add_f32 v34, v34, v38
  v_add_f32 v82, v82, v86
  v_add_f32 v35, v35, v39
  v_add_f32 v83, v83, v87
  v_add_f32 v32, v32, v80
  v_add_f32 v33, v33, v81
  v_add_f32 v34, v34, v82
  v_add_f32 v35, v35, v83
  v_cvt_pk_bf16_f32 v58, v32, v33
  v_cvt_pk_bf16_f32 v59, v34, v35
  ds_read_b128 v[16:19], v9 offset:256
  ds_read_b128 v[20:23], v9 offset:1024
  ds_read_b128 v[24:27], v9 offset:1792
  ds_read_b128 v[28:31], v9 offset:2560
  ds_read_b128 v[32:35], v9 offset:272
  ds_read_b128 v[36:39], v9 offset:1040
  ds_read_b128 v[80:83], v9 offset:1808
  ds_read_b128 v[84:87], v9 offset:2576
  s_waitcnt lgkmcnt(0)
  v_add_f32 v16, v16, v20
  v_add_f32 v24, v24, v28
  v_add_f32 v17, v17, v21
  v_add_f32 v25, v25, v29
  v_add_f32 v18, v18, v22
  v_add_f32 v26, v26, v30
  v_add_f32 v19, v19, v23
  v_add_f32 v27, v27, v31
  v_add_f32 v16, v16, v24
  v_add_f32 v17, v17, v25
  v_add_f32 v18, v18, v26
  v_add_f32 v19, v19, v27
  v_cvt_pk_bf16_f32 v60, v16, v17
  v_cvt_pk_bf16_f32 v61, v18, v19
  v_add_f32 v32, v32, v36
  v_add_f32 v80, v80, v84
  v_add_f32 v33, v33, v37
  v_add_f32 v81, v81, v85
  v_add_f32 v34, v34, v38
  v_add_f32 v82, v82, v86
  v_add_f32 v35, v35, v39
  v_add_f32 v83, v83, v87
  v_add_f32 v32, v32, v80
  v_add_f32 v33, v33, v81
  v_add_f32 v34, v34, v82
  v_add_f32 v35, v35, v83
  v_cvt_pk_bf16_f32 v62, v32, v33
  v_cvt_pk_bf16_f32 v63, v34, v35
  ds_read_b128 v[16:19], v9 offset:512
  ds_read_b128 v[20:23], v9 offset:1280
  ds_read_b128 v[24:27], v9 offset:2048
  ds_read_b128 v[28:31], v9 offset:2816
  ds_read_b128 v[32:35], v9 offset:528
  ds_read_b128 v[36:39], v9 offset:1296
  ds_read_b128 v[80:83], v9 offset:2064
  ds_read_b128 v[84:87], v9 offset:2832
  s_waitcnt lgkmcnt(0)
  v_add_f32 v16, v16, v20
  v_add_f32 v24, v24, v28
  v_add_f32 v17, v17, v21
  v_add_f32 v25, v25, v29
  v_add_f32 v18, v18, v22
  v_add_f32 v26, v26, v30
  v_add_f32 v19, v19, v23
  v_add_f32 v27, v27, v31
  v_add_f32 v16, v16, v24
  v_add_f32 v17, v17, v25
  v_add_f32 v18, v18, v26
  v_add_f32 v19, v19, v27
  v_cvt_pk_bf16_f32 v64, v16, v17
  v_cvt_pk_bf16_f32 v65, v18, v19
  v_add_f32 v32, v32, v36
  v_add_f32 v80, v80, v84
  v_add_f32 v33, v33, v37
  v_add_f32 v81, v81, v85
  v_add_f32 v34, v34, v38
  v_add_f32 v82, v82, v86
  v_add_f32 v35, v35, v39
  v_add_f32 v83, v83, v87
  v_add_f32 v32, v32, v80
  v_add_f32 v33, v33, v81
  v_add_f32 v34, v34, v82
  v_add_f32 v35, v35, v83
  v_cvt_pk_bf16_f32 v66, v32, v33
  v_cvt_pk_bf16_f32 v67, v34, v35
  v_mov_b32 v16, 0
  v_mov_b32 v17, 0
  v_mov_b32 v18, 0
  v_mov_b32 v19, 0
  v_mov_b32 v20, 0
  v_mov_b32 v21, 0
  v_mov_b32 v22, 0
  v_mov_b32 v23, 0
  v_mov_b32 v24, 0
  v_mov_b32 v25, 0
  v_mov_b32 v26, 0
  v_mov_b32 v27, 0
  v_mov_b32 v28, 0
  v_mov_b32 v29, 0
  v_mov_b32 v30, 0
  v_mov_b32 v31, 0
  v_mov_b32 v32, 0
  v_mov_b32 v33, 0
  v_mov_b32 v34, 0
  v_mov_b32 v35, 0
  v_mov_b32 v36, 0
  v_mov_b32 v37, 0
  v_mov_b32 v38, 0
  v_mov_b32 v39, 0
  s_setprio 0
  v_dot2_f32_bf16 v80, v192, v56, 0
  v_dot2_f32_bf16 v81, v196, v60, 0
  v_dot2_f32_bf16 v82, v200, v64, 0
  v_dot2_f32_bf16 v83, v204, v56, 0
  v_dot2_f32_bf16 v84, v208, v60, 0
  v_dot2_f32_bf16 v85, v212, v64, 0
  v_dot2c_f32_bf16 v80, v193, v57
  v_dot2c_f32_bf16 v81, v197, v61
  v_dot2c_f32_bf16 v82, v201, v65
  v_dot2c_f32_bf16 v83, v205, v57
  v_dot2c_f32_bf16 v84, v209, v61
  v_dot2c_f32_bf16 v85, v213, v65
  v_dot2c_f32_bf16 v80, v194, v58
  v_dot2c_f32_bf16 v81, v198, v62
  v_dot2c_f32_bf16 v82, v202, v66
  v_dot2c_f32_bf16 v83, v206, v58
  v_dot2c_f32_bf16 v84, v210, v62
  v_dot2c_f32_bf16 v85, v214, v66
  v_dot2c_f32_bf16 v80, v195, v59
  v_dot2c_f32_bf16 v81, v199, v63
  v_dot2c_f32_bf16 v82, v203, v67
  v_dot2c_f32_bf16 v83, v207, v59
  v_dot2c_f32_bf16 v84, v211, v63
  v_dot2c_f32_bf16 v85, v215, v67
  s_nop 2
  v_add_f32 v80, v80, v81
  v_add_f32 v83, v83, v84
  v_add_f32 v80, v80, v82
  v_add_f32 v83, v83, v85
  s_nop 0
  v_add_f32_dpp v80, v80, v80 quad_perm:[1,0,3,2] row_mask:0xf bank_mask:0xf
  v_add_f32_dpp v83, v83, v83 quad_perm:[1,0,3,2] row_mask:0xf bank_mask:0xf
  s_nop 0
  v_add_f32_dpp v80, v80, v80 quad_perm:[2,3,0,1] row_mask:0xf bank_mask:0xf
  v_add_f32_dpp v83, v83, v83 quad_perm:[2,3,0,1] row_mask:0xf bank_mask:0xf
  s_nop 0
  v_add_f32_dpp v80, v80, v80 row_half_mirror row_mask:0xf bank_mask:0xf
  v_add_f32_dpp v83, v83, v83 row_half_mirror row_mask:0xf bank_mask:0xf
  s_nop 0
  v_cvt_pk_bf16_f32 v80, v80, v80
  v_cvt_pk_bf16_f32 v83, v83, v83
  v_lshlrev_b32 v80, 16, v80
  v_lshlrev_b32 v83, 16, v83
  v_mul_f32 v80, s49, v80
  v_mul_f32 v83, s49, v83
  v_cvt_pk_bf16_f32 v40, v80, v83
  global_load_dwordx4 v[192:195], v5, s[38:39] offset:0 nt
  global_load_dwordx4 v[196:199], v5, s[38:39] offset:128 nt
  global_load_dwordx4 v[200:203], v5, s[38:39] offset:256 nt
  global_load_dwordx4 v[204:207], v5, s[38:39] offset:3072 nt
  global_load_dwordx4 v[208:211], v5, s[38:39] offset:3200 nt
  global_load_dwordx4 v[212:215], v5, s[38:39] offset:3328 nt
  s_add_u32 s38, s38, 6144
  s_addc_u32 s39, s39, 0
  v_dot2_f32_bf16 v80, v216, v56, 0
  v_dot2_f32_bf16 v81, v220, v60, 0
  v_dot2_f32_bf16 v82, v224, v64, 0
  v_dot2_f32_bf16 v83, v228, v56, 0
  v_dot2_f32_bf16 v84, v232, v60, 0
  v_dot2_f32_bf16 v85, v236, v64, 0
  v_dot2c_f32_bf16 v80, v217, v57
  v_dot2c_f32_bf16 v81, v221, v61
  v_dot2c_f32_bf16 v82, v225, v65
  v_dot2c_f32_bf16 v83, v229, v57
  v_dot2c_f32_bf16 v84, v233, v61
  v_dot2c_f32_bf16 v85, v237, v65
  v_dot2c_f32_bf16 v80, v218, v58
  v_dot2c_f32_bf16 v81, v222, v62
  v_dot2c_f32_bf16 v82, v226, v66
  v_dot2c_f32_bf16 v83, v230, v58
  v_dot2c_f32_bf16 v84, v234, v62
  v_dot2c_f32_bf16 v85, v238, v66
  v_dot2c_f32_bf16 v80, v219, v59
  v_dot2c_f32_bf16 v81, v223, v63
  v_dot2c_f32_bf16 v82, v227, v67
  v_dot2c_f32_bf16 v83, v231, v59
  v_dot2c_f32_bf16 v84, v235, v63
  v_dot2c_f32_bf16 v85, v239, v67
  s_nop 2
  v_add_f32 v80, v80, v81
  v_add_f32 v83, v83, v84
  v_add_f32 v80, v80, v82
  v_add_f32 v83, v83, v85
  s_nop 0
  v_add_f32_dpp v80, v80, v80 quad_perm:[1,0,3,2] row_mask:0xf bank_mask:0xf
  v_add_f32_dpp v83, v83, v83 quad_perm:[1,0,3,2] row_mask:0xf bank_mask:0xf
  s_nop 0
  v_add_f32_dpp v80, v80, v80 quad_perm:[2,3,0,1] row_mask:0xf bank_mask:0xf
  v_add_f32_dpp v83, v83, v83 quad_perm:[2,3,0,1] row_mask:0xf bank_mask:0xf
  s_nop 0
  v_add_f32_dpp v80, v80, v80 row_half_mirror row_mask:0xf bank_mask:0xf
  v_add_f32_dpp v83, v83, v83 row_half_mirror row_mask:0xf bank_mask:0xf
  s_nop 0
  v_cvt_pk_bf16_f32 v80, v80, v80
  v_cvt_pk_bf16_f32 v83, v83, v83
  v_lshlrev_b32 v80, 16, v80
  v_lshlrev_b32 v83, 16, v83
  v_mul_f32 v80, s49, v80
  v_mul_f32 v83, s49, v83
  v_cvt_pk_bf16_f32 v41, v80, v83
  global_load_dwordx4 v[216:219], v5, s[38:39] offset:0 nt
  global_load_dwordx4 v[220:223], v5, s[38:39] offset:128 nt
  global_load_dwordx4 v[224:227], v5, s[38:39] offset:256 nt
  global_load_dwordx4 v[228:231], v5, s[38:39] offset:3072 nt
  global_load_dwordx4 v[232:235], v5, s[38:39] offset:3200 nt
  global_load_dwordx4 v[236:239], v5, s[38:39] offset:3328 nt
  s_add_u32 s38, s38, 6144
  s_addc_u32 s39, s39, 0
  s_waitcnt vmcnt(30)
  v_dot2_f32_bf16 v80, v144, v56, 0
  v_dot2_f32_bf16 v81, v148, v60, 0
  v_dot2_f32_bf16 v82, v152, v64, 0
  v_dot2_f32_bf16 v83, v156, v56, 0
  v_dot2_f32_bf16 v84, v160, v60, 0
  v_dot2_f32_bf16 v85, v164, v64, 0
  v_dot2c_f32_bf16 v80, v145, v57
  v_dot2c_f32_bf16 v81, v149, v61
  v_dot2c_f32_bf16 v82, v153, v65
  v_dot2c_f32_bf16 v83, v157, v57
  v_dot2c_f32_bf16 v84, v161, v61
  v_dot2c_f32_bf16 v85, v165, v65
  v_dot2c_f32_bf16 v80, v146, v58
  v_dot2c_f32_bf16 v81, v150, v62
  v_dot2c_f32_bf16 v82, v154, v66
  v_dot2c_f32_bf16 v83, v158, v58
  v_dot2c_f32_bf16 v84, v162, v62
  v_dot2c_f32_bf16 v85, v166, v66
  v_dot2c_f32_bf16 v80, v147, v59
  v_dot2c_f32_bf16 v81, v151, v63
  v_dot2c_f32_bf16 v82, v155, v67
  v_dot2c_f32_bf16 v83, v159, v59
  v_dot2c_f32_bf16 v84, v163, v63
  v_dot2c_f32_bf16 v85, v167, v67
  s_nop 2
  v_add_f32 v80, v80, v81
  v_add_f32 v83, v83, v84
  v_add_f32 v80, v80, v82
  v_add_f32 v83, v83, v85
  s_nop 0
  v_add_f32_dpp v80, v80, v80 quad_perm:[1,0,3,2] row_mask:0xf bank_mask:0xf
  v_add_f32_dpp v83, v83, v83 quad_perm:[1,0,3,2] row_mask:0xf bank_mask:0xf
  s_nop 0
  v_add_f32_dpp v80, v80, v80 quad_perm:[2,3,0,1] row_mask:0xf bank_mask:0xf
  v_add_f32_dpp v83, v83, v83 quad_perm:[2,3,0,1] row_mask:0xf bank_mask:0xf
  s_nop 0
  v_add_f32_dpp v80, v80, v80 row_half_mirror row_mask:0xf bank_mask:0xf
  v_add_f32_dpp v83, v83, v83 row_half_mirror row_mask:0xf bank_mask:0xf
  s_nop 0
  v_cvt_pk_bf16_f32 v80, v80, v80
  v_cvt_pk_bf16_f32 v83, v83, v83
  v_lshlrev_b32 v80, 16, v80
  v_lshlrev_b32 v83, 16, v83
  v_mul_f32 v80, s49, v80
  v_mul_f32 v83, s49, v83
  v_cvt_pk_bf16_f32 v42, v80, v83
  global_load_dwordx4 v[144:147], v5, s[38:39] offset:0 nt
  global_load_dwordx4 v[148:151], v5, s[38:39] offset:128 nt
  global_load_dwordx4 v[152:155], v5, s[38:39] offset:256 nt
  global_load_dwordx4 v[156:159], v5, s[38:39] offset:3072 nt
  global_load_dwordx4 v[160:163], v5, s[38:39] offset:3200 nt
  global_load_dwordx4 v[164:167], v5, s[38:39] offset:3328 nt
  s_add_u32 s38, s38, 6144
  s_addc_u32 s39, s39, 0
  s_waitcnt vmcnt(30)
  v_dot2_f32_bf16 v80, v168, v56, 0
  v_dot2_f32_bf16 v81, v172, v60, 0
  v_dot2_f32_bf16 v82, v176, v64, 0
  v_dot2_f32_bf16 v83, v180, v56, 0
  v_dot2_f32_bf16 v84, v184, v60, 0
  v_dot2_f32_bf16 v85, v188, v64, 0
  v_dot2c_f32_bf16 v80, v169, v57
  v_dot2c_f32_bf16 v81, v173, v61
  v_dot2c_f32_bf16 v82, v177, v65
  v_dot2c_f32_bf16 v83, v181, v57
  v_dot2c_f32_bf16 v84, v185, v61
  v_dot2c_f32_bf16 v85, v189, v65
  v_dot2c_f32_bf16 v80, v170, v58
  v_dot2c_f32_bf16 v81, v174, v62
  v_dot2c_f32_bf16 v82, v178, v66
  v_dot2c_f32_bf16 v83, v182, v58
  v_dot2c_f32_bf16 v84, v186, v62
  v_dot2c_f32_bf16 v85, v190, v66
  v_dot2c_f32_bf16 v80, v171, v59
  v_dot2c_f32_bf16 v81, v175, v63
  v_dot2c_f32_bf16 v82, v179, v67
  v_dot2c_f32_bf16 v83, v183, v59
  v_dot2c_f32_bf16 v84, v187, v63
  v_dot2c_f32_bf16 v85, v191, v67
  s_nop 2
  v_add_f32 v80, v80, v81
  v_add_f32 v83, v83, v84
  v_add_f32 v80, v80, v82
  v_add_f32 v83, v83, v85
  s_nop 0
  v_add_f32_dpp v80, v80, v80 quad_perm:[1,0,3,2] row_mask:0xf bank_mask:0xf
  v_add_f32_dpp v83, v83, v83 quad_perm:[1,0,3,2] row_mask:0xf bank_mask:0xf
  s_nop 0
  v_add_f32_dpp v80, v80, v80 quad_perm:[2,3,0,1] row_mask:0xf bank_mask:0xf
  v_add_f32_dpp v83, v83, v83 quad_perm:[2,3,0,1] row_mask:0xf bank_mask:0xf
  s_nop 0
  v_add_f32_dpp v80, v80, v80 row_half_mirror row_mask:0xf bank_mask:0xf
  v_add_f32_dpp v83, v83, v83 row_half_mirror row_mask:0xf bank_mask:0xf
  s_nop 0
  v_cvt_pk_bf16_f32 v80, v80, v80
  v_cvt_pk_bf16_f32 v83, v83, v83
  v_lshlrev_b32 v80, 16, v80
  v_lshlrev_b32 v83, 16, v83
  v_mul_f32 v80, s49, v80
  v_mul_f32 v83, s49, v83
  v_cvt_pk_bf16_f32 v43, v80, v83
  global_load_dwordx4 v[168:171], v5, s[38:39] offset:0 nt
  global_load_dwordx4 v[172:175], v5, s[38:39] offset:128 nt
  global_load_dwordx4 v[176:179], v5, s[38:39] offset:256 nt
  global_load_dwordx4 v[180:183], v5, s[38:39] offset:3072 nt
  global_load_dwordx4 v[184:187], v5, s[38:39] offset:3200 nt
  global_load_dwordx4 v[188:191], v5, s[38:39] offset:3328 nt
  s_add_u32 s38, s38, 6144
  s_addc_u32 s39, s39, 0
  s_waitcnt vmcnt(30)
  v_dot2_f32_bf16 v80, v96, v56, 0
  v_dot2_f32_bf16 v81, v100, v60, 0
  v_dot2_f32_bf16 v82, v104, v64, 0
  v_dot2_f32_bf16 v83, v108, v56, 0
  v_dot2_f32_bf16 v84, v112, v60, 0
  v_dot2_f32_bf16 v85, v116, v64, 0
  v_dot2c_f32_bf16 v80, v97, v57
  v_dot2c_f32_bf16 v81, v101, v61
  v_dot2c_f32_bf16 v82, v105, v65
  v_dot2c_f32_bf16 v83, v109, v57
  v_dot2c_f32_bf16 v84, v113, v61
  v_dot2c_f32_bf16 v85, v117, v65
  v_dot2c_f32_bf16 v80, v98, v58
  v_dot2c_f32_bf16 v81, v102, v62
  v_dot2c_f32_bf16 v82, v106, v66
  v_dot2c_f32_bf16 v83, v110, v58
  v_dot2c_f32_bf16 v84, v114, v62
  v_dot2c_f32_bf16 v85, v118, v66
  v_dot2c_f32_bf16 v80, v99, v59
  v_dot2c_f32_bf16 v81, v103, v63
  v_dot2c_f32_bf16 v82, v107, v67
  v_dot2c_f32_bf16 v83, v111, v59
  v_dot2c_f32_bf16 v84, v115, v63
  v_dot2c_f32_bf16 v85, v119, v67
  s_nop 2
  v_add_f32 v80, v80, v81
  v_add_f32 v83, v83, v84
  v_add_f32 v80, v80, v82
  v_add_f32 v83, v83, v85
  s_nop 0
  v_add_f32_dpp v80, v80, v80 quad_perm:[1,0,3,2] row_mask:0xf bank_mask:0xf
  v_add_f32_dpp v83, v83, v83 quad_perm:[1,0,3,2] row_mask:0xf bank_mask:0xf
  s_nop 0
  v_add_f32_dpp v80, v80, v80 quad_perm:[2,3,0,1] row_mask:0xf bank_mask:0xf
  v_add_f32_dpp v83, v83, v83 quad_perm:[2,3,0,1] row_mask:0xf bank_mask:0xf
  s_nop 0
  v_add_f32_dpp v80, v80, v80 row_half_mirror row_mask:0xf bank_mask:0xf
  v_add_f32_dpp v83, v83, v83 row_half_mirror row_mask:0xf bank_mask:0xf
  s_nop 0
  v_cvt_pk_bf16_f32 v80, v80, v80
  v_cvt_pk_bf16_f32 v83, v83, v83
  v_lshlrev_b32 v80, 16, v80
  v_lshlrev_b32 v83, 16, v83
  v_mul_f32 v80, s49, v80
  v_mul_f32 v83, s49, v83
  v_cvt_pk_bf16_f32 v44, v80, v83
  global_load_dwordx4 v[96:99], v5, s[38:39] offset:0 nt
  global_load_dwordx4 v[100:103], v5, s[38:39] offset:128 nt
  global_load_dwordx4 v[104:107], v5, s[38:39] offset:256 nt
  global_load_dwordx4 v[108:111], v5, s[38:39] offset:3072 nt
  global_load_dwordx4 v[112:115], v5, s[38:39] offset:3200 nt
  global_load_dwordx4 v[116:119], v5, s[38:39] offset:3328 nt
  s_add_u32 s38, s38, 6144
  s_addc_u32 s39, s39, 0
  s_waitcnt vmcnt(30)
  v_dot2_f32_bf16 v80, v120, v56, 0
  v_dot2_f32_bf16 v81, v124, v60, 0
  v_dot2_f32_bf16 v82, v128, v64, 0
  v_dot2_f32_bf16 v83, v132, v56, 0
  v_dot2_f32_bf16 v84, v136, v60, 0
  v_dot2_f32_bf16 v85, v140, v64, 0
  v_dot2c_f32_bf16 v80, v121, v57
  v_dot2c_f32_bf16 v81, v125, v61
  v_dot2c_f32_bf16 v82, v129, v65
  v_dot2c_f32_bf16 v83, v133, v57
  v_dot2c_f32_bf16 v84, v137, v61
  v_dot2c_f32_bf16 v85, v141, v65
  v_dot2c_f32_bf16 v80, v122, v58
  v_dot2c_f32_bf16 v81, v126, v62
  v_dot2c_f32_bf16 v82, v130, v66
  v_dot2c_f32_bf16 v83, v134, v58
  v_dot2c_f32_bf16 v84, v138, v62
  v_dot2c_f32_bf16 v85, v142, v66
  v_dot2c_f32_bf16 v80, v123, v59
  v_dot2c_f32_bf16 v81, v127, v63
  v_dot2c_f32_bf16 v82, v131, v67
  v_dot2c_f32_bf16 v83, v135, v59
  v_dot2c_f32_bf16 v84, v139, v63
  v_dot2c_f32_bf16 v85, v143, v67
  s_nop 2
  v_add_f32 v80, v80, v81
  v_add_f32 v83, v83, v84
  v_add_f32 v80, v80, v82
  v_add_f32 v83, v83, v85
  s_nop 0
  v_add_f32_dpp v80, v80, v80 quad_perm:[1,0,3,2] row_mask:0xf bank_mask:0xf
  v_add_f32_dpp v83, v83, v83 quad_perm:[1,0,3,2] row_mask:0xf bank_mask:0xf
  s_nop 0
  v_add_f32_dpp v80, v80, v80 quad_perm:[2,3,0,1] row_mask:0xf bank_mask:0xf
  v_add_f32_dpp v83, v83, v83 quad_perm:[2,3,0,1] row_mask:0xf bank_mask:0xf
  s_nop 0
  v_add_f32_dpp v80, v80, v80 row_half_mirror row_mask:0xf bank_mask:0xf
  v_add_f32_dpp v83, v83, v83 row_half_mirror row_mask:0xf bank_mask:0xf
  s_nop 0
  v_cvt_pk_bf16_f32 v80, v80, v80
  v_cvt_pk_bf16_f32 v83, v83, v83
  v_lshlrev_b32 v80, 16, v80
  v_lshlrev_b32 v83, 16, v83
  v_mul_f32 v80, s49, v80
  v_mul_f32 v83, s49, v83
  v_cvt_pk_bf16_f32 v45, v80, v83
  global_load_dwordx4 v[120:123], v5, s[38:39] offset:0 nt
  global_load_dwordx4 v[124:127], v5, s[38:39] offset:128 nt
  global_load_dwordx4 v[128:131], v5, s[38:39] offset:256 nt
  global_load_dwordx4 v[132:135], v5, s[38:39] offset:3072 nt
  global_load_dwordx4 v[136:139], v5, s[38:39] offset:3200 nt
  global_load_dwordx4 v[140:143], v5, s[38:39] offset:3328 nt
  s_add_u32 s38, s38, 6144
  s_addc_u32 s39, s39, 0
  s_waitcnt vmcnt(30)
  v_dot2_f32_bf16 v80, v192, v56, 0
  v_dot2_f32_bf16 v81, v196, v60, 0
  v_dot2_f32_bf16 v82, v200, v64, 0
  v_dot2_f32_bf16 v83, v204, v56, 0
  v_dot2_f32_bf16 v84, v208, v60, 0
  v_dot2_f32_bf16 v85, v212, v64, 0
  v_dot2c_f32_bf16 v80, v193, v57
  v_dot2c_f32_bf16 v81, v197, v61
  v_dot2c_f32_bf16 v82, v201, v65
  v_dot2c_f32_bf16 v83, v205, v57
  v_dot2c_f32_bf16 v84, v209, v61
  v_dot2c_f32_bf16 v85, v213, v65
  v_dot2c_f32_bf16 v80, v194, v58
  v_dot2c_f32_bf16 v81, v198, v62
  v_dot2c_f32_bf16 v82, v202, v66
  v_dot2c_f32_bf16 v83, v206, v58
  v_dot2c_f32_bf16 v84, v210, v62
  v_dot2c_f32_bf16 v85, v214, v66
  v_dot2c_f32_bf16 v80, v195, v59
  v_dot2c_f32_bf16 v81, v199, v63
  v_dot2c_f32_bf16 v82, v203, v67
  v_dot2c_f32_bf16 v83, v207, v59
  v_dot2c_f32_bf16 v84, v211, v63
  v_dot2c_f32_bf16 v85, v215, v67
  s_nop 2
  v_add_f32 v80, v80, v81
  v_add_f32 v83, v83, v84
  v_add_f32 v80, v80, v82
  v_add_f32 v83, v83, v85
  s_nop 0
  v_add_f32_dpp v80, v80, v80 quad_perm:[1,0,3,2] row_mask:0xf bank_mask:0xf
  v_add_f32_dpp v83, v83, v83 quad_perm:[1,0,3,2] row_mask:0xf bank_mask:0xf
  s_nop 0
  v_add_f32_dpp v80, v80, v80 quad_perm:[2,3,0,1] row_mask:0xf bank_mask:0xf
  v_add_f32_dpp v83, v83, v83 quad_perm:[2,3,0,1] row_mask:0xf bank_mask:0xf
  s_nop 0
  v_add_f32_dpp v80, v80, v80 row_half_mirror row_mask:0xf bank_mask:0xf
  v_add_f32_dpp v83, v83, v83 row_half_mirror row_mask:0xf bank_mask:0xf
  s_nop 0
  v_cvt_pk_bf16_f32 v80, v80, v80
  v_cvt_pk_bf16_f32 v83, v83, v83
  v_lshlrev_b32 v80, 16, v80
  v_lshlrev_b32 v83, 16, v83
  v_mul_f32 v80, s49, v80
  v_mul_f32 v83, s49, v83
  v_cvt_pk_bf16_f32 v46, v80, v83
  global_load_dwordx4 v[192:195], v5, s[38:39] offset:0 nt
  global_load_dwordx4 v[196:199], v5, s[38:39] offset:128 nt
  global_load_dwordx4 v[200:203], v5, s[38:39] offset:256 nt
  global_load_dwordx4 v[204:207], v5, s[38:39] offset:3072 nt
  global_load_dwordx4 v[208:211], v5, s[38:39] offset:3200 nt
  global_load_dwordx4 v[212:215], v5, s[38:39] offset:3328 nt
  s_add_u32 s38, s38, 6144
  s_addc_u32 s39, s39, 0
  s_waitcnt vmcnt(30)
  v_dot2_f32_bf16 v80, v216, v56, 0
  v_dot2_f32_bf16 v81, v220, v60, 0
  v_dot2_f32_bf16 v82, v224, v64, 0
  v_dot2_f32_bf16 v83, v228, v56, 0
  v_dot2_f32_bf16 v84, v232, v60, 0
  v_dot2_f32_bf16 v85, v236, v64, 0
  v_dot2c_f32_bf16 v80, v217, v57
  v_dot2c_f32_bf16 v81, v221, v61
  v_dot2c_f32_bf16 v82, v225, v65
  v_dot2c_f32_bf16 v83, v229, v57
  v_dot2c_f32_bf16 v84, v233, v61
  v_dot2c_f32_bf16 v85, v237, v65
  v_dot2c_f32_bf16 v80, v218, v58
  v_dot2c_f32_bf16 v81, v222, v62
  v_dot2c_f32_bf16 v82, v226, v66
  v_dot2c_f32_bf16 v83, v230, v58
  v_dot2c_f32_bf16 v84, v234, v62
  v_dot2c_f32_bf16 v85, v238, v66
  v_dot2c_f32_bf16 v80, v219, v59
  v_dot2c_f32_bf16 v81, v223, v63
  v_dot2c_f32_bf16 v82, v227, v67
  v_dot2c_f32_bf16 v83, v231, v59
  v_dot2c_f32_bf16 v84, v235, v63
  v_dot2c_f32_bf16 v85, v239, v67
  s_nop 2
  v_add_f32 v80, v80, v81
  v_add_f32 v83, v83, v84
  v_add_f32 v80, v80, v82
  v_add_f32 v83, v83, v85
  s_nop 0
  v_add_f32_dpp v80, v80, v80 quad_perm:[1,0,3,2] row_mask:0xf bank_mask:0xf
  v_add_f32_dpp v83, v83, v83 quad_perm:[1,0,3,2] row_mask:0xf bank_mask:0xf
  s_nop 0
  v_add_f32_dpp v80, v80, v80 quad_perm:[2,3,0,1] row_mask:0xf bank_mask:0xf
  v_add_f32_dpp v83, v83, v83 quad_perm:[2,3,0,1] row_mask:0xf bank_mask:0xf
  s_nop 0
  v_add_f32_dpp v80, v80, v80 row_half_mirror row_mask:0xf bank_mask:0xf
  v_add_f32_dpp v83, v83, v83 row_half_mirror row_mask:0xf bank_mask:0xf
  s_nop 0
  v_cvt_pk_bf16_f32 v80, v80, v80
  v_cvt_pk_bf16_f32 v83, v83, v83
  v_lshlrev_b32 v80, 16, v80
  v_lshlrev_b32 v83, 16, v83
  v_mul_f32 v80, s49, v80
  v_mul_f32 v83, s49, v83
  v_cvt_pk_bf16_f32 v47, v80, v83
  global_load_dwordx4 v[216:219], v5, s[38:39] offset:0 nt
  global_load_dwordx4 v[220:223], v5, s[38:39] offset:128 nt
  global_load_dwordx4 v[224:227], v5, s[38:39] offset:256 nt
  global_load_dwordx4 v[228:231], v5, s[38:39] offset:3072 nt
  global_load_dwordx4 v[232:235], v5, s[38:39] offset:3200 nt
  global_load_dwordx4 v[236:239], v5, s[38:39] offset:3328 nt
  s_add_u32 s38, s38, 6144
  s_addc_u32 s39, s39, 0
  s_waitcnt vmcnt(30)
  v_dot2_f32_bf16 v80, v144, v56, 0
  v_dot2_f32_bf16 v81, v148, v60, 0
  v_dot2_f32_bf16 v82, v152, v64, 0
  v_dot2_f32_bf16 v83, v156, v56, 0
  v_dot2_f32_bf16 v84, v160, v60, 0
  v_dot2_f32_bf16 v85, v164, v64, 0
  v_dot2c_f32_bf16 v80, v145, v57
  v_dot2c_f32_bf16 v81, v149, v61
  v_dot2c_f32_bf16 v82, v153, v65
  v_dot2c_f32_bf16 v83, v157, v57
  v_dot2c_f32_bf16 v84, v161, v61
  v_dot2c_f32_bf16 v85, v165, v65
  v_dot2c_f32_bf16 v80, v146, v58
  v_dot2c_f32_bf16 v81, v150, v62
  v_dot2c_f32_bf16 v82, v154, v66
  v_dot2c_f32_bf16 v83, v158, v58
  v_dot2c_f32_bf16 v84, v162, v62
  v_dot2c_f32_bf16 v85, v166, v66
  v_dot2c_f32_bf16 v80, v147, v59
  v_dot2c_f32_bf16 v81, v151, v63
  v_dot2c_f32_bf16 v82, v155, v67
  v_dot2c_f32_bf16 v83, v159, v59
  v_dot2c_f32_bf16 v84, v163, v63
  v_dot2c_f32_bf16 v85, v167, v67
  s_nop 2
  v_add_f32 v80, v80, v81
  v_add_f32 v83, v83, v84
  v_add_f32 v80, v80, v82
  v_add_f32 v83, v83, v85
  s_nop 0
  v_add_f32_dpp v80, v80, v80 quad_perm:[1,0,3,2] row_mask:0xf bank_mask:0xf
  v_add_f32_dpp v83, v83, v83 quad_perm:[1,0,3,2] row_mask:0xf bank_mask:0xf
  s_nop 0
  v_add_f32_dpp v80, v80, v80 quad_perm:[2,3,0,1] row_mask:0xf bank_mask:0xf
  v_add_f32_dpp v83, v83, v83 quad_perm:[2,3,0,1] row_mask:0xf bank_mask:0xf
  s_nop 0
  v_add_f32_dpp v80, v80, v80 row_half_mirror row_mask:0xf bank_mask:0xf
  v_add_f32_dpp v83, v83, v83 row_half_mirror row_mask:0xf bank_mask:0xf
  s_nop 0
  v_cvt_pk_bf16_f32 v80, v80, v80
  v_cvt_pk_bf16_f32 v83, v83, v83
  v_lshlrev_b32 v80, 16, v80
  v_lshlrev_b32 v83, 16, v83
  v_mul_f32 v80, s49, v80
  v_mul_f32 v83, s49, v83
  v_cvt_pk_bf16_f32 v48, v80, v83
  global_load_dwordx4 v[144:147], v5, s[38:39] offset:0 nt
  global_load_dwordx4 v[148:151], v5, s[38:39] offset:128 nt
  global_load_dwordx4 v[152:155], v5, s[38:39] offset:256 nt
  global_load_dwordx4 v[156:159], v5, s[38:39] offset:3072 nt
  global_load_dwordx4 v[160:163], v5, s[38:39] offset:3200 nt
  global_load_dwordx4 v[164:167], v5, s[38:39] offset:3328 nt
  s_add_u32 s38, s38, 6144
  s_addc_u32 s39, s39, 0
  s_waitcnt vmcnt(30)
  v_dot2_f32_bf16 v80, v168, v56, 0
  v_dot2_f32_bf16 v81, v172, v60, 0
  v_dot2_f32_bf16 v82, v176, v64, 0
  v_dot2_f32_bf16 v83, v180, v56, 0
  v_dot2_f32_bf16 v84, v184, v60, 0
  v_dot2_f32_bf16 v85, v188, v64, 0
  v_dot2c_f32_bf16 v80, v169, v57
  v_dot2c_f32_bf16 v81, v173, v61
  v_dot2c_f32_bf16 v82, v177, v65
  v_dot2c_f32_bf16 v83, v181, v57
  v_dot2c_f32_bf16 v84, v185, v61
  v_dot2c_f32_bf16 v85, v189, v65
  v_dot2c_f32_bf16 v80, v170, v58
  v_dot2c_f32_bf16 v81, v174, v62
  v_dot2c_f32_bf16 v82, v178, v66
  v_dot2c_f32_bf16 v83, v182, v58
  v_dot2c_f32_bf16 v84, v186, v62
  v_dot2c_f32_bf16 v85, v190, v66
  v_dot2c_f32_bf16 v80, v171, v59
  v_dot2c_f32_bf16 v81, v175, v63
  v_dot2c_f32_bf16 v82, v179, v67
  v_dot2c_f32_bf16 v83, v183, v59
  v_dot2c_f32_bf16 v84, v187, v63
  v_dot2c_f32_bf16 v85, v191, v67
  s_nop 2
  v_add_f32 v80, v80, v81
  v_add_f32 v83, v83, v84
  v_add_f32 v80, v80, v82
  v_add_f32 v83, v83, v85
  s_nop 0
  v_add_f32_dpp v80, v80, v80 quad_perm:[1,0,3,2] row_mask:0xf bank_mask:0xf
  v_add_f32_dpp v83, v83, v83 quad_perm:[1,0,3,2] row_mask:0xf bank_mask:0xf
  s_nop 0
  v_add_f32_dpp v80, v80, v80 quad_perm:[2,3,0,1] row_mask:0xf bank_mask:0xf
  v_add_f32_dpp v83, v83, v83 quad_perm:[2,3,0,1] row_mask:0xf bank_mask:0xf
  s_nop 0
  v_add_f32_dpp v80, v80, v80 row_half_mirror row_mask:0xf bank_mask:0xf
  v_add_f32_dpp v83, v83, v83 row_half_mirror row_mask:0xf bank_mask:0xf
  s_nop 0
  v_cvt_pk_bf16_f32 v80, v80, v80
  v_cvt_pk_bf16_f32 v83, v83, v83
  v_lshlrev_b32 v80, 16, v80
  v_lshlrev_b32 v83, 16, v83
  v_mul_f32 v80, s49, v80
  v_mul_f32 v83, s49, v83
  v_cvt_pk_bf16_f32 v49, v80, v83
  global_load_dwordx4 v[168:171], v5, s[38:39] offset:0 nt
  global_load_dwordx4 v[172:175], v5, s[38:39] offset:128 nt
  global_load_dwordx4 v[176:179], v5, s[38:39] offset:256 nt
  global_load_dwordx4 v[180:183], v5, s[38:39] offset:3072 nt
  global_load_dwordx4 v[184:187], v5, s[38:39] offset:3200 nt
  global_load_dwordx4 v[188:191], v5, s[38:39] offset:3328 nt
  s_add_u32 s38, s38, 6144
  s_addc_u32 s39, s39, 0
  s_waitcnt vmcnt(30)
  v_dot2_f32_bf16 v80, v96, v56, 0
  v_dot2_f32_bf16 v81, v100, v60, 0
  v_dot2_f32_bf16 v82, v104, v64, 0
  v_dot2_f32_bf16 v83, v108, v56, 0
  v_dot2_f32_bf16 v84, v112, v60, 0
  v_dot2_f32_bf16 v85, v116, v64, 0
  v_dot2c_f32_bf16 v80, v97, v57
  v_dot2c_f32_bf16 v81, v101, v61
  v_dot2c_f32_bf16 v82, v105, v65
  v_dot2c_f32_bf16 v83, v109, v57
  v_dot2c_f32_bf16 v84, v113, v61
  v_dot2c_f32_bf16 v85, v117, v65
  v_dot2c_f32_bf16 v80, v98, v58
  v_dot2c_f32_bf16 v81, v102, v62
  v_dot2c_f32_bf16 v82, v106, v66
  v_dot2c_f32_bf16 v83, v110, v58
  v_dot2c_f32_bf16 v84, v114, v62
  v_dot2c_f32_bf16 v85, v118, v66
  v_dot2c_f32_bf16 v80, v99, v59
  v_dot2c_f32_bf16 v81, v103, v63
  v_dot2c_f32_bf16 v82, v107, v67
  v_dot2c_f32_bf16 v83, v111, v59
  v_dot2c_f32_bf16 v84, v115, v63
  v_dot2c_f32_bf16 v85, v119, v67
  s_nop 2
  v_add_f32 v80, v80, v81
  v_add_f32 v83, v83, v84
  v_add_f32 v80, v80, v82
  v_add_f32 v83, v83, v85
  s_nop 0
  v_add_f32_dpp v80, v80, v80 quad_perm:[1,0,3,2] row_mask:0xf bank_mask:0xf
  v_add_f32_dpp v83, v83, v83 quad_perm:[1,0,3,2] row_mask:0xf bank_mask:0xf
  s_nop 0
  v_add_f32_dpp v80, v80, v80 quad_perm:[2,3,0,1] row_mask:0xf bank_mask:0xf
  v_add_f32_dpp v83, v83, v83 quad_perm:[2,3,0,1] row_mask:0xf bank_mask:0xf
  s_nop 0
  v_add_f32_dpp v80, v80, v80 row_half_mirror row_mask:0xf bank_mask:0xf
  v_add_f32_dpp v83, v83, v83 row_half_mirror row_mask:0xf bank_mask:0xf
  s_nop 0
  v_cvt_pk_bf16_f32 v80, v80, v80
  v_cvt_pk_bf16_f32 v83, v83, v83
  v_lshlrev_b32 v80, 16, v80
  v_lshlrev_b32 v83, 16, v83
  v_mul_f32 v80, s49, v80
  v_mul_f32 v83, s49, v83
  v_cvt_pk_bf16_f32 v50, v80, v83
  global_load_dwordx4 v[96:99], v5, s[40:41] offset:0 nt
  global_load_dwordx4 v[100:103], v5, s[40:41] offset:128 nt
  global_load_dwordx4 v[104:107], v5, s[40:41] offset:256 nt
  global_load_dwordx4 v[108:111], v5, s[40:41] offset:3072 nt
  global_load_dwordx4 v[112:115], v5, s[40:41] offset:3200 nt
  global_load_dwordx4 v[116:119], v5, s[40:41] offset:3328 nt
  s_add_u32 s40, s40, 6144
  s_addc_u32 s41, s41, 0
  s_waitcnt vmcnt(30)
  v_dot2_f32_bf16 v80, v120, v56, 0
  v_dot2_f32_bf16 v81, v124, v60, 0
  v_dot2_f32_bf16 v82, v128, v64, 0
  v_dot2_f32_bf16 v83, v132, v56, 0
  v_dot2_f32_bf16 v84, v136, v60, 0
  v_dot2_f32_bf16 v85, v140, v64, 0
  v_dot2c_f32_bf16 v80, v121, v57
  v_dot2c_f32_bf16 v81, v125, v61
  v_dot2c_f32_bf16 v82, v129, v65
  v_dot2c_f32_bf16 v83, v133, v57
  v_dot2c_f32_bf16 v84, v137, v61
  v_dot2c_f32_bf16 v85, v141, v65
  v_dot2c_f32_bf16 v80, v122, v58
  v_dot2c_f32_bf16 v81, v126, v62
  v_dot2c_f32_bf16 v82, v130, v66
  v_dot2c_f32_bf16 v83, v134, v58
  v_dot2c_f32_bf16 v84, v138, v62
  v_dot2c_f32_bf16 v85, v142, v66
  v_dot2c_f32_bf16 v80, v123, v59
  v_dot2c_f32_bf16 v81, v127, v63
  v_dot2c_f32_bf16 v82, v131, v67
  v_dot2c_f32_bf16 v83, v135, v59
  v_dot2c_f32_bf16 v84, v139, v63
  v_dot2c_f32_bf16 v85, v143, v67
  s_nop 2
  v_add_f32 v80, v80, v81
  v_add_f32 v83, v83, v84
  v_add_f32 v80, v80, v82
  v_add_f32 v83, v83, v85
  s_nop 0
  v_add_f32_dpp v80, v80, v80 quad_perm:[1,0,3,2] row_mask:0xf bank_mask:0xf
  v_add_f32_dpp v83, v83, v83 quad_perm:[1,0,3,2] row_mask:0xf bank_mask:0xf
  s_nop 0
  v_add_f32_dpp v80, v80, v80 quad_perm:[2,3,0,1] row_mask:0xf bank_mask:0xf
  v_add_f32_dpp v83, v83, v83 quad_perm:[2,3,0,1] row_mask:0xf bank_mask:0xf
  s_nop 0
  v_add_f32_dpp v80, v80, v80 row_half_mirror row_mask:0xf bank_mask:0xf
  v_add_f32_dpp v83, v83, v83 row_half_mirror row_mask:0xf bank_mask:0xf
  s_nop 0
  v_cvt_pk_bf16_f32 v80, v80, v80
  v_cvt_pk_bf16_f32 v83, v83, v83
  v_lshlrev_b32 v80, 16, v80
  v_lshlrev_b32 v83, 16, v83
  v_mul_f32 v80, s49, v80
  v_mul_f32 v83, s49, v83
  v_cvt_pk_bf16_f32 v51, v80, v83
  global_load_dwordx4 v[120:123], v5, s[40:41] offset:0 nt
  global_load_dwordx4 v[124:127], v5, s[40:41] offset:128 nt
  global_load_dwordx4 v[128:131], v5, s[40:41] offset:256 nt
  global_load_dwordx4 v[132:135], v5, s[40:41] offset:3072 nt
  global_load_dwordx4 v[136:139], v5, s[40:41] offset:3200 nt
  global_load_dwordx4 v[140:143], v5, s[40:41] offset:3328 nt
  s_add_u32 s40, s40, 6144
  s_addc_u32 s41, s41, 0
  s_waitcnt vmcnt(30)
  v_dot2_f32_bf16 v80, v192, v56, 0
  v_dot2_f32_bf16 v81, v196, v60, 0
  v_dot2_f32_bf16 v82, v200, v64, 0
  v_dot2_f32_bf16 v83, v204, v56, 0
  v_dot2_f32_bf16 v84, v208, v60, 0
  v_dot2_f32_bf16 v85, v212, v64, 0
  v_dot2c_f32_bf16 v80, v193, v57
  v_dot2c_f32_bf16 v81, v197, v61
  v_dot2c_f32_bf16 v82, v201, v65
  v_dot2c_f32_bf16 v83, v205, v57
  v_dot2c_f32_bf16 v84, v209, v61
  v_dot2c_f32_bf16 v85, v213, v65
  v_dot2c_f32_bf16 v80, v194, v58
  v_dot2c_f32_bf16 v81, v198, v62
  v_dot2c_f32_bf16 v82, v202, v66
  v_dot2c_f32_bf16 v83, v206, v58
  v_dot2c_f32_bf16 v84, v210, v62
  v_dot2c_f32_bf16 v85, v214, v66
  v_dot2c_f32_bf16 v80, v195, v59
  v_dot2c_f32_bf16 v81, v199, v63
  v_dot2c_f32_bf16 v82, v203, v67
  v_dot2c_f32_bf16 v83, v207, v59
  v_dot2c_f32_bf16 v84, v211, v63
  v_dot2c_f32_bf16 v85, v215, v67
  s_nop 2
  v_add_f32 v80, v80, v81
  v_add_f32 v83, v83, v84
  v_add_f32 v80, v80, v82
  v_add_f32 v83, v83, v85
  s_nop 0
  v_add_f32_dpp v80, v80, v80 quad_perm:[1,0,3,2] row_mask:0xf bank_mask:0xf
  v_add_f32_dpp v83, v83, v83 quad_perm:[1,0,3,2] row_mask:0xf bank_mask:0xf
  s_nop 0
  v_add_f32_dpp v80, v80, v80 quad_perm:[2,3,0,1] row_mask:0xf bank_mask:0xf
  v_add_f32_dpp v83, v83, v83 quad_perm:[2,3,0,1] row_mask:0xf bank_mask:0xf
  s_nop 0
  v_add_f32_dpp v80, v80, v80 row_half_mirror row_mask:0xf bank_mask:0xf
  v_add_f32_dpp v83, v83, v83 row_half_mirror row_mask:0xf bank_mask:0xf
  s_nop 0
  v_cvt_pk_bf16_f32 v80, v80, v80
  v_cvt_pk_bf16_f32 v83, v83, v83
  v_lshlrev_b32 v80, 16, v80
  v_lshlrev_b32 v83, 16, v83
  v_mul_f32 v80, s49, v80
  v_mul_f32 v83, s49, v83
  v_cvt_pk_bf16_f32 v52, v80, v83
  global_load_dwordx4 v[192:195], v5, s[40:41] offset:0 nt
  global_load_dwordx4 v[196:199], v5, s[40:41] offset:128 nt
  global_load_dwordx4 v[200:203], v5, s[40:41] offset:256 nt
  global_load_dwordx4 v[204:207], v5, s[40:41] offset:3072 nt
  global_load_dwordx4 v[208:211], v5, s[40:41] offset:3200 nt
  global_load_dwordx4 v[212:215], v5, s[40:41] offset:3328 nt
  s_add_u32 s40, s40, 6144
  s_addc_u32 s41, s41, 0
  s_waitcnt vmcnt(30)
  v_dot2_f32_bf16 v80, v216, v56, 0
  v_dot2_f32_bf16 v81, v220, v60, 0
  v_dot2_f32_bf16 v82, v224, v64, 0
  v_dot2_f32_bf16 v83, v228, v56, 0
  v_dot2_f32_bf16 v84, v232, v60, 0
  v_dot2_f32_bf16 v85, v236, v64, 0
  v_dot2c_f32_bf16 v80, v217, v57
  v_dot2c_f32_bf16 v81, v221, v61
  v_dot2c_f32_bf16 v82, v225, v65
  v_dot2c_f32_bf16 v83, v229, v57
  v_dot2c_f32_bf16 v84, v233, v61
  v_dot2c_f32_bf16 v85, v237, v65
  v_dot2c_f32_bf16 v80, v218, v58
  v_dot2c_f32_bf16 v81, v222, v62
  v_dot2c_f32_bf16 v82, v226, v66
  v_dot2c_f32_bf16 v83, v230, v58
  v_dot2c_f32_bf16 v84, v234, v62
  v_dot2c_f32_bf16 v85, v238, v66
  v_dot2c_f32_bf16 v80, v219, v59
  v_dot2c_f32_bf16 v81, v223, v63
  v_dot2c_f32_bf16 v82, v227, v67
  v_dot2c_f32_bf16 v83, v231, v59
  v_dot2c_f32_bf16 v84, v235, v63
  v_dot2c_f32_bf16 v85, v239, v67
  s_nop 2
  v_add_f32 v80, v80, v81
  v_add_f32 v83, v83, v84
  v_add_f32 v80, v80, v82
  v_add_f32 v83, v83, v85
  s_nop 0
  v_add_f32_dpp v80, v80, v80 quad_perm:[1,0,3,2] row_mask:0xf bank_mask:0xf
  v_add_f32_dpp v83, v83, v83 quad_perm:[1,0,3,2] row_mask:0xf bank_mask:0xf
  s_nop 0
  v_add_f32_dpp v80, v80, v80 quad_perm:[2,3,0,1] row_mask:0xf bank_mask:0xf
  v_add_f32_dpp v83, v83, v83 quad_perm:[2,3,0,1] row_mask:0xf bank_mask:0xf
  s_nop 0
  v_add_f32_dpp v80, v80, v80 row_half_mirror row_mask:0xf bank_mask:0xf
  v_add_f32_dpp v83, v83, v83 row_half_mirror row_mask:0xf bank_mask:0xf
  s_nop 0
  v_cvt_pk_bf16_f32 v80, v80, v80
  v_cvt_pk_bf16_f32 v83, v83, v83
  v_lshlrev_b32 v80, 16, v80
  v_lshlrev_b32 v83, 16, v83
  v_mul_f32 v80, s49, v80
  v_mul_f32 v83, s49, v83
  v_cvt_pk_bf16_f32 v53, v80, v83
  global_load_dwordx4 v[216:219], v5, s[40:41] offset:0 nt
  global_load_dwordx4 v[220:223], v5, s[40:41] offset:128 nt
  global_load_dwordx4 v[224:227], v5, s[40:41] offset:256 nt
  global_load_dwordx4 v[228:231], v5, s[40:41] offset:3072 nt
  global_load_dwordx4 v[232:235], v5, s[40:41] offset:3200 nt
  global_load_dwordx4 v[236:239], v5, s[40:41] offset:3328 nt
  s_add_u32 s40, s40, 6144
  s_addc_u32 s41, s41, 0
  s_waitcnt vmcnt(30)
  v_dot2_f32_bf16 v80, v144, v56, 0
  v_dot2_f32_bf16 v81, v148, v60, 0
  v_dot2_f32_bf16 v82, v152, v64, 0
  v_dot2_f32_bf16 v83, v156, v56, 0
  v_dot2_f32_bf16 v84, v160, v60, 0
  v_dot2_f32_bf16 v85, v164, v64, 0
  v_dot2c_f32_bf16 v80, v145, v57
  v_dot2c_f32_bf16 v81, v149, v61
  v_dot2c_f32_bf16 v82, v153, v65
  v_dot2c_f32_bf16 v83, v157, v57
  v_dot2c_f32_bf16 v84, v161, v61
  v_dot2c_f32_bf16 v85, v165, v65
  v_dot2c_f32_bf16 v80, v146, v58
  v_dot2c_f32_bf16 v81, v150, v62
  v_dot2c_f32_bf16 v82, v154, v66
  v_dot2c_f32_bf16 v83, v158, v58
  v_dot2c_f32_bf16 v84, v162, v62
  v_dot2c_f32_bf16 v85, v166, v66
  v_dot2c_f32_bf16 v80, v147, v59
  v_dot2c_f32_bf16 v81, v151, v63
  v_dot2c_f32_bf16 v82, v155, v67
  v_dot2c_f32_bf16 v83, v159, v59
  v_dot2c_f32_bf16 v84, v163, v63
  v_dot2c_f32_bf16 v85, v167, v67
  s_nop 2
  v_add_f32 v80, v80, v81
  v_add_f32 v83, v83, v84
  v_add_f32 v80, v80, v82
  v_add_f32 v83, v83, v85
  s_nop 0
  v_add_f32_dpp v80, v80, v80 quad_perm:[1,0,3,2] row_mask:0xf bank_mask:0xf
  v_add_f32_dpp v83, v83, v83 quad_perm:[1,0,3,2] row_mask:0xf bank_mask:0xf
  s_nop 0
  v_add_f32_dpp v80, v80, v80 quad_perm:[2,3,0,1] row_mask:0xf bank_mask:0xf
  v_add_f32_dpp v83, v83, v83 quad_perm:[2,3,0,1] row_mask:0xf bank_mask:0xf
  s_nop 0
  v_add_f32_dpp v80, v80, v80 row_half_mirror row_mask:0xf bank_mask:0xf
  v_add_f32_dpp v83, v83, v83 row_half_mirror row_mask:0xf bank_mask:0xf
  s_nop 0
  v_cvt_pk_bf16_f32 v80, v80, v80
  v_cvt_pk_bf16_f32 v83, v83, v83
  v_lshlrev_b32 v80, 16, v80
  v_lshlrev_b32 v83, 16, v83
  v_mul_f32 v80, s49, v80
  v_mul_f32 v83, s49, v83
  v_cvt_pk_bf16_f32 v54, v80, v83
  global_load_dwordx4 v[144:147], v5, s[40:41] offset:0 nt
  global_load_dwordx4 v[148:151], v5, s[40:41] offset:128 nt
  global_load_dwordx4 v[152:155], v5, s[40:41] offset:256 nt
  global_load_dwordx4 v[156:159], v5, s[40:41] offset:3072 nt
  global_load_dwordx4 v[160:163], v5, s[40:41] offset:3200 nt
  global_load_dwordx4 v[164:167], v5, s[40:41] offset:3328 nt
  s_add_u32 s40, s40, 6144
  s_addc_u32 s41, s41, 0
  s_waitcnt vmcnt(30)
  v_dot2_f32_bf16 v80, v168, v56, 0
  v_dot2_f32_bf16 v81, v172, v60, 0
  v_dot2_f32_bf16 v82, v176, v64, 0
  v_dot2_f32_bf16 v83, v180, v56, 0
  v_dot2_f32_bf16 v84, v184, v60, 0
  v_dot2_f32_bf16 v85, v188, v64, 0
  v_dot2c_f32_bf16 v80, v169, v57
  v_dot2c_f32_bf16 v81, v173, v61
  v_dot2c_f32_bf16 v82, v177, v65
  v_dot2c_f32_bf16 v83, v181, v57
  v_dot2c_f32_bf16 v84, v185, v61
  v_dot2c_f32_bf16 v85, v189, v65
  v_dot2c_f32_bf16 v80, v170, v58
  v_dot2c_f32_bf16 v81, v174, v62
  v_dot2c_f32_bf16 v82, v178, v66
  v_dot2c_f32_bf16 v83, v182, v58
  v_dot2c_f32_bf16 v84, v186, v62
  v_dot2c_f32_bf16 v85, v190, v66
  v_dot2c_f32_bf16 v80, v171, v59
  v_dot2c_f32_bf16 v81, v175, v63
  v_dot2c_f32_bf16 v82, v179, v67
  v_dot2c_f32_bf16 v83, v183, v59
  v_dot2c_f32_bf16 v84, v187, v63
  v_dot2c_f32_bf16 v85, v191, v67
  s_nop 2
  v_add_f32 v80, v80, v81
  v_add_f32 v83, v83, v84
  v_add_f32 v80, v80, v82
  v_add_f32 v83, v83, v85
  s_nop 0
  v_add_f32_dpp v80, v80, v80 quad_perm:[1,0,3,2] row_mask:0xf bank_mask:0xf
  v_add_f32_dpp v83, v83, v83 quad_perm:[1,0,3,2] row_mask:0xf bank_mask:0xf
  s_nop 0
  v_add_f32_dpp v80, v80, v80 quad_perm:[2,3,0,1] row_mask:0xf bank_mask:0xf
  v_add_f32_dpp v83, v83, v83 quad_perm:[2,3,0,1] row_mask:0xf bank_mask:0xf
  s_nop 0
  v_add_f32_dpp v80, v80, v80 row_half_mirror row_mask:0xf bank_mask:0xf
  v_add_f32_dpp v83, v83, v83 row_half_mirror row_mask:0xf bank_mask:0xf
  s_nop 0
  v_cvt_pk_bf16_f32 v80, v80, v80
  v_cvt_pk_bf16_f32 v83, v83, v83
  v_lshlrev_b32 v80, 16, v80
  v_lshlrev_b32 v83, 16, v83
  v_mul_f32 v80, s49, v80
  v_mul_f32 v83, s49, v83
  v_cvt_pk_bf16_f32 v55, v80, v83
  global_load_dwordx4 v[168:171], v5, s[40:41] offset:0 nt
  global_load_dwordx4 v[172:175], v5, s[40:41] offset:128 nt
  global_load_dwordx4 v[176:179], v5, s[40:41] offset:256 nt
  global_load_dwordx4 v[180:183], v5, s[40:41] offset:3072 nt
  global_load_dwordx4 v[184:187], v5, s[40:41] offset:3200 nt
  global_load_dwordx4 v[188:191], v5, s[40:41] offset:3328 nt
  s_add_u32 s40, s40, 6144
  s_addc_u32 s41, s41, 0
  v_lshlrev_b32 v80, 16, v40
  v_and_b32 v81, 0xffff0000, v40
  v_max_f32 v11, v80, v81
  v_lshlrev_b32 v80, 16, v41
  v_and_b32 v81, 0xffff0000, v41
  v_max3_f32 v11, v11, v80, v81
  v_lshlrev_b32 v80, 16, v42
  v_and_b32 v81, 0xffff0000, v42
  v_max3_f32 v11, v11, v80, v81
  v_lshlrev_b32 v80, 16, v43
  v_and_b32 v81, 0xffff0000, v43
  v_max3_f32 v11, v11, v80, v81
  v_lshlrev_b32 v80, 16, v44
  v_and_b32 v81, 0xffff0000, v44
  v_max3_f32 v11, v11, v80, v81
  v_lshlrev_b32 v80, 16, v45
  v_and_b32 v81, 0xffff0000, v45
  v_max3_f32 v11, v11, v80, v81
  v_lshlrev_b32 v80, 16, v46
  v_and_b32 v81, 0xffff0000, v46
  v_max3_f32 v11, v11, v80, v81
  v_lshlrev_b32 v80, 16, v47
  v_and_b32 v81, 0xffff0000, v47
  v_max3_f32 v11, v11, v80, v81
  v_lshlrev_b32 v80, 16, v48
  v_and_b32 v81, 0xffff0000, v48
  v_max3_f32 v11, v11, v80, v81
  v_lshlrev_b32 v80, 16, v49
  v_and_b32 v81, 0xffff0000, v49
  v_max3_f32 v11, v11, v80, v81
  v_lshlrev_b32 v80, 16, v50
  v_and_b32 v81, 0xffff0000, v50
  v_max3_f32 v11, v11, v80, v81
  v_lshlrev_b32 v80, 16, v51
  v_and_b32 v81, 0xffff0000, v51
  v_max3_f32 v11, v11, v80, v81
  v_lshlrev_b32 v80, 16, v52
  v_and_b32 v81, 0xffff0000, v52
  v_max3_f32 v11, v11, v80, v81
  v_lshlrev_b32 v80, 16, v53
  v_and_b32 v81, 0xffff0000, v53
  v_max3_f32 v11, v11, v80, v81
  v_lshlrev_b32 v80, 16, v54
  v_and_b32 v81, 0xffff0000, v54
  v_max3_f32 v11, v11, v80, v81
  v_lshlrev_b32 v80, 16, v55
  v_and_b32 v81, 0xffff0000, v55
  v_max3_f32 v11, v11, v80, v81
  s_nop 3
  v_max_f32_dpp v11, v11, v11 row_ror:8 row_mask:0xf bank_mask:0xf
  v_mov_b32 v80, v11
  s_nop 1
  v_permlane16_swap_b32 v11, v80
  s_nop 1
  v_max_f32 v11, v11, v80
  v_mov_b32 v80, v11
  s_nop 1
  v_permlane32_swap_b32 v11, v80
  s_nop 1
  v_max_f32 v11, v11, v80
  v_mov_b32 v12, 0
  v_lshlrev_b32 v80, 16, v40
  v_and_b32 v81, 0xffff0000, v40
  v_sub_f32 v80, v80, v11
  v_sub_f32 v81, v81, v11
  v_mul_f32 v80, s50, v80
  v_mul_f32 v81, s50, v81
  v_exp_f32 v80, v80
  v_exp_f32 v81, v81
  s_nop 0
  v_add_f32 v12, v12, v80
  v_add_f32 v12, v12, v81
  v_lshlrev_b32 v80, 16, v41
  v_and_b32 v81, 0xffff0000, v41
  v_sub_f32 v80, v80, v11
  v_sub_f32 v81, v81, v11
  v_mul_f32 v80, s50, v80
  v_mul_f32 v81, s50, v81
  v_exp_f32 v80, v80
  v_exp_f32 v81, v81
  s_nop 0
  v_add_f32 v12, v12, v80
  v_add_f32 v12, v12, v81
  v_lshlrev_b32 v80, 16, v42
  v_and_b32 v81, 0xffff0000, v42
  v_sub_f32 v80, v80, v11
  v_sub_f32 v81, v81, v11
  v_mul_f32 v80, s50, v80
  v_mul_f32 v81, s50, v81
  v_exp_f32 v80, v80
  v_exp_f32 v81, v81
  s_nop 0
  v_add_f32 v12, v12, v80
  v_add_f32 v12, v12, v81
  v_lshlrev_b32 v80, 16, v43
  v_and_b32 v81, 0xffff0000, v43
  v_sub_f32 v80, v80, v11
  v_sub_f32 v81, v81, v11
  v_mul_f32 v80, s50, v80
  v_mul_f32 v81, s50, v81
  v_exp_f32 v80, v80
  v_exp_f32 v81, v81
  s_nop 0
  v_add_f32 v12, v12, v80
  v_add_f32 v12, v12, v81
  v_lshlrev_b32 v80, 16, v44
  v_and_b32 v81, 0xffff0000, v44
  v_sub_f32 v80, v80, v11
  v_sub_f32 v81, v81, v11
  v_mul_f32 v80, s50, v80
  v_mul_f32 v81, s50, v81
  v_exp_f32 v80, v80
  v_exp_f32 v81, v81
  s_nop 0
  v_add_f32 v12, v12, v80
  v_add_f32 v12, v12, v81
  v_lshlrev_b32 v80, 16, v45
  v_and_b32 v81, 0xffff0000, v45
  v_sub_f32 v80, v80, v11
  v_sub_f32 v81, v81, v11
  v_mul_f32 v80, s50, v80
  v_mul_f32 v81, s50, v81
  v_exp_f32 v80, v80
  v_exp_f32 v81, v81
  s_nop 0
  v_add_f32 v12, v12, v80
  v_add_f32 v12, v12, v81
  v_lshlrev_b32 v80, 16, v46
  v_and_b32 v81, 0xffff0000, v46
  v_sub_f32 v80, v80, v11
  v_sub_f32 v81, v81, v11
  v_mul_f32 v80, s50, v80
  v_mul_f32 v81, s50, v81
  v_exp_f32 v80, v80
  v_exp_f32 v81, v81
  s_nop 0
  v_add_f32 v12, v12, v80
  v_add_f32 v12, v12, v81
  v_lshlrev_b32 v80, 16, v47
  v_and_b32 v81, 0xffff0000, v47
  v_sub_f32 v80, v80, v11
  v_sub_f32 v81, v81, v11
  v_mul_f32 v80, s50, v80
  v_mul_f32 v81, s50, v81
  v_exp_f32 v80, v80
  v_exp_f32 v81, v81
  s_nop 0
  v_add_f32 v12, v12, v80
  v_add_f32 v12, v12, v81
  v_lshlrev_b32 v80, 16, v48
  v_and_b32 v81, 0xffff0000, v48
  v_sub_f32 v80, v80, v11
  v_sub_f32 v81, v81, v11
  v_mul_f32 v80, s50, v80
  v_mul_f32 v81, s50, v81
  v_exp_f32 v80, v80
  v_exp_f32 v81, v81
  s_nop 0
  v_add_f32 v12, v12, v80
  v_add_f32 v12, v12, v81
  v_lshlrev_b32 v80, 16, v49
  v_and_b32 v81, 0xffff0000, v49
  v_sub_f32 v80, v80, v11
  v_sub_f32 v81, v81, v11
  v_mul_f32 v80, s50, v80
  v_mul_f32 v81, s50, v81
  v_exp_f32 v80, v80
  v_exp_f32 v81, v81
  s_nop 0
  v_add_f32 v12, v12, v80
  v_add_f32 v12, v12, v81
  v_lshlrev_b32 v80, 16, v50
  v_and_b32 v81, 0xffff0000, v50
  v_sub_f32 v80, v80, v11
  v_sub_f32 v81, v81, v11
  v_mul_f32 v80, s50, v80
  v_mul_f32 v81, s50, v81
  v_exp_f32 v80, v80
  v_exp_f32 v81, v81
  s_nop 0
  v_add_f32 v12, v12, v80
  v_add_f32 v12, v12, v81
  v_lshlrev_b32 v80, 16, v51
  v_and_b32 v81, 0xffff0000, v51
  v_sub_f32 v80, v80, v11
  v_sub_f32 v81, v81, v11
  v_mul_f32 v80, s50, v80
  v_mul_f32 v81, s50, v81
  v_exp_f32 v80, v80
  v_exp_f32 v81, v81
  s_nop 0
  v_add_f32 v12, v12, v80
  v_add_f32 v12, v12, v81
  v_lshlrev_b32 v80, 16, v52
  v_and_b32 v81, 0xffff0000, v52
  v_sub_f32 v80, v80, v11
  v_sub_f32 v81, v81, v11
  v_mul_f32 v80, s50, v80
  v_mul_f32 v81, s50, v81
  v_exp_f32 v80, v80
  v_exp_f32 v81, v81
  s_nop 0
  v_add_f32 v12, v12, v80
  v_add_f32 v12, v12, v81
  v_lshlrev_b32 v80, 16, v53
  v_and_b32 v81, 0xffff0000, v53
  v_sub_f32 v80, v80, v11
  v_sub_f32 v81, v81, v11
  v_mul_f32 v80, s50, v80
  v_mul_f32 v81, s50, v81
  v_exp_f32 v80, v80
  v_exp_f32 v81, v81
  s_nop 0
  v_add_f32 v12, v12, v80
  v_add_f32 v12, v12, v81
  v_lshlrev_b32 v80, 16, v54
  v_and_b32 v81, 0xffff0000, v54
  v_sub_f32 v80, v80, v11
  v_sub_f32 v81, v81, v11
  v_mul_f32 v80, s50, v80
  v_mul_f32 v81, s50, v81
  v_exp_f32 v80, v80
  v_exp_f32 v81, v81
  s_nop 0
  v_add_f32 v12, v12, v80
  v_add_f32 v12, v12, v81
  v_lshlrev_b32 v80, 16, v55
  v_and_b32 v81, 0xffff0000, v55
  v_sub_f32 v80, v80, v11
  v_sub_f32 v81, v81, v11
  v_mul_f32 v80, s50, v80
  v_mul_f32 v81, s50, v81
  v_exp_f32 v80, v80
  v_exp_f32 v81, v81
  s_nop 0
  v_add_f32 v12, v12, v80
  v_add_f32 v12, v12, v81
  s_nop 3
  v_add_f32_dpp v12, v12, v12 row_ror:8 row_mask:0xf bank_mask:0xf
  v_mov_b32 v80, v12
  s_nop 1
  v_permlane16_swap_b32 v12, v80
  s_nop 1
  v_add_f32 v12, v12, v80
  v_mov_b32 v80, v12
  s_nop 1
  v_permlane32_swap_b32 v12, v80
  s_nop 1
  v_add_f32 v12, v12, v80
  v_mov_b32 v80, v11
  v_mov_b32 v81, v12
  v_lshlrev_b32 v82, 3, v3
  s_mov_b64 exec, 1
  ds_write_b64 v82, v[80:81] offset:3072
  s_mov_b64 exec, -1
  s_waitcnt lgkmcnt(0)
  s_barrier
  v_mov_b32 v88, 0
  ds_read_b128 v[80:83], v88 offset:3072
  ds_read_b128 v[84:87], v88 offset:3088
  s_waitcnt lgkmcnt(0)
  v_max3_f32 v13, v80, v82, v84
  v_max_f32 v13, v13, v86
  v_sub_f32 v80, v80, v13
  v_mul_f32 v80, s50, v80
  v_exp_f32 v80, v80
  v_sub_f32 v82, v82, v13
  v_mul_f32 v82, s50, v82
  v_exp_f32 v82, v82
  v_sub_f32 v84, v84, v13
  v_mul_f32 v84, s50, v84
  v_exp_f32 v84, v84
  v_sub_f32 v86, v86, v13
  v_mul_f32 v86, s50, v86
  v_exp_f32 v86, v86
  s_nop 0
  v_mul_f32 v12, v80, v81
  v_fmac_f32 v12, v82, v83
  v_fmac_f32 v12, v84, v85
  v_fmac_f32 v12, v86, v87
  v_rcp_f32 v12, v12
  v_mov_b32 v11, v13
  v_lshlrev_b32 v80, 16, v40
  v_and_b32 v81, 0xffff0000, v40
  v_sub_f32 v80, v80, v11
  v_sub_f32 v81, v81, v11
  v_mul_f32 v80, s50, v80
  v_mul_f32 v81, s50, v81
  v_exp_f32 v80, v80
  v_exp_f32 v81, v81
  s_nop 0
  v_mul_f32 v80, v80, v12
  v_mul_f32 v81, v81, v12
  v_cvt_pk_bf16_f32 v40, v80, v81
  v_lshlrev_b32 v80, 16, v41
  v_and_b32 v81, 0xffff0000, v41
  v_sub_f32 v80, v80, v11
  v_sub_f32 v81, v81, v11
  v_mul_f32 v80, s50, v80
  v_mul_f32 v81, s50, v81
  v_exp_f32 v80, v80
  v_exp_f32 v81, v81
  s_nop 0
  v_mul_f32 v80, v80, v12
  v_mul_f32 v81, v81, v12
  v_cvt_pk_bf16_f32 v41, v80, v81
  v_lshlrev_b32 v80, 16, v42
  v_and_b32 v81, 0xffff0000, v42
  v_sub_f32 v80, v80, v11
  v_sub_f32 v81, v81, v11
  v_mul_f32 v80, s50, v80
  v_mul_f32 v81, s50, v81
  v_exp_f32 v80, v80
  v_exp_f32 v81, v81
  s_nop 0
  v_mul_f32 v80, v80, v12
  v_mul_f32 v81, v81, v12
  v_cvt_pk_bf16_f32 v42, v80, v81
  v_lshlrev_b32 v80, 16, v43
  v_and_b32 v81, 0xffff0000, v43
  v_sub_f32 v80, v80, v11
  v_sub_f32 v81, v81, v11
  v_mul_f32 v80, s50, v80
  v_mul_f32 v81, s50, v81
  v_exp_f32 v80, v80
  v_exp_f32 v81, v81
  s_nop 0
  v_mul_f32 v80, v80, v12
  v_mul_f32 v81, v81, v12
  v_cvt_pk_bf16_f32 v43, v80, v81
  v_lshlrev_b32 v80, 16, v44
  v_and_b32 v81, 0xffff0000, v44
  v_sub_f32 v80, v80, v11
  v_sub_f32 v81, v81, v11
  v_mul_f32 v80, s50, v80
  v_mul_f32 v81, s50, v81
  v_exp_f32 v80, v80
  v_exp_f32 v81, v81
  s_nop 0
  v_mul_f32 v80, v80, v12
  v_mul_f32 v81, v81, v12
  v_cvt_pk_bf16_f32 v44, v80, v81
  v_lshlrev_b32 v80, 16, v45
  v_and_b32 v81, 0xffff0000, v45
  v_sub_f32 v80, v80, v11
  v_sub_f32 v81, v81, v11
  v_mul_f32 v80, s50, v80
  v_mul_f32 v81, s50, v81
  v_exp_f32 v80, v80
  v_exp_f32 v81, v81
  s_nop 0
  v_mul_f32 v80, v80, v12
  v_mul_f32 v81, v81, v12
  v_cvt_pk_bf16_f32 v45, v80, v81
  v_lshlrev_b32 v80, 16, v46
  v_and_b32 v81, 0xffff0000, v46
  v_sub_f32 v80, v80, v11
  v_sub_f32 v81, v81, v11
  v_mul_f32 v80, s50, v80
  v_mul_f32 v81, s50, v81
  v_exp_f32 v80, v80
  v_exp_f32 v81, v81
  s_nop 0
  v_mul_f32 v80, v80, v12
  v_mul_f32 v81, v81, v12
  v_cvt_pk_bf16_f32 v46, v80, v81
  v_lshlrev_b32 v80, 16, v47
  v_and_b32 v81, 0xffff0000, v47
  v_sub_f32 v80, v80, v11
  v_sub_f32 v81, v81, v11
  v_mul_f32 v80, s50, v80
  v_mul_f32 v81, s50, v81
  v_exp_f32 v80, v80
  v_exp_f32 v81, v81
  s_nop 0
  v_mul_f32 v80, v80, v12
  v_mul_f32 v81, v81, v12
  v_cvt_pk_bf16_f32 v47, v80, v81
  v_lshlrev_b32 v80, 16, v48
  v_and_b32 v81, 0xffff0000, v48
  v_sub_f32 v80, v80, v11
  v_sub_f32 v81, v81, v11
  v_mul_f32 v80, s50, v80
  v_mul_f32 v81, s50, v81
  v_exp_f32 v80, v80
  v_exp_f32 v81, v81
  s_nop 0
  v_mul_f32 v80, v80, v12
  v_mul_f32 v81, v81, v12
  v_cvt_pk_bf16_f32 v48, v80, v81
  v_lshlrev_b32 v80, 16, v49
  v_and_b32 v81, 0xffff0000, v49
  v_sub_f32 v80, v80, v11
  v_sub_f32 v81, v81, v11
  v_mul_f32 v80, s50, v80
  v_mul_f32 v81, s50, v81
  v_exp_f32 v80, v80
  v_exp_f32 v81, v81
  s_nop 0
  v_mul_f32 v80, v80, v12
  v_mul_f32 v81, v81, v12
  v_cvt_pk_bf16_f32 v49, v80, v81
  v_lshlrev_b32 v80, 16, v50
  v_and_b32 v81, 0xffff0000, v50
  v_sub_f32 v80, v80, v11
  v_sub_f32 v81, v81, v11
  v_mul_f32 v80, s50, v80
  v_mul_f32 v81, s50, v81
  v_exp_f32 v80, v80
  v_exp_f32 v81, v81
  s_nop 0
  v_mul_f32 v80, v80, v12
  v_mul_f32 v81, v81, v12
  v_cvt_pk_bf16_f32 v50, v80, v81
  v_lshlrev_b32 v80, 16, v51
  v_and_b32 v81, 0xffff0000, v51
  v_sub_f32 v80, v80, v11
  v_sub_f32 v81, v81, v11
  v_mul_f32 v80, s50, v80
  v_mul_f32 v81, s50, v81
  v_exp_f32 v80, v80
  v_exp_f32 v81, v81
  s_nop 0
  v_mul_f32 v80, v80, v12
  v_mul_f32 v81, v81, v12
  v_cvt_pk_bf16_f32 v51, v80, v81
  v_lshlrev_b32 v80, 16, v52
  v_and_b32 v81, 0xffff0000, v52
  v_sub_f32 v80, v80, v11
  v_sub_f32 v81, v81, v11
  v_mul_f32 v80, s50, v80
  v_mul_f32 v81, s50, v81
  v_exp_f32 v80, v80
  v_exp_f32 v81, v81
  s_nop 0
  v_mul_f32 v80, v80, v12
  v_mul_f32 v81, v81, v12
  v_cvt_pk_bf16_f32 v52, v80, v81
  v_lshlrev_b32 v80, 16, v53
  v_and_b32 v81, 0xffff0000, v53
  v_sub_f32 v80, v80, v11
  v_sub_f32 v81, v81, v11
  v_mul_f32 v80, s50, v80
  v_mul_f32 v81, s50, v81
  v_exp_f32 v80, v80
  v_exp_f32 v81, v81
  s_nop 0
  v_mul_f32 v80, v80, v12
  v_mul_f32 v81, v81, v12
  v_cvt_pk_bf16_f32 v53, v80, v81
  v_lshlrev_b32 v80, 16, v54
  v_and_b32 v81, 0xffff0000, v54
  v_sub_f32 v80, v80, v11
  v_sub_f32 v81, v81, v11
  v_mul_f32 v80, s50, v80
  v_mul_f32 v81, s50, v81
  v_exp_f32 v80, v80
  v_exp_f32 v81, v81
  s_nop 0
  v_mul_f32 v80, v80, v12
  v_mul_f32 v81, v81, v12
  v_cvt_pk_bf16_f32 v54, v80, v81
  v_lshlrev_b32 v80, 16, v55
  v_and_b32 v81, 0xffff0000, v55
  v_sub_f32 v80, v80, v11
  v_sub_f32 v81, v81, v11
  v_mul_f32 v80, s50, v80
  v_mul_f32 v81, s50, v81
  v_exp_f32 v80, v80
  v_exp_f32 v81, v81
  s_nop 0
  v_mul_f32 v80, v80, v12
  v_mul_f32 v81, v81, v12
  v_cvt_pk_bf16_f32 v55, v80, v81
  s_mul_i32 s32, s2, 2560
  s_add_u32 s34, s28, s32
  s_addc_u32 s35, s29, 0
  s_waitcnt vmcnt(30)
  v_and_b32 v80, 0xffff, v40
  v_lshlrev_b32 v81, 16, v40
  v_lshrrev_b32 v82, 16, v40
  v_and_b32 v83, 0xffff0000, v40
  v_dot2c_f32_bf16 v16, v96, v80
  v_dot2c_f32_bf16 v17, v96, v81
  v_dot2c_f32_bf16 v18, v97, v80
  v_dot2c_f32_bf16 v19, v97, v81
  v_dot2c_f32_bf16 v20, v98, v80
  v_dot2c_f32_bf16 v21, v98, v81
  v_dot2c_f32_bf16 v22, v99, v80
  v_dot2c_f32_bf16 v23, v99, v81
  v_dot2c_f32_bf16 v24, v100, v80
  v_dot2c_f32_bf16 v25, v100, v81
  v_dot2c_f32_bf16 v26, v101, v80
  v_dot2c_f32_bf16 v27, v101, v81
  v_dot2c_f32_bf16 v28, v102, v80
  v_dot2c_f32_bf16 v29, v102, v81
  v_dot2c_f32_bf16 v30, v103, v80
  v_dot2c_f32_bf16 v31, v103, v81
  v_dot2c_f32_bf16 v32, v104, v80
  v_dot2c_f32_bf16 v33, v104, v81
  v_dot2c_f32_bf16 v34, v105, v80
  v_dot2c_f32_bf16 v35, v105, v81
  v_dot2c_f32_bf16 v36, v106, v80
  v_dot2c_f32_bf16 v37, v106, v81
  v_dot2c_f32_bf16 v38, v107, v80
  v_dot2c_f32_bf16 v39, v107, v81
  v_dot2c_f32_bf16 v16, v108, v82
  v_dot2c_f32_bf16 v17, v108, v83
  v_dot2c_f32_bf16 v18, v109, v82
  v_dot2c_f32_bf16 v19, v109, v83
  v_dot2c_f32_bf16 v20, v110, v82
  v_dot2c_f32_bf16 v21, v110, v83
  v_dot2c_f32_bf16 v22, v111, v82
  v_dot2c_f32_bf16 v23, v111, v83
  v_dot2c_f32_bf16 v24, v112, v82
  v_dot2c_f32_bf16 v25, v112, v83
  v_dot2c_f32_bf16 v26, v113, v82
  v_dot2c_f32_bf16 v27, v113, v83
  v_dot2c_f32_bf16 v28, v114, v82
  v_dot2c_f32_bf16 v29, v114, v83
  v_dot2c_f32_bf16 v30, v115, v82
  v_dot2c_f32_bf16 v31, v115, v83
  v_dot2c_f32_bf16 v32, v116, v82
  v_dot2c_f32_bf16 v33, v116, v83
  v_dot2c_f32_bf16 v34, v117, v82
  v_dot2c_f32_bf16 v35, v117, v83
  v_dot2c_f32_bf16 v36, v118, v82
  v_dot2c_f32_bf16 v37, v118, v83
  v_dot2c_f32_bf16 v38, v119, v82
  v_dot2c_f32_bf16 v39, v119, v83
  global_load_dwordx4 v[96:99], v5, s[40:41] offset:0 nt
  global_load_dwordx4 v[100:103], v5, s[40:41] offset:128 nt
  global_load_dwordx4 v[104:107], v5, s[40:41] offset:256 nt
  global_load_dwordx4 v[108:111], v5, s[40:41] offset:3072 nt
  global_load_dwordx4 v[112:115], v5, s[40:41] offset:3200 nt
  global_load_dwordx4 v[116:119], v5, s[40:41] offset:3328 nt
  s_add_u32 s40, s40, 6144
  s_addc_u32 s41, s41, 0
  s_waitcnt vmcnt(30)
  v_and_b32 v80, 0xffff, v41
  v_lshlrev_b32 v81, 16, v41
  v_lshrrev_b32 v82, 16, v41
  v_and_b32 v83, 0xffff0000, v41
  v_dot2c_f32_bf16 v16, v120, v80
  v_dot2c_f32_bf16 v17, v120, v81
  v_dot2c_f32_bf16 v18, v121, v80
  v_dot2c_f32_bf16 v19, v121, v81
  v_dot2c_f32_bf16 v20, v122, v80
  v_dot2c_f32_bf16 v21, v122, v81
  v_dot2c_f32_bf16 v22, v123, v80
  v_dot2c_f32_bf16 v23, v123, v81
  v_dot2c_f32_bf16 v24, v124, v80
  v_dot2c_f32_bf16 v25, v124, v81
  v_dot2c_f32_bf16 v26, v125, v80
  v_dot2c_f32_bf16 v27, v125, v81
  v_dot2c_f32_bf16 v28, v126, v80
  v_dot2c_f32_bf16 v29, v126, v81
  v_dot2c_f32_bf16 v30, v127, v80
  v_dot2c_f32_bf16 v31, v127, v81
  v_dot2c_f32_bf16 v32, v128, v80
  v_dot2c_f32_bf16 v33, v128, v81
  v_dot2c_f32_bf16 v34, v129, v80
  v_dot2c_f32_bf16 v35, v129, v81
  v_dot2c_f32_bf16 v36, v130, v80
  v_dot2c_f32_bf16 v37, v130, v81
  v_dot2c_f32_bf16 v38, v131, v80
  v_dot2c_f32_bf16 v39, v131, v81
  v_dot2c_f32_bf16 v16, v132, v82
  v_dot2c_f32_bf16 v17, v132, v83
  v_dot2c_f32_bf16 v18, v133, v82
  v_dot2c_f32_bf16 v19, v133, v83
  v_dot2c_f32_bf16 v20, v134, v82
  v_dot2c_f32_bf16 v21, v134, v83
  v_dot2c_f32_bf16 v22, v135, v82
  v_dot2c_f32_bf16 v23, v135, v83
  v_dot2c_f32_bf16 v24, v136, v82
  v_dot2c_f32_bf16 v25, v136, v83
  v_dot2c_f32_bf16 v26, v137, v82
  v_dot2c_f32_bf16 v27, v137, v83
  v_dot2c_f32_bf16 v28, v138, v82
  v_dot2c_f32_bf16 v29, v138, v83
  v_dot2c_f32_bf16 v30, v139, v82
  v_dot2c_f32_bf16 v31, v139, v83
  v_dot2c_f32_bf16 v32, v140, v82
  v_dot2c_f32_bf16 v33, v140, v83
  v_dot2c_f32_bf16 v34, v141, v82
  v_dot2c_f32_bf16 v35, v141, v83
  v_dot2c_f32_bf16 v36, v142, v82
  v_dot2c_f32_bf16 v37, v142, v83
  v_dot2c_f32_bf16 v38, v143, v82
  v_dot2c_f32_bf16 v39, v143, v83
  global_load_dwordx4 v[120:123], v5, s[40:41] offset:0 nt
  global_load_dwordx4 v[124:127], v5, s[40:41] offset:128 nt
  global_load_dwordx4 v[128:131], v5, s[40:41] offset:256 nt
  global_load_dwordx4 v[132:135], v5, s[40:41] offset:3072 nt
  global_load_dwordx4 v[136:139], v5, s[40:41] offset:3200 nt
  global_load_dwordx4 v[140:143], v5, s[40:41] offset:3328 nt
  s_add_u32 s40, s40, 6144
  s_addc_u32 s41, s41, 0
  s_waitcnt vmcnt(30)
  v_and_b32 v80, 0xffff, v42
  v_lshlrev_b32 v81, 16, v42
  v_lshrrev_b32 v82, 16, v42
  v_and_b32 v83, 0xffff0000, v42
  v_dot2c_f32_bf16 v16, v192, v80
  v_dot2c_f32_bf16 v17, v192, v81
  v_dot2c_f32_bf16 v18, v193, v80
  v_dot2c_f32_bf16 v19, v193, v81
  v_dot2c_f32_bf16 v20, v194, v80
  v_dot2c_f32_bf16 v21, v194, v81
  v_dot2c_f32_bf16 v22, v195, v80
  v_dot2c_f32_bf16 v23, v195, v81
  v_dot2c_f32_bf16 v24, v196, v80
  v_dot2c_f32_bf16 v25, v196, v81
  v_dot2c_f32_bf16 v26, v197, v80
  v_dot2c_f32_bf16 v27, v197, v81
  v_dot2c_f32_bf16 v28, v198, v80
  v_dot2c_f32_bf16 v29, v198, v81
  v_dot2c_f32_bf16 v30, v199, v80
  v_dot2c_f32_bf16 v31, v199, v81
  v_dot2c_f32_bf16 v32, v200, v80
  v_dot2c_f32_bf16 v33, v200, v81
  v_dot2c_f32_bf16 v34, v201, v80
  v_dot2c_f32_bf16 v35, v201, v81
  v_dot2c_f32_bf16 v36, v202, v80
  v_dot2c_f32_bf16 v37, v202, v81
  v_dot2c_f32_bf16 v38, v203, v80
  v_dot2c_f32_bf16 v39, v203, v81
  v_dot2c_f32_bf16 v16, v204, v82
  v_dot2c_f32_bf16 v17, v204, v83
  v_dot2c_f32_bf16 v18, v205, v82
  v_dot2c_f32_bf16 v19, v205, v83
  v_dot2c_f32_bf16 v20, v206, v82
  v_dot2c_f32_bf16 v21, v206, v83
  v_dot2c_f32_bf16 v22, v207, v82
  v_dot2c_f32_bf16 v23, v207, v83
  v_dot2c_f32_bf16 v24, v208, v82
  v_dot2c_f32_bf16 v25, v208, v83
  v_dot2c_f32_bf16 v26, v209, v82
  v_dot2c_f32_bf16 v27, v209, v83
  v_dot2c_f32_bf16 v28, v210, v82
  v_dot2c_f32_bf16 v29, v210, v83
  v_dot2c_f32_bf16 v30, v211, v82
  v_dot2c_f32_bf16 v31, v211, v83
  v_dot2c_f32_bf16 v32, v212, v82
  v_dot2c_f32_bf16 v33, v212, v83
  v_dot2c_f32_bf16 v34, v213, v82
  v_dot2c_f32_bf16 v35, v213, v83
  v_dot2c_f32_bf16 v36, v214, v82
  v_dot2c_f32_bf16 v37, v214, v83
  v_dot2c_f32_bf16 v38, v215, v82
  v_dot2c_f32_bf16 v39, v215, v83
  global_load_dwordx4 v[192:195], v5, s[40:41] offset:0 nt
  global_load_dwordx4 v[196:199], v5, s[40:41] offset:128 nt
  global_load_dwordx4 v[200:203], v5, s[40:41] offset:256 nt
  global_load_dwordx4 v[204:207], v5, s[40:41] offset:3072 nt
  global_load_dwordx4 v[208:211], v5, s[40:41] offset:3200 nt
  global_load_dwordx4 v[212:215], v5, s[40:41] offset:3328 nt
  s_add_u32 s40, s40, 6144
  s_addc_u32 s41, s41, 0
  s_waitcnt vmcnt(30)
  v_and_b32 v80, 0xffff, v43
  v_lshlrev_b32 v81, 16, v43
  v_lshrrev_b32 v82, 16, v43
  v_and_b32 v83, 0xffff0000, v43
  v_dot2c_f32_bf16 v16, v216, v80
  v_dot2c_f32_bf16 v17, v216, v81
  v_dot2c_f32_bf16 v18, v217, v80
  v_dot2c_f32_bf16 v19, v217, v81
  v_dot2c_f32_bf16 v20, v218, v80
  v_dot2c_f32_bf16 v21, v218, v81
  v_dot2c_f32_bf16 v22, v219, v80
  v_dot2c_f32_bf16 v23, v219, v81
  v_dot2c_f32_bf16 v24, v220, v80
  v_dot2c_f32_bf16 v25, v220, v81
  v_dot2c_f32_bf16 v26, v221, v80
  v_dot2c_f32_bf16 v27, v221, v81
  v_dot2c_f32_bf16 v28, v222, v80
  v_dot2c_f32_bf16 v29, v222, v81
  v_dot2c_f32_bf16 v30, v223, v80
  v_dot2c_f32_bf16 v31, v223, v81
  v_dot2c_f32_bf16 v32, v224, v80
  v_dot2c_f32_bf16 v33, v224, v81
  v_dot2c_f32_bf16 v34, v225, v80
  v_dot2c_f32_bf16 v35, v225, v81
  v_dot2c_f32_bf16 v36, v226, v80
  v_dot2c_f32_bf16 v37, v226, v81
  v_dot2c_f32_bf16 v38, v227, v80
  v_dot2c_f32_bf16 v39, v227, v81
  v_dot2c_f32_bf16 v16, v228, v82
  v_dot2c_f32_bf16 v17, v228, v83
  v_dot2c_f32_bf16 v18, v229, v82
  v_dot2c_f32_bf16 v19, v229, v83
  v_dot2c_f32_bf16 v20, v230, v82
  v_dot2c_f32_bf16 v21, v230, v83
  v_dot2c_f32_bf16 v22, v231, v82
  v_dot2c_f32_bf16 v23, v231, v83
  v_dot2c_f32_bf16 v24, v232, v82
  v_dot2c_f32_bf16 v25, v232, v83
  v_dot2c_f32_bf16 v26, v233, v82
  v_dot2c_f32_bf16 v27, v233, v83
  v_dot2c_f32_bf16 v28, v234, v82
  v_dot2c_f32_bf16 v29, v234, v83
  v_dot2c_f32_bf16 v30, v235, v82
  v_dot2c_f32_bf16 v31, v235, v83
  v_dot2c_f32_bf16 v32, v236, v82
  v_dot2c_f32_bf16 v33, v236, v83
  v_dot2c_f32_bf16 v34, v237, v82
  v_dot2c_f32_bf16 v35, v237, v83
  v_dot2c_f32_bf16 v36, v238, v82
  v_dot2c_f32_bf16 v37, v238, v83
  v_dot2c_f32_bf16 v38, v239, v82
  v_dot2c_f32_bf16 v39, v239, v83
  global_load_dwordx4 v[216:219], v5, s[40:41] offset:0 nt
  global_load_dwordx4 v[220:223], v5, s[40:41] offset:128 nt
  global_load_dwordx4 v[224:227], v5, s[40:41] offset:256 nt
  global_load_dwordx4 v[228:231], v5, s[40:41] offset:3072 nt
  global_load_dwordx4 v[232:235], v5, s[40:41] offset:3200 nt
  global_load_dwordx4 v[236:239], v5, s[40:41] offset:3328 nt
  s_add_u32 s40, s40, 6144
  s_addc_u32 s41, s41, 0
  s_waitcnt vmcnt(30)
  v_and_b32 v80, 0xffff, v44
  v_lshlrev_b32 v81, 16, v44
  v_lshrrev_b32 v82, 16, v44
  v_and_b32 v83, 0xffff0000, v44
  v_dot2c_f32_bf16 v16, v144, v80
  v_dot2c_f32_bf16 v17, v144, v81
  v_dot2c_f32_bf16 v18, v145, v80
  v_dot2c_f32_bf16 v19, v145, v81
  v_dot2c_f32_bf16 v20, v146, v80
  v_dot2c_f32_bf16 v21, v146, v81
  v_dot2c_f32_bf16 v22, v147, v80
  v_dot2c_f32_bf16 v23, v147, v81
  v_dot2c_f32_bf16 v24, v148, v80
  v_dot2c_f32_bf16 v25, v148, v81
  v_dot2c_f32_bf16 v26, v149, v80
  v_dot2c_f32_bf16 v27, v149, v81
  v_dot2c_f32_bf16 v28, v150, v80
  v_dot2c_f32_bf16 v29, v150, v81
  v_dot2c_f32_bf16 v30, v151, v80
  v_dot2c_f32_bf16 v31, v151, v81
  v_dot2c_f32_bf16 v32, v152, v80
  v_dot2c_f32_bf16 v33, v152, v81
  v_dot2c_f32_bf16 v34, v153, v80
  v_dot2c_f32_bf16 v35, v153, v81
  v_dot2c_f32_bf16 v36, v154, v80
  v_dot2c_f32_bf16 v37, v154, v81
  v_dot2c_f32_bf16 v38, v155, v80
  v_dot2c_f32_bf16 v39, v155, v81
  v_dot2c_f32_bf16 v16, v156, v82
  v_dot2c_f32_bf16 v17, v156, v83
  v_dot2c_f32_bf16 v18, v157, v82
  v_dot2c_f32_bf16 v19, v157, v83
  v_dot2c_f32_bf16 v20, v158, v82
  v_dot2c_f32_bf16 v21, v158, v83
  v_dot2c_f32_bf16 v22, v159, v82
  v_dot2c_f32_bf16 v23, v159, v83
  v_dot2c_f32_bf16 v24, v160, v82
  v_dot2c_f32_bf16 v25, v160, v83
  v_dot2c_f32_bf16 v26, v161, v82
  v_dot2c_f32_bf16 v27, v161, v83
  v_dot2c_f32_bf16 v28, v162, v82
  v_dot2c_f32_bf16 v29, v162, v83
  v_dot2c_f32_bf16 v30, v163, v82
  v_dot2c_f32_bf16 v31, v163, v83
  v_dot2c_f32_bf16 v32, v164, v82
  v_dot2c_f32_bf16 v33, v164, v83
  v_dot2c_f32_bf16 v34, v165, v82
  v_dot2c_f32_bf16 v35, v165, v83
  v_dot2c_f32_bf16 v36, v166, v82
  v_dot2c_f32_bf16 v37, v166, v83
  v_dot2c_f32_bf16 v38, v167, v82
  v_dot2c_f32_bf16 v39, v167, v83
  global_load_dwordx4 v[144:147], v5, s[40:41] offset:0 nt
  global_load_dwordx4 v[148:151], v5, s[40:41] offset:128 nt
  global_load_dwordx4 v[152:155], v5, s[40:41] offset:256 nt
  global_load_dwordx4 v[156:159], v5, s[40:41] offset:3072 nt
  global_load_dwordx4 v[160:163], v5, s[40:41] offset:3200 nt
  global_load_dwordx4 v[164:167], v5, s[40:41] offset:3328 nt
  s_add_u32 s40, s40, 6144
  s_addc_u32 s41, s41, 0
  s_waitcnt vmcnt(30)
  v_and_b32 v80, 0xffff, v45
  v_lshlrev_b32 v81, 16, v45
  v_lshrrev_b32 v82, 16, v45
  v_and_b32 v83, 0xffff0000, v45
  v_dot2c_f32_bf16 v16, v168, v80
  v_dot2c_f32_bf16 v17, v168, v81
  v_dot2c_f32_bf16 v18, v169, v80
  v_dot2c_f32_bf16 v19, v169, v81
  v_dot2c_f32_bf16 v20, v170, v80
  v_dot2c_f32_bf16 v21, v170, v81
  v_dot2c_f32_bf16 v22, v171, v80
  v_dot2c_f32_bf16 v23, v171, v81
  v_dot2c_f32_bf16 v24, v172, v80
  v_dot2c_f32_bf16 v25, v172, v81
  v_dot2c_f32_bf16 v26, v173, v80
  v_dot2c_f32_bf16 v27, v173, v81
  v_dot2c_f32_bf16 v28, v174, v80
  v_dot2c_f32_bf16 v29, v174, v81
  v_dot2c_f32_bf16 v30, v175, v80
  v_dot2c_f32_bf16 v31, v175, v81
  v_dot2c_f32_bf16 v32, v176, v80
  v_dot2c_f32_bf16 v33, v176, v81
  v_dot2c_f32_bf16 v34, v177, v80
  v_dot2c_f32_bf16 v35, v177, v81
  v_dot2c_f32_bf16 v36, v178, v80
  v_dot2c_f32_bf16 v37, v178, v81
  v_dot2c_f32_bf16 v38, v179, v80
  v_dot2c_f32_bf16 v39, v179, v81
  v_dot2c_f32_bf16 v16, v180, v82
  v_dot2c_f32_bf16 v17, v180, v83
  v_dot2c_f32_bf16 v18, v181, v82
  v_dot2c_f32_bf16 v19, v181, v83
  v_dot2c_f32_bf16 v20, v182, v82
  v_dot2c_f32_bf16 v21, v182, v83
  v_dot2c_f32_bf16 v22, v183, v82
  v_dot2c_f32_bf16 v23, v183, v83
  v_dot2c_f32_bf16 v24, v184, v82
  v_dot2c_f32_bf16 v25, v184, v83
  v_dot2c_f32_bf16 v26, v185, v82
  v_dot2c_f32_bf16 v27, v185, v83
  v_dot2c_f32_bf16 v28, v186, v82
  v_dot2c_f32_bf16 v29, v186, v83
  v_dot2c_f32_bf16 v30, v187, v82
  v_dot2c_f32_bf16 v31, v187, v83
  v_dot2c_f32_bf16 v32, v188, v82
  v_dot2c_f32_bf16 v33, v188, v83
  v_dot2c_f32_bf16 v34, v189, v82
  v_dot2c_f32_bf16 v35, v189, v83
  v_dot2c_f32_bf16 v36, v190, v82
  v_dot2c_f32_bf16 v37, v190, v83
  v_dot2c_f32_bf16 v38, v191, v82
  v_dot2c_f32_bf16 v39, v191, v83
  global_load_dwordx4 v[168:171], v5, s[40:41] offset:0 nt
  global_load_dwordx4 v[172:175], v5, s[40:41] offset:128 nt
  global_load_dwordx4 v[176:179], v5, s[40:41] offset:256 nt
  global_load_dwordx4 v[180:183], v5, s[40:41] offset:3072 nt
  global_load_dwordx4 v[184:187], v5, s[40:41] offset:3200 nt
  global_load_dwordx4 v[188:191], v5, s[40:41] offset:3328 nt
  s_add_u32 s40, s40, 6144
  s_addc_u32 s41, s41, 0
  s_waitcnt vmcnt(30)
  v_and_b32 v80, 0xffff, v46
  v_lshlrev_b32 v81, 16, v46
  v_lshrrev_b32 v82, 16, v46
  v_and_b32 v83, 0xffff0000, v46
  v_dot2c_f32_bf16 v16, v96, v80
  v_dot2c_f32_bf16 v17, v96, v81
  v_dot2c_f32_bf16 v18, v97, v80
  v_dot2c_f32_bf16 v19, v97, v81
  v_dot2c_f32_bf16 v20, v98, v80
  v_dot2c_f32_bf16 v21, v98, v81
  v_dot2c_f32_bf16 v22, v99, v80
  v_dot2c_f32_bf16 v23, v99, v81
  v_dot2c_f32_bf16 v24, v100, v80
  v_dot2c_f32_bf16 v25, v100, v81
  v_dot2c_f32_bf16 v26, v101, v80
  v_dot2c_f32_bf16 v27, v101, v81
  v_dot2c_f32_bf16 v28, v102, v80
  v_dot2c_f32_bf16 v29, v102, v81
  v_dot2c_f32_bf16 v30, v103, v80
  v_dot2c_f32_bf16 v31, v103, v81
  v_dot2c_f32_bf16 v32, v104, v80
  v_dot2c_f32_bf16 v33, v104, v81
  v_dot2c_f32_bf16 v34, v105, v80
  v_dot2c_f32_bf16 v35, v105, v81
  v_dot2c_f32_bf16 v36, v106, v80
  v_dot2c_f32_bf16 v37, v106, v81
  v_dot2c_f32_bf16 v38, v107, v80
  v_dot2c_f32_bf16 v39, v107, v81
  v_dot2c_f32_bf16 v16, v108, v82
  v_dot2c_f32_bf16 v17, v108, v83
  v_dot2c_f32_bf16 v18, v109, v82
  v_dot2c_f32_bf16 v19, v109, v83
  v_dot2c_f32_bf16 v20, v110, v82
  v_dot2c_f32_bf16 v21, v110, v83
  v_dot2c_f32_bf16 v22, v111, v82
  v_dot2c_f32_bf16 v23, v111, v83
  v_dot2c_f32_bf16 v24, v112, v82
  v_dot2c_f32_bf16 v25, v112, v83
  v_dot2c_f32_bf16 v26, v113, v82
  v_dot2c_f32_bf16 v27, v113, v83
  v_dot2c_f32_bf16 v28, v114, v82
  v_dot2c_f32_bf16 v29, v114, v83
  v_dot2c_f32_bf16 v30, v115, v82
  v_dot2c_f32_bf16 v31, v115, v83
  v_dot2c_f32_bf16 v32, v116, v82
  v_dot2c_f32_bf16 v33, v116, v83
  v_dot2c_f32_bf16 v34, v117, v82
  v_dot2c_f32_bf16 v35, v117, v83
  v_dot2c_f32_bf16 v36, v118, v82
  v_dot2c_f32_bf16 v37, v118, v83
  v_dot2c_f32_bf16 v38, v119, v82
  v_dot2c_f32_bf16 v39, v119, v83
  global_load_dwordx4 v[96:99], v5, s[40:41] offset:0 nt
  global_load_dwordx4 v[100:103], v5, s[40:41] offset:128 nt
  global_load_dwordx4 v[104:107], v5, s[40:41] offset:256 nt
  global_load_dwordx4 v[108:111], v5, s[40:41] offset:3072 nt
  global_load_dwordx4 v[112:115], v5, s[40:41] offset:3200 nt
  global_load_dwordx4 v[116:119], v5, s[40:41] offset:3328 nt
  s_add_u32 s40, s40, 6144
  s_addc_u32 s41, s41, 0
  s_waitcnt vmcnt(30)
  v_and_b32 v80, 0xffff, v47
  v_lshlrev_b32 v81, 16, v47
  v_lshrrev_b32 v82, 16, v47
  v_and_b32 v83, 0xffff0000, v47
  v_dot2c_f32_bf16 v16, v120, v80
  v_dot2c_f32_bf16 v17, v120, v81
  v_dot2c_f32_bf16 v18, v121, v80
  v_dot2c_f32_bf16 v19, v121, v81
  v_dot2c_f32_bf16 v20, v122, v80
  v_dot2c_f32_bf16 v21, v122, v81
  v_dot2c_f32_bf16 v22, v123, v80
  v_dot2c_f32_bf16 v23, v123, v81
  v_dot2c_f32_bf16 v24, v124, v80
  v_dot2c_f32_bf16 v25, v124, v81
  v_dot2c_f32_bf16 v26, v125, v80
  v_dot2c_f32_bf16 v27, v125, v81
  v_dot2c_f32_bf16 v28, v126, v80
  v_dot2c_f32_bf16 v29, v126, v81
  v_dot2c_f32_bf16 v30, v127, v80
  v_dot2c_f32_bf16 v31, v127, v81
  v_dot2c_f32_bf16 v32, v128, v80
  v_dot2c_f32_bf16 v33, v128, v81
  v_dot2c_f32_bf16 v34, v129, v80
  v_dot2c_f32_bf16 v35, v129, v81
  v_dot2c_f32_bf16 v36, v130, v80
  v_dot2c_f32_bf16 v37, v130, v81
  v_dot2c_f32_bf16 v38, v131, v80
  v_dot2c_f32_bf16 v39, v131, v81
  v_dot2c_f32_bf16 v16, v132, v82
  v_dot2c_f32_bf16 v17, v132, v83
  v_dot2c_f32_bf16 v18, v133, v82
  v_dot2c_f32_bf16 v19, v133, v83
  v_dot2c_f32_bf16 v20, v134, v82
  v_dot2c_f32_bf16 v21, v134, v83
  v_dot2c_f32_bf16 v22, v135, v82
  v_dot2c_f32_bf16 v23, v135, v83
  v_dot2c_f32_bf16 v24, v136, v82
  v_dot2c_f32_bf16 v25, v136, v83
  v_dot2c_f32_bf16 v26, v137, v82
  v_dot2c_f32_bf16 v27, v137, v83
  v_dot2c_f32_bf16 v28, v138, v82
  v_dot2c_f32_bf16 v29, v138, v83
  v_dot2c_f32_bf16 v30, v139, v82
  v_dot2c_f32_bf16 v31, v139, v83
  v_dot2c_f32_bf16 v32, v140, v82
  v_dot2c_f32_bf16 v33, v140, v83
  v_dot2c_f32_bf16 v34, v141, v82
  v_dot2c_f32_bf16 v35, v141, v83
  v_dot2c_f32_bf16 v36, v142, v82
  v_dot2c_f32_bf16 v37, v142, v83
  v_dot2c_f32_bf16 v38, v143, v82
  v_dot2c_f32_bf16 v39, v143, v83
  global_load_dwordx4 v[120:123], v5, s[40:41] offset:0 nt
  global_load_dwordx4 v[124:127], v5, s[40:41] offset:128 nt
  global_load_dwordx4 v[128:131], v5, s[40:41] offset:256 nt
  global_load_dwordx4 v[132:135], v5, s[40:41] offset:3072 nt
  global_load_dwordx4 v[136:139], v5, s[40:41] offset:3200 nt
  global_load_dwordx4 v[140:143], v5, s[40:41] offset:3328 nt
  s_add_u32 s40, s40, 6144
  s_addc_u32 s41, s41, 0
  s_waitcnt vmcnt(30)
  v_and_b32 v80, 0xffff, v48
  v_lshlrev_b32 v81, 16, v48
  v_lshrrev_b32 v82, 16, v48
  v_and_b32 v83, 0xffff0000, v48
  v_dot2c_f32_bf16 v16, v192, v80
  v_dot2c_f32_bf16 v17, v192, v81
  v_dot2c_f32_bf16 v18, v193, v80
  v_dot2c_f32_bf16 v19, v193, v81
  v_dot2c_f32_bf16 v20, v194, v80
  v_dot2c_f32_bf16 v21, v194, v81
  v_dot2c_f32_bf16 v22, v195, v80
  v_dot2c_f32_bf16 v23, v195, v81
  v_dot2c_f32_bf16 v24, v196, v80
  v_dot2c_f32_bf16 v25, v196, v81
  v_dot2c_f32_bf16 v26, v197, v80
  v_dot2c_f32_bf16 v27, v197, v81
  v_dot2c_f32_bf16 v28, v198, v80
  v_dot2c_f32_bf16 v29, v198, v81
  v_dot2c_f32_bf16 v30, v199, v80
  v_dot2c_f32_bf16 v31, v199, v81
  v_dot2c_f32_bf16 v32, v200, v80
  v_dot2c_f32_bf16 v33, v200, v81
  v_dot2c_f32_bf16 v34, v201, v80
  v_dot2c_f32_bf16 v35, v201, v81
  v_dot2c_f32_bf16 v36, v202, v80
  v_dot2c_f32_bf16 v37, v202, v81
  v_dot2c_f32_bf16 v38, v203, v80
  v_dot2c_f32_bf16 v39, v203, v81
  v_dot2c_f32_bf16 v16, v204, v82
  v_dot2c_f32_bf16 v17, v204, v83
  v_dot2c_f32_bf16 v18, v205, v82
  v_dot2c_f32_bf16 v19, v205, v83
  v_dot2c_f32_bf16 v20, v206, v82
  v_dot2c_f32_bf16 v21, v206, v83
  v_dot2c_f32_bf16 v22, v207, v82
  v_dot2c_f32_bf16 v23, v207, v83
  v_dot2c_f32_bf16 v24, v208, v82
  v_dot2c_f32_bf16 v25, v208, v83
  v_dot2c_f32_bf16 v26, v209, v82
  v_dot2c_f32_bf16 v27, v209, v83
  v_dot2c_f32_bf16 v28, v210, v82
  v_dot2c_f32_bf16 v29, v210, v83
  v_dot2c_f32_bf16 v30, v211, v82
  v_dot2c_f32_bf16 v31, v211, v83
  v_dot2c_f32_bf16 v32, v212, v82
  v_dot2c_f32_bf16 v33, v212, v83
  v_dot2c_f32_bf16 v34, v213, v82
  v_dot2c_f32_bf16 v35, v213, v83
  v_dot2c_f32_bf16 v36, v214, v82
  v_dot2c_f32_bf16 v37, v214, v83
  v_dot2c_f32_bf16 v38, v215, v82
  v_dot2c_f32_bf16 v39, v215, v83
  global_load_dwordx4 v[192:195], v5, s[40:41] offset:0 nt
  global_load_dwordx4 v[196:199], v5, s[40:41] offset:128 nt
  global_load_dwordx4 v[200:203], v5, s[40:41] offset:256 nt
  global_load_dwordx4 v[204:207], v5, s[40:41] offset:3072 nt
  global_load_dwordx4 v[208:211], v5, s[40:41] offset:3200 nt
  global_load_dwordx4 v[212:215], v5, s[40:41] offset:3328 nt
  s_add_u32 s40, s40, 6144
  s_addc_u32 s41, s41, 0
  s_waitcnt vmcnt(30)
  v_and_b32 v80, 0xffff, v49
  v_lshlrev_b32 v81, 16, v49
  v_lshrrev_b32 v82, 16, v49
  v_and_b32 v83, 0xffff0000, v49
  v_dot2c_f32_bf16 v16, v216, v80
  v_dot2c_f32_bf16 v17, v216, v81
  v_dot2c_f32_bf16 v18, v217, v80
  v_dot2c_f32_bf16 v19, v217, v81
  v_dot2c_f32_bf16 v20, v218, v80
  v_dot2c_f32_bf16 v21, v218, v81
  v_dot2c_f32_bf16 v22, v219, v80
  v_dot2c_f32_bf16 v23, v219, v81
  v_dot2c_f32_bf16 v24, v220, v80
  v_dot2c_f32_bf16 v25, v220, v81
  v_dot2c_f32_bf16 v26, v221, v80
  v_dot2c_f32_bf16 v27, v221, v81
  v_dot2c_f32_bf16 v28, v222, v80
  v_dot2c_f32_bf16 v29, v222, v81
  v_dot2c_f32_bf16 v30, v223, v80
  v_dot2c_f32_bf16 v31, v223, v81
  v_dot2c_f32_bf16 v32, v224, v80
  v_dot2c_f32_bf16 v33, v224, v81
  v_dot2c_f32_bf16 v34, v225, v80
  v_dot2c_f32_bf16 v35, v225, v81
  v_dot2c_f32_bf16 v36, v226, v80
  v_dot2c_f32_bf16 v37, v226, v81
  v_dot2c_f32_bf16 v38, v227, v80
  v_dot2c_f32_bf16 v39, v227, v81
  v_dot2c_f32_bf16 v16, v228, v82
  v_dot2c_f32_bf16 v17, v228, v83
  v_dot2c_f32_bf16 v18, v229, v82
  v_dot2c_f32_bf16 v19, v229, v83
  v_dot2c_f32_bf16 v20, v230, v82
  v_dot2c_f32_bf16 v21, v230, v83
  v_dot2c_f32_bf16 v22, v231, v82
  v_dot2c_f32_bf16 v23, v231, v83
  v_dot2c_f32_bf16 v24, v232, v82
  v_dot2c_f32_bf16 v25, v232, v83
  v_dot2c_f32_bf16 v26, v233, v82
  v_dot2c_f32_bf16 v27, v233, v83
  v_dot2c_f32_bf16 v28, v234, v82
  v_dot2c_f32_bf16 v29, v234, v83
  v_dot2c_f32_bf16 v30, v235, v82
  v_dot2c_f32_bf16 v31, v235, v83
  v_dot2c_f32_bf16 v32, v236, v82
  v_dot2c_f32_bf16 v33, v236, v83
  v_dot2c_f32_bf16 v34, v237, v82
  v_dot2c_f32_bf16 v35, v237, v83
  v_dot2c_f32_bf16 v36, v238, v82
  v_dot2c_f32_bf16 v37, v238, v83
  v_dot2c_f32_bf16 v38, v239, v82
  v_dot2c_f32_bf16 v39, v239, v83
  global_load_dwordx4 v[216:219], v5, s[40:41] offset:0 nt
  global_load_dwordx4 v[220:223], v5, s[40:41] offset:128 nt
  global_load_dwordx4 v[224:227], v5, s[40:41] offset:256 nt
  global_load_dwordx4 v[228:231], v5, s[40:41] offset:3072 nt
  global_load_dwordx4 v[232:235], v5, s[40:41] offset:3200 nt
  global_load_dwordx4 v[236:239], v5, s[40:41] offset:3328 nt
  s_add_u32 s40, s40, 6144
  s_addc_u32 s41, s41, 0
  s_waitcnt vmcnt(30)
  v_and_b32 v80, 0xffff, v50
  v_lshlrev_b32 v81, 16, v50
  v_lshrrev_b32 v82, 16, v50
  v_and_b32 v83, 0xffff0000, v50
  v_dot2c_f32_bf16 v16, v144, v80
  v_dot2c_f32_bf16 v17, v144, v81
  v_dot2c_f32_bf16 v18, v145, v80
  v_dot2c_f32_bf16 v19, v145, v81
  v_dot2c_f32_bf16 v20, v146, v80
  v_dot2c_f32_bf16 v21, v146, v81
  v_dot2c_f32_bf16 v22, v147, v80
  v_dot2c_f32_bf16 v23, v147, v81
  v_dot2c_f32_bf16 v24, v148, v80
  v_dot2c_f32_bf16 v25, v148, v81
  v_dot2c_f32_bf16 v26, v149, v80
  v_dot2c_f32_bf16 v27, v149, v81
  v_dot2c_f32_bf16 v28, v150, v80
  v_dot2c_f32_bf16 v29, v150, v81
  v_dot2c_f32_bf16 v30, v151, v80
  v_dot2c_f32_bf16 v31, v151, v81
  v_dot2c_f32_bf16 v32, v152, v80
  v_dot2c_f32_bf16 v33, v152, v81
  v_dot2c_f32_bf16 v34, v153, v80
  v_dot2c_f32_bf16 v35, v153, v81
  v_dot2c_f32_bf16 v36, v154, v80
  v_dot2c_f32_bf16 v37, v154, v81
  v_dot2c_f32_bf16 v38, v155, v80
  v_dot2c_f32_bf16 v39, v155, v81
  v_dot2c_f32_bf16 v16, v156, v82
  v_dot2c_f32_bf16 v17, v156, v83
  v_dot2c_f32_bf16 v18, v157, v82
  v_dot2c_f32_bf16 v19, v157, v83
  v_dot2c_f32_bf16 v20, v158, v82
  v_dot2c_f32_bf16 v21, v158, v83
  v_dot2c_f32_bf16 v22, v159, v82
  v_dot2c_f32_bf16 v23, v159, v83
  v_dot2c_f32_bf16 v24, v160, v82
  v_dot2c_f32_bf16 v25, v160, v83
  v_dot2c_f32_bf16 v26, v161, v82
  v_dot2c_f32_bf16 v27, v161, v83
  v_dot2c_f32_bf16 v28, v162, v82
  v_dot2c_f32_bf16 v29, v162, v83
  v_dot2c_f32_bf16 v30, v163, v82
  v_dot2c_f32_bf16 v31, v163, v83
  v_dot2c_f32_bf16 v32, v164, v82
  v_dot2c_f32_bf16 v33, v164, v83
  v_dot2c_f32_bf16 v34, v165, v82
  v_dot2c_f32_bf16 v35, v165, v83
  v_dot2c_f32_bf16 v36, v166, v82
  v_dot2c_f32_bf16 v37, v166, v83
  v_dot2c_f32_bf16 v38, v167, v82
  v_dot2c_f32_bf16 v39, v167, v83
  s_add_u32 s46, s42, 0
  s_addc_u32 s47, s43, 0
  global_load_dwordx4 v[144:147], v6, s[46:47]
  s_add_u32 s46, s46, 10240
  s_addc_u32 s47, s47, 0
  global_load_dwordx4 v[148:151], v6, s[46:47]
  s_add_u32 s46, s46, 10240
  s_addc_u32 s47, s47, 0
  global_load_dwordx4 v[152:155], v6, s[46:47]
  s_add_u32 s46, s46, 10240
  s_addc_u32 s47, s47, 0
  global_load_dwordx4 v[156:159], v6, s[46:47]
  s_add_u32 s46, s46, 10240
  s_addc_u32 s47, s47, 0
  global_load_dwordx4 v[160:163], v6, s[46:47]
  s_add_u32 s46, s46, 10240
  s_addc_u32 s47, s47, 0
  global_load_dwordx4 v[164:167], v6, s[46:47]
  s_add_u32 s46, s46, 10240
  s_addc_u32 s47, s47, 0
  s_waitcnt vmcnt(30)
  v_and_b32 v80, 0xffff, v51
  v_lshlrev_b32 v81, 16, v51
  v_lshrrev_b32 v82, 16, v51
  v_and_b32 v83, 0xffff0000, v51
  v_dot2c_f32_bf16 v16, v168, v80
  v_dot2c_f32_bf16 v17, v168, v81
  v_dot2c_f32_bf16 v18, v169, v80
  v_dot2c_f32_bf16 v19, v169, v81
  v_dot2c_f32_bf16 v20, v170, v80
  v_dot2c_f32_bf16 v21, v170, v81
  v_dot2c_f32_bf16 v22, v171, v80
  v_dot2c_f32_bf16 v23, v171, v81
  v_dot2c_f32_bf16 v24, v172, v80
  v_dot2c_f32_bf16 v25, v172, v81
  v_dot2c_f32_bf16 v26, v173, v80
  v_dot2c_f32_bf16 v27, v173, v81
  v_dot2c_f32_bf16 v28, v174, v80
  v_dot2c_f32_bf16 v29, v174, v81
  v_dot2c_f32_bf16 v30, v175, v80
  v_dot2c_f32_bf16 v31, v175, v81
  v_dot2c_f32_bf16 v32, v176, v80
  v_dot2c_f32_bf16 v33, v176, v81
  v_dot2c_f32_bf16 v34, v177, v80
  v_dot2c_f32_bf16 v35, v177, v81
  v_dot2c_f32_bf16 v36, v178, v80
  v_dot2c_f32_bf16 v37, v178, v81
  v_dot2c_f32_bf16 v38, v179, v80
  v_dot2c_f32_bf16 v39, v179, v81
  v_dot2c_f32_bf16 v16, v180, v82
  v_dot2c_f32_bf16 v17, v180, v83
  v_dot2c_f32_bf16 v18, v181, v82
  v_dot2c_f32_bf16 v19, v181, v83
  v_dot2c_f32_bf16 v20, v182, v82
  v_dot2c_f32_bf16 v21, v182, v83
  v_dot2c_f32_bf16 v22, v183, v82
  v_dot2c_f32_bf16 v23, v183, v83
  v_dot2c_f32_bf16 v24, v184, v82
  v_dot2c_f32_bf16 v25, v184, v83
  v_dot2c_f32_bf16 v26, v185, v82
  v_dot2c_f32_bf16 v27, v185, v83
  v_dot2c_f32_bf16 v28, v186, v82
  v_dot2c_f32_bf16 v29, v186, v83
  v_dot2c_f32_bf16 v30, v187, v82
  v_dot2c_f32_bf16 v31, v187, v83
  v_dot2c_f32_bf16 v32, v188, v82
  v_dot2c_f32_bf16 v33, v188, v83
  v_dot2c_f32_bf16 v34, v189, v82
  v_dot2c_f32_bf16 v35, v189, v83
  v_dot2c_f32_bf16 v36, v190, v82
  v_dot2c_f32_bf16 v37, v190, v83
  v_dot2c_f32_bf16 v38, v191, v82
  v_dot2c_f32_bf16 v39, v191, v83
  global_load_dwordx4 v[168:171], v6, s[46:47]
  s_add_u32 s46, s46, 10240
  s_addc_u32 s47, s47, 0
  global_load_dwordx4 v[172:175], v6, s[46:47]
  s_add_u32 s46, s46, 10240
  s_addc_u32 s47, s47, 0
  global_load_dwordx4 v[176:179], v6, s[46:47]
  s_add_u32 s46, s46, 10240
  s_addc_u32 s47, s47, 0
  global_load_dwordx4 v[180:183], v6, s[46:47]
  s_add_u32 s46, s46, 10240
  s_addc_u32 s47, s47, 0
  global_load_dwordx4 v[184:187], v6, s[46:47]
  s_add_u32 s46, s46, 10240
  s_addc_u32 s47, s47, 0
  global_load_dwordx4 v[188:191], v6, s[46:47]
  s_add_u32 s46, s46, 10240
  s_addc_u32 s47, s47, 0
  s_waitcnt vmcnt(30)
  v_and_b32 v80, 0xffff, v52
  v_lshlrev_b32 v81, 16, v52
  v_lshrrev_b32 v82, 16, v52
  v_and_b32 v83, 0xffff0000, v52
  v_dot2c_f32_bf16 v16, v96, v80
  v_dot2c_f32_bf16 v17, v96, v81
  v_dot2c_f32_bf16 v18, v97, v80
  v_dot2c_f32_bf16 v19, v97, v81
  v_dot2c_f32_bf16 v20, v98, v80
  v_dot2c_f32_bf16 v21, v98, v81
  v_dot2c_f32_bf16 v22, v99, v80
  v_dot2c_f32_bf16 v23, v99, v81
  v_dot2c_f32_bf16 v24, v100, v80
  v_dot2c_f32_bf16 v25, v100, v81
  v_dot2c_f32_bf16 v26, v101, v80
  v_dot2c_f32_bf16 v27, v101, v81
  v_dot2c_f32_bf16 v28, v102, v80
  v_dot2c_f32_bf16 v29, v102, v81
  v_dot2c_f32_bf16 v30, v103, v80
  v_dot2c_f32_bf16 v31, v103, v81
  v_dot2c_f32_bf16 v32, v104, v80
  v_dot2c_f32_bf16 v33, v104, v81
  v_dot2c_f32_bf16 v34, v105, v80
  v_dot2c_f32_bf16 v35, v105, v81
  v_dot2c_f32_bf16 v36, v106, v80
  v_dot2c_f32_bf16 v37, v106, v81
  v_dot2c_f32_bf16 v38, v107, v80
  v_dot2c_f32_bf16 v39, v107, v81
  v_dot2c_f32_bf16 v16, v108, v82
  v_dot2c_f32_bf16 v17, v108, v83
  v_dot2c_f32_bf16 v18, v109, v82
  v_dot2c_f32_bf16 v19, v109, v83
  v_dot2c_f32_bf16 v20, v110, v82
  v_dot2c_f32_bf16 v21, v110, v83
  v_dot2c_f32_bf16 v22, v111, v82
  v_dot2c_f32_bf16 v23, v111, v83
  v_dot2c_f32_bf16 v24, v112, v82
  v_dot2c_f32_bf16 v25, v112, v83
  v_dot2c_f32_bf16 v26, v113, v82
  v_dot2c_f32_bf16 v27, v113, v83
  v_dot2c_f32_bf16 v28, v114, v82
  v_dot2c_f32_bf16 v29, v114, v83
  v_dot2c_f32_bf16 v30, v115, v82
  v_dot2c_f32_bf16 v31, v115, v83
  v_dot2c_f32_bf16 v32, v116, v82
  v_dot2c_f32_bf16 v33, v116, v83
  v_dot2c_f32_bf16 v34, v117, v82
  v_dot2c_f32_bf16 v35, v117, v83
  v_dot2c_f32_bf16 v36, v118, v82
  v_dot2c_f32_bf16 v37, v118, v83
  v_dot2c_f32_bf16 v38, v119, v82
  v_dot2c_f32_bf16 v39, v119, v83
  global_load_dwordx4 v[96:99], v6, s[46:47]
  s_add_u32 s46, s46, 10240
  s_addc_u32 s47, s47, 0
  global_load_dwordx4 v[100:103], v6, s[46:47]
  s_add_u32 s46, s46, 10240
  s_addc_u32 s47, s47, 0
  global_load_dwordx4 v[104:107], v6, s[46:47]
  s_add_u32 s46, s46, 10240
  s_addc_u32 s47, s47, 0
  global_load_dwordx4 v[108:111], v6, s[46:47]
  s_add_u32 s46, s46, 10240
  s_addc_u32 s47, s47, 0
  global_load_dwordx4 v[112:115], v6, s[46:47]
  s_add_u32 s46, s46, 10240
  s_addc_u32 s47, s47, 0
  global_load_dwordx4 v[116:119], v6, s[46:47]
  s_add_u32 s46, s46, 10240
  s_addc_u32 s47, s47, 0
  s_waitcnt vmcnt(30)
  v_and_b32 v80, 0xffff, v53
  v_lshlrev_b32 v81, 16, v53
  v_lshrrev_b32 v82, 16, v53
  v_and_b32 v83, 0xffff0000, v53
  v_dot2c_f32_bf16 v16, v120, v80
  v_dot2c_f32_bf16 v17, v120, v81
  v_dot2c_f32_bf16 v18, v121, v80
  v_dot2c_f32_bf16 v19, v121, v81
  v_dot2c_f32_bf16 v20, v122, v80
  v_dot2c_f32_bf16 v21, v122, v81
  v_dot2c_f32_bf16 v22, v123, v80
  v_dot2c_f32_bf16 v23, v123, v81
  v_dot2c_f32_bf16 v24, v124, v80
  v_dot2c_f32_bf16 v25, v124, v81
  v_dot2c_f32_bf16 v26, v125, v80
  v_dot2c_f32_bf16 v27, v125, v81
  v_dot2c_f32_bf16 v28, v126, v80
  v_dot2c_f32_bf16 v29, v126, v81
  v_dot2c_f32_bf16 v30, v127, v80
  v_dot2c_f32_bf16 v31, v127, v81
  v_dot2c_f32_bf16 v32, v128, v80
  v_dot2c_f32_bf16 v33, v128, v81
  v_dot2c_f32_bf16 v34, v129, v80
  v_dot2c_f32_bf16 v35, v129, v81
  v_dot2c_f32_bf16 v36, v130, v80
  v_dot2c_f32_bf16 v37, v130, v81
  v_dot2c_f32_bf16 v38, v131, v80
  v_dot2c_f32_bf16 v39, v131, v81
  v_dot2c_f32_bf16 v16, v132, v82
  v_dot2c_f32_bf16 v17, v132, v83
  v_dot2c_f32_bf16 v18, v133, v82
  v_dot2c_f32_bf16 v19, v133, v83
  v_dot2c_f32_bf16 v20, v134, v82
  v_dot2c_f32_bf16 v21, v134, v83
  v_dot2c_f32_bf16 v22, v135, v82
  v_dot2c_f32_bf16 v23, v135, v83
  v_dot2c_f32_bf16 v24, v136, v82
  v_dot2c_f32_bf16 v25, v136, v83
  v_dot2c_f32_bf16 v26, v137, v82
  v_dot2c_f32_bf16 v27, v137, v83
  v_dot2c_f32_bf16 v28, v138, v82
  v_dot2c_f32_bf16 v29, v138, v83
  v_dot2c_f32_bf16 v30, v139, v82
  v_dot2c_f32_bf16 v31, v139, v83
  v_dot2c_f32_bf16 v32, v140, v82
  v_dot2c_f32_bf16 v33, v140, v83
  v_dot2c_f32_bf16 v34, v141, v82
  v_dot2c_f32_bf16 v35, v141, v83
  v_dot2c_f32_bf16 v36, v142, v82
  v_dot2c_f32_bf16 v37, v142, v83
  v_dot2c_f32_bf16 v38, v143, v82
  v_dot2c_f32_bf16 v39, v143, v83
  global_load_dwordx4 v[120:123], v6, s[46:47]
  s_add_u32 s46, s46, 10240
  s_addc_u32 s47, s47, 0
  global_load_dwordx4 v[124:127], v6, s[46:47]
  s_add_u32 s46, s46, 10240
  s_addc_u32 s47, s47, 0
  global_load_dwordx4 v[128:131], v6, s[46:47]
  s_add_u32 s46, s46, 10240
  s_addc_u32 s47, s47, 0
  global_load_dwordx4 v[132:135], v6, s[46:47]
  s_add_u32 s46, s46, 10240
  s_addc_u32 s47, s47, 0
  global_load_dwordx4 v[136:139], v6, s[46:47]
  s_add_u32 s46, s46, 10240
  s_addc_u32 s47, s47, 0
  global_load_dwordx4 v[140:143], v6, s[46:47]
  s_add_u32 s46, s46, 10240
  s_addc_u32 s47, s47, 0
  s_waitcnt vmcnt(30)
  v_and_b32 v80, 0xffff, v54
  v_lshlrev_b32 v81, 16, v54
  v_lshrrev_b32 v82, 16, v54
  v_and_b32 v83, 0xffff0000, v54
  v_dot2c_f32_bf16 v16, v192, v80
  v_dot2c_f32_bf16 v17, v192, v81
  v_dot2c_f32_bf16 v18, v193, v80
  v_dot2c_f32_bf16 v19, v193, v81
  v_dot2c_f32_bf16 v20, v194, v80
  v_dot2c_f32_bf16 v21, v194, v81
  v_dot2c_f32_bf16 v22, v195, v80
  v_dot2c_f32_bf16 v23, v195, v81
  v_dot2c_f32_bf16 v24, v196, v80
  v_dot2c_f32_bf16 v25, v196, v81
  v_dot2c_f32_bf16 v26, v197, v80
  v_dot2c_f32_bf16 v27, v197, v81
  v_dot2c_f32_bf16 v28, v198, v80
  v_dot2c_f32_bf16 v29, v198, v81
  v_dot2c_f32_bf16 v30, v199, v80
  v_dot2c_f32_bf16 v31, v199, v81
  v_dot2c_f32_bf16 v32, v200, v80
  v_dot2c_f32_bf16 v33, v200, v81
  v_dot2c_f32_bf16 v34, v201, v80
  v_dot2c_f32_bf16 v35, v201, v81
  v_dot2c_f32_bf16 v36, v202, v80
  v_dot2c_f32_bf16 v37, v202, v81
  v_dot2c_f32_bf16 v38, v203, v80
  v_dot2c_f32_bf16 v39, v203, v81
  v_dot2c_f32_bf16 v16, v204, v82
  v_dot2c_f32_bf16 v17, v204, v83
  v_dot2c_f32_bf16 v18, v205, v82
  v_dot2c_f32_bf16 v19, v205, v83
  v_dot2c_f32_bf16 v20, v206, v82
  v_dot2c_f32_bf16 v21, v206, v83
  v_dot2c_f32_bf16 v22, v207, v82
  v_dot2c_f32_bf16 v23, v207, v83
  v_dot2c_f32_bf16 v24, v208, v82
  v_dot2c_f32_bf16 v25, v208, v83
  v_dot2c_f32_bf16 v26, v209, v82
  v_dot2c_f32_bf16 v27, v209, v83
  v_dot2c_f32_bf16 v28, v210, v82
  v_dot2c_f32_bf16 v29, v210, v83
  v_dot2c_f32_bf16 v30, v211, v82
  v_dot2c_f32_bf16 v31, v211, v83
  v_dot2c_f32_bf16 v32, v212, v82
  v_dot2c_f32_bf16 v33, v212, v83
  v_dot2c_f32_bf16 v34, v213, v82
  v_dot2c_f32_bf16 v35, v213, v83
  v_dot2c_f32_bf16 v36, v214, v82
  v_dot2c_f32_bf16 v37, v214, v83
  v_dot2c_f32_bf16 v38, v215, v82
  v_dot2c_f32_bf16 v39, v215, v83
  s_add_u32 s46, s42, 512
  s_addc_u32 s47, s43, 0
  global_load_dwordx4 v[192:195], v6, s[46:47]
  s_add_u32 s46, s46, 10240
  s_addc_u32 s47, s47, 0
  global_load_dwordx4 v[196:199], v6, s[46:47]
  s_add_u32 s46, s46, 10240
  s_addc_u32 s47, s47, 0
  global_load_dwordx4 v[200:203], v6, s[46:47]
  s_add_u32 s46, s46, 10240
  s_addc_u32 s47, s47, 0
  global_load_dwordx4 v[204:207], v6, s[46:47]
  s_add_u32 s46, s46, 10240
  s_addc_u32 s47, s47, 0
  global_load_dwordx4 v[208:211], v6, s[46:47]
  s_add_u32 s46, s46, 10240
  s_addc_u32 s47, s47, 0
  global_load_dwordx4 v[212:215], v6, s[46:47]
  s_add_u32 s46, s46, 10240
  s_addc_u32 s47, s47, 0
  s_waitcnt vmcnt(30)
  v_and_b32 v80, 0xffff, v55
  v_lshlrev_b32 v81, 16, v55
  v_lshrrev_b32 v82, 16, v55
  v_and_b32 v83, 0xffff0000, v55
  v_dot2c_f32_bf16 v16, v216, v80
  v_dot2c_f32_bf16 v17, v216, v81
  v_dot2c_f32_bf16 v18, v217, v80
  v_dot2c_f32_bf16 v19, v217, v81
  v_dot2c_f32_bf16 v20, v218, v80
  v_dot2c_f32_bf16 v21, v218, v81
  v_dot2c_f32_bf16 v22, v219, v80
  v_dot2c_f32_bf16 v23, v219, v81
  v_dot2c_f32_bf16 v24, v220, v80
  v_dot2c_f32_bf16 v25, v220, v81
  v_dot2c_f32_bf16 v26, v221, v80
  v_dot2c_f32_bf16 v27, v221, v81
  v_dot2c_f32_bf16 v28, v222, v80
  v_dot2c_f32_bf16 v29, v222, v81
  v_dot2c_f32_bf16 v30, v223, v80
  v_dot2c_f32_bf16 v31, v223, v81
  v_dot2c_f32_bf16 v32, v224, v80
  v_dot2c_f32_bf16 v33, v224, v81
  v_dot2c_f32_bf16 v34, v225, v80
  v_dot2c_f32_bf16 v35, v225, v81
  v_dot2c_f32_bf16 v36, v226, v80
  v_dot2c_f32_bf16 v37, v226, v81
  v_dot2c_f32_bf16 v38, v227, v80
  v_dot2c_f32_bf16 v39, v227, v81
  v_dot2c_f32_bf16 v16, v228, v82
  v_dot2c_f32_bf16 v17, v228, v83
  v_dot2c_f32_bf16 v18, v229, v82
  v_dot2c_f32_bf16 v19, v229, v83
  v_dot2c_f32_bf16 v20, v230, v82
  v_dot2c_f32_bf16 v21, v230, v83
  v_dot2c_f32_bf16 v22, v231, v82
  v_dot2c_f32_bf16 v23, v231, v83
  v_dot2c_f32_bf16 v24, v232, v82
  v_dot2c_f32_bf16 v25, v232, v83
  v_dot2c_f32_bf16 v26, v233, v82
  v_dot2c_f32_bf16 v27, v233, v83
  v_dot2c_f32_bf16 v28, v234, v82
  v_dot2c_f32_bf16 v29, v234, v83
  v_dot2c_f32_bf16 v30, v235, v82
  v_dot2c_f32_bf16 v31, v235, v83
  v_dot2c_f32_bf16 v32, v236, v82
  v_dot2c_f32_bf16 v33, v236, v83
  v_dot2c_f32_bf16 v34, v237, v82
  v_dot2c_f32_bf16 v35, v237, v83
  v_dot2c_f32_bf16 v36, v238, v82
  v_dot2c_f32_bf16 v37, v238, v83
  v_dot2c_f32_bf16 v38, v239, v82
  v_dot2c_f32_bf16 v39, v239, v83
  global_load_dwordx4 v[216:219], v6, s[46:47]
  s_add_u32 s46, s46, 10240
  s_addc_u32 s47, s47, 0
  global_load_dwordx4 v[220:223], v6, s[46:47]
  s_add_u32 s46, s46, 10240
  s_addc_u32 s47, s47, 0
  global_load_dwordx4 v[224:227], v6, s[46:47]
  s_add_u32 s46, s46, 10240
  s_addc_u32 s47, s47, 0
  global_load_dwordx4 v[228:231], v6, s[46:47]
  s_add_u32 s46, s46, 10240
  s_addc_u32 s47, s47, 0
  global_load_dwordx4 v[232:235], v6, s[46:47]
  s_add_u32 s46, s46, 10240
  s_addc_u32 s47, s47, 0
  global_load_dwordx4 v[236:239], v6, s[46:47]
  s_add_u32 s46, s46, 10240
  s_addc_u32 s47, s47, 0
  s_nop 3
  v_add_f32_dpp v16, v16, v16 row_ror:8 row_mask:0xf bank_mask:0xf
  v_add_f32_dpp v17, v17, v17 row_ror:8 row_mask:0xf bank_mask:0xf
  v_add_f32_dpp v18, v18, v18 row_ror:8 row_mask:0xf bank_mask:0xf
  v_add_f32_dpp v19, v19, v19 row_ror:8 row_mask:0xf bank_mask:0xf
  v_add_f32_dpp v20, v20, v20 row_ror:8 row_mask:0xf bank_mask:0xf
  v_add_f32_dpp v21, v21, v21 row_ror:8 row_mask:0xf bank_mask:0xf
  v_add_f32_dpp v22, v22, v22 row_ror:8 row_mask:0xf bank_mask:0xf
  v_add_f32_dpp v23, v23, v23 row_ror:8 row_mask:0xf bank_mask:0xf
  v_add_f32_dpp v24, v24, v24 row_ror:8 row_mask:0xf bank_mask:0xf
  v_add_f32_dpp v25, v25, v25 row_ror:8 row_mask:0xf bank_mask:0xf
  v_add_f32_dpp v26, v26, v26 row_ror:8 row_mask:0xf bank_mask:0xf
  v_add_f32_dpp v27, v27, v27 row_ror:8 row_mask:0xf bank_mask:0xf
  v_add_f32_dpp v28, v28, v28 row_ror:8 row_mask:0xf bank_mask:0xf
  v_add_f32_dpp v29, v29, v29 row_ror:8 row_mask:0xf bank_mask:0xf
  v_add_f32_dpp v30, v30, v30 row_ror:8 row_mask:0xf bank_mask:0xf
  v_add_f32_dpp v31, v31, v31 row_ror:8 row_mask:0xf bank_mask:0xf
  v_add_f32_dpp v32, v32, v32 row_ror:8 row_mask:0xf bank_mask:0xf
  v_add_f32_dpp v33, v33, v33 row_ror:8 row_mask:0xf bank_mask:0xf
  v_add_f32_dpp v34, v34, v34 row_ror:8 row_mask:0xf bank_mask:0xf
  v_add_f32_dpp v35, v35, v35 row_ror:8 row_mask:0xf bank_mask:0xf
  v_add_f32_dpp v36, v36, v36 row_ror:8 row_mask:0xf bank_mask:0xf
  v_add_f32_dpp v37, v37, v37 row_ror:8 row_mask:0xf bank_mask:0xf
  v_add_f32_dpp v38, v38, v38 row_ror:8 row_mask:0xf bank_mask:0xf
  v_add_f32_dpp v39, v39, v39 row_ror:8 row_mask:0xf bank_mask:0xf
  v_mov_b32 v80, v16
  v_mov_b32 v81, v17
  v_mov_b32 v82, v18
  v_mov_b32 v83, v19
  v_mov_b32 v84, v20
  v_mov_b32 v85, v21
  v_mov_b32 v86, v22
  v_mov_b32 v87, v23
  v_permlane16_swap_b32 v16, v80
  v_permlane16_swap_b32 v17, v81
  v_permlane16_swap_b32 v18, v82
  v_permlane16_swap_b32 v19, v83
  v_permlane16_swap_b32 v20, v84
  v_permlane16_swap_b32 v21, v85
  v_permlane16_swap_b32 v22, v86
  v_permlane16_swap_b32 v23, v87
  v_add_f32 v16, v16, v80
  v_add_f32 v17, v17, v81
  v_add_f32 v18, v18, v82
  v_add_f32 v19, v19, v83
  v_add_f32 v20, v20, v84
  v_add_f32 v21, v21, v85
  v_add_f32 v22, v22, v86
  v_add_f32 v23, v23, v87
  v_mov_b32 v80, v24
  v_mov_b32 v81, v25
  v_mov_b32 v82, v26
  v_mov_b32 v83, v27
  v_mov_b32 v84, v28
  v_mov_b32 v85, v29
  v_mov_b32 v86, v30
  v_mov_b32 v87, v31
  v_permlane16_swap_b32 v24, v80
  v_permlane16_swap_b32 v25, v81
  v_permlane16_swap_b32 v26, v82
  v_permlane16_swap_b32 v27, v83
  v_permlane16_swap_b32 v28, v84
  v_permlane16_swap_b32 v29, v85
  v_permlane16_swap_b32 v30, v86
  v_permlane16_swap_b32 v31, v87
  v_add_f32 v24, v24, v80
  v_add_f32 v25, v25, v81
  v_add_f32 v26, v26, v82
  v_add_f32 v27, v27, v83
  v_add_f32 v28, v28, v84
  v_add_f32 v29, v29, v85
  v_add_f32 v30, v30, v86
  v_add_f32 v31, v31, v87
  v_mov_b32 v80, v32
  v_mov_b32 v81, v33
  v_mov_b32 v82, v34
  v_mov_b32 v83, v35
  v_mov_b32 v84, v36
  v_mov_b32 v85, v37
  v_mov_b32 v86, v38
  v_mov_b32 v87, v39
  v_permlane16_swap_b32 v32, v80
  v_permlane16_swap_b32 v33, v81
  v_permlane16_swap_b32 v34, v82
  v_permlane16_swap_b32 v35, v83
  v_permlane16_swap_b32 v36, v84
  v_permlane16_swap_b32 v37, v85
  v_permlane16_swap_b32 v38, v86
  v_permlane16_swap_b32 v39, v87
  v_add_f32 v32, v32, v80
  v_add_f32 v33, v33, v81
  v_add_f32 v34, v34, v82
  v_add_f32 v35, v35, v83
  v_add_f32 v36, v36, v84
  v_add_f32 v37, v37, v85
  v_add_f32 v38, v38, v86
  v_add_f32 v39, v39, v87
  v_mov_b32 v80, v16
  v_mov_b32 v81, v17
  v_mov_b32 v82, v18
  v_mov_b32 v83, v19
  v_mov_b32 v84, v20
  v_mov_b32 v85, v21
  v_mov_b32 v86, v22
  v_mov_b32 v87, v23
  v_permlane32_swap_b32 v16, v80
  v_permlane32_swap_b32 v17, v81
  v_permlane32_swap_b32 v18, v82
  v_permlane32_swap_b32 v19, v83
  v_permlane32_swap_b32 v20, v84
  v_permlane32_swap_b32 v21, v85
  v_permlane32_swap_b32 v22, v86
  v_permlane32_swap_b32 v23, v87
  v_add_f32 v16, v16, v80
  v_add_f32 v17, v17, v81
  v_add_f32 v18, v18, v82
  v_add_f32 v19, v19, v83
  v_add_f32 v20, v20, v84
  v_add_f32 v21, v21, v85
  v_add_f32 v22, v22, v86
  v_add_f32 v23, v23, v87
  v_mov_b32 v80, v24
  v_mov_b32 v81, v25
  v_mov_b32 v82, v26
  v_mov_b32 v83, v27
  v_mov_b32 v84, v28
  v_mov_b32 v85, v29
  v_mov_b32 v86, v30
  v_mov_b32 v87, v31
  v_permlane32_swap_b32 v24, v80
  v_permlane32_swap_b32 v25, v81
  v_permlane32_swap_b32 v26, v82
  v_permlane32_swap_b32 v27, v83
  v_permlane32_swap_b32 v28, v84
  v_permlane32_swap_b32 v29, v85
  v_permlane32_swap_b32 v30, v86
  v_permlane32_swap_b32 v31, v87
  v_add_f32 v24, v24, v80
  v_add_f32 v25, v25, v81
  v_add_f32 v26, v26, v82
  v_add_f32 v27, v27, v83
  v_add_f32 v28, v28, v84
  v_add_f32 v29, v29, v85
  v_add_f32 v30, v30, v86
  v_add_f32 v31, v31, v87
  v_mov_b32 v80, v32
  v_mov_b32 v81, v33
  v_mov_b32 v82, v34
  v_mov_b32 v83, v35
  v_mov_b32 v84, v36
  v_mov_b32 v85, v37
  v_mov_b32 v86, v38
  v_mov_b32 v87, v39
  v_permlane32_swap_b32 v32, v80
  v_permlane32_swap_b32 v33, v81
  v_permlane32_swap_b32 v34, v82
  v_permlane32_swap_b32 v35, v83
  v_permlane32_swap_b32 v36, v84
  v_permlane32_swap_b32 v37, v85
  v_permlane32_swap_b32 v38, v86
  v_permlane32_swap_b32 v39, v87
  v_add_f32 v32, v32, v80
  v_add_f32 v33, v33, v81
  v_add_f32 v34, v34, v82
  v_add_f32 v35, v35, v83
  v_add_f32 v36, v36, v84
  v_add_f32 v37, v37, v85
  v_add_f32 v38, v38, v86
  v_add_f32 v39, v39, v87
  s_mov_b64 exec, 0xff
  ds_write_b128 v8, v[16:19] offset:4096
  ds_write_b128 v8, v[20:23] offset:4112
  ds_write_b128 v8, v[24:27] offset:4352
  ds_write_b128 v8, v[28:31] offset:4368
  ds_write_b128 v8, v[32:35] offset:4608
  ds_write_b128 v8, v[36:39] offset:4624
  s_mov_b64 exec, -1
  s_waitcnt lgkmcnt(0)
  s_barrier
  v_lshlrev_b32 v80, 2, v0
  v_cmp_gt_u32 vcc, 192, v0
  s_and_saveexec_b64 s[52:53], vcc
  ds_read_b32 v81, v80 offset:4096
  ds_read_b32 v82, v80 offset:4864
  ds_read_b32 v83, v80 offset:5632
  ds_read_b32 v84, v80 offset:6400
  s_waitcnt lgkmcnt(0)
  v_add_f32 v81, v81, v82
  v_add_f32 v83, v83, v84
  v_add_f32 v81, v81, v83
  ds_write_b32 v80, v81 offset:7168
  s_mov_b64 exec, s[52:53]
  s_waitcnt lgkmcnt(0)
  s_barrier
  ds_read_b32 v56, v10 offset:7168
  ds_read_b32 v57, v10 offset:7200
  ds_read_b32 v58, v10 offset:7232
  ds_read_b32 v59, v10 offset:7264
  ds_read_b32 v60, v10 offset:7296
  ds_read_b32 v61, v10 offset:7328
  ds_read_b32 v62, v10 offset:7360
  ds_read_b32 v63, v10 offset:7392
  ds_read_b32 v64, v10 offset:7424
  ds_read_b32 v65, v10 offset:7456
  ds_read_b32 v66, v10 offset:7488
  ds_read_b32 v67, v10 offset:7520
  ds_read_b32 v68, v10 offset:7552
  ds_read_b32 v69, v10 offset:7584
  ds_read_b32 v70, v10 offset:7616
  ds_read_b32 v71, v10 offset:7648
  ds_read_b32 v72, v10 offset:7680
  ds_read_b32 v73, v10 offset:7712
  ds_read_b32 v74, v10 offset:7744
  ds_read_b32 v75, v10 offset:7776
  ds_read_b32 v76, v10 offset:7808
  ds_read_b32 v77, v10 offset:7840
  ds_read_b32 v78, v10 offset:7872
  ds_read_b32 v79, v10 offset:7904
  v_mov_b32 v16, 0
  v_mov_b32 v17, 0
  v_mov_b32 v18, 0
  v_mov_b32 v19, 0
  v_mov_b32 v20, 0
  v_mov_b32 v21, 0
  v_mov_b32 v22, 0
  v_mov_b32 v23, 0
  v_mov_b32 v24, 0
  v_mov_b32 v25, 0
  v_mov_b32 v26, 0
  v_mov_b32 v27, 0
  v_mov_b32 v28, 0
  v_mov_b32 v29, 0
  v_mov_b32 v30, 0
  v_mov_b32 v31, 0
  v_mov_b32 v32, 0
  v_mov_b32 v33, 0
  v_mov_b32 v34, 0
  v_mov_b32 v35, 0
  v_mov_b32 v36, 0
  v_mov_b32 v37, 0
  v_mov_b32 v38, 0
  v_mov_b32 v39, 0
  s_waitcnt lgkmcnt(0)
  v_readfirstlane_b32 s48, v3
  s_nop 3
  s_cmp_ge_u32 s48, 2
  s_cbranch_scc1 L_att_b
  s_waitcnt vmcnt(30)
  v_cvt_pk_bf16_f32 v80, v56, 0
  v_cvt_pk_bf16_f32 v81, 0, v56
  v_dot2c_f32_bf16 v16, v144, v80
  v_dot2c_f32_bf16 v17, v144, v81
  v_dot2c_f32_bf16 v18, v145, v80
  v_dot2c_f32_bf16 v19, v145, v81
  v_dot2c_f32_bf16 v20, v146, v80
  v_dot2c_f32_bf16 v21, v146, v81
  v_dot2c_f32_bf16 v22, v147, v80
  v_dot2c_f32_bf16 v23, v147, v81
  v_cvt_pk_bf16_f32 v80, v57, 0
  v_cvt_pk_bf16_f32 v81, 0, v57
  v_dot2c_f32_bf16 v16, v148, v80
  v_dot2c_f32_bf16 v17, v148, v81
  v_dot2c_f32_bf16 v18, v149, v80
  v_dot2c_f32_bf16 v19, v149, v81
  v_dot2c_f32_bf16 v20, v150, v80
  v_dot2c_f32_bf16 v21, v150, v81
  v_dot2c_f32_bf16 v22, v151, v80
  v_dot2c_f32_bf16 v23, v151, v81
  v_cvt_pk_bf16_f32 v80, v58, 0
  v_cvt_pk_bf16_f32 v81, 0, v58
  v_dot2c_f32_bf16 v16, v152, v80
  v_dot2c_f32_bf16 v17, v152, v81
  v_dot2c_f32_bf16 v18, v153, v80
  v_dot2c_f32_bf16 v19, v153, v81
  v_dot2c_f32_bf16 v20, v154, v80
  v_dot2c_f32_bf16 v21, v154, v81
  v_dot2c_f32_bf16 v22, v155, v80
  v_dot2c_f32_bf16 v23, v155, v81
  v_cvt_pk_bf16_f32 v80, v59, 0
  v_cvt_pk_bf16_f32 v81, 0, v59
  v_dot2c_f32_bf16 v16, v156, v80
  v_dot2c_f32_bf16 v17, v156, v81
  v_dot2c_f32_bf16 v18, v157, v80
  v_dot2c_f32_bf16 v19, v157, v81
  v_dot2c_f32_bf16 v20, v158, v80
  v_dot2c_f32_bf16 v21, v158, v81
  v_dot2c_f32_bf16 v22, v159, v80
  v_dot2c_f32_bf16 v23, v159, v81
  v_cvt_pk_bf16_f32 v80, v60, 0
  v_cvt_pk_bf16_f32 v81, 0, v60
  v_dot2c_f32_bf16 v16, v160, v80
  v_dot2c_f32_bf16 v17, v160, v81
  v_dot2c_f32_bf16 v18, v161, v80
  v_dot2c_f32_bf16 v19, v161, v81
  v_dot2c_f32_bf16 v20, v162, v80
  v_dot2c_f32_bf16 v21, v162, v81
  v_dot2c_f32_bf16 v22, v163, v80
  v_dot2c_f32_bf16 v23, v163, v81
  v_cvt_pk_bf16_f32 v80, v61, 0
  v_cvt_pk_bf16_f32 v81, 0, v61
  v_dot2c_f32_bf16 v16, v164, v80
  v_dot2c_f32_bf16 v17, v164, v81
  v_dot2c_f32_bf16 v18, v165, v80
  v_dot2c_f32_bf16 v19, v165, v81
  v_dot2c_f32_bf16 v20, v166, v80
  v_dot2c_f32_bf16 v21, v166, v81
  v_dot2c_f32_bf16 v22, v167, v80
  v_dot2c_f32_bf16 v23, v167, v81
  global_load_dwordx4 v[144:147], v6, s[46:47]
  s_add_u32 s46, s46, 10240
  s_addc_u32 s47, s47, 0
  global_load_dwordx4 v[148:151], v6, s[46:47]
  s_add_u32 s46, s46, 10240
  s_addc_u32 s47, s47, 0
  global_load_dwordx4 v[152:155], v6, s[46:47]
  s_add_u32 s46, s46, 10240
  s_addc_u32 s47, s47, 0
  global_load_dwordx4 v[156:159], v6, s[46:47]
  s_add_u32 s46, s46, 10240
  s_addc_u32 s47, s47, 0
  global_load_dwordx4 v[160:163], v6, s[46:47]
  s_add_u32 s46, s46, 10240
  s_addc_u32 s47, s47, 0
  global_load_dwordx4 v[164:167], v6, s[46:47]
  s_add_u32 s46, s46, 10240
  s_addc_u32 s47, s47, 0
  s_waitcnt vmcnt(30)
  v_cvt_pk_bf16_f32 v80, v62, 0
  v_cvt_pk_bf16_f32 v81, 0, v62
  v_dot2c_f32_bf16 v16, v168, v80
  v_dot2c_f32_bf16 v17, v168, v81
  v_dot2c_f32_bf16 v18, v169, v80
  v_dot2c_f32_bf16 v19, v169, v81
  v_dot2c_f32_bf16 v20, v170, v80
  v_dot2c_f32_bf16 v21, v170, v81
  v_dot2c_f32_bf16 v22, v171, v80
  v_dot2c_f32_bf16 v23, v171, v81
  v_cvt_pk_bf16_f32 v80, v63, 0
  v_cvt_pk_bf16_f32 v81, 0, v63
  v_dot2c_f32_bf16 v16, v172, v80
  v_dot2c_f32_bf16 v17, v172, v81
  v_dot2c_f32_bf16 v18, v173, v80
  v_dot2c_f32_bf16 v19, v173, v81
  v_dot2c_f32_bf16 v20, v174, v80
  v_dot2c_f32_bf16 v21, v174, v81
  v_dot2c_f32_bf16 v22, v175, v80
  v_dot2c_f32_bf16 v23, v175, v81
  v_cvt_pk_bf16_f32 v80, v64, 0
  v_cvt_pk_bf16_f32 v81, 0, v64
  v_dot2c_f32_bf16 v16, v176, v80
  v_dot2c_f32_bf16 v17, v176, v81
  v_dot2c_f32_bf16 v18, v177, v80
  v_dot2c_f32_bf16 v19, v177, v81
  v_dot2c_f32_bf16 v20, v178, v80
  v_dot2c_f32_bf16 v21, v178, v81
  v_dot2c_f32_bf16 v22, v179, v80
  v_dot2c_f32_bf16 v23, v179, v81
  v_cvt_pk_bf16_f32 v80, v65, 0
  v_cvt_pk_bf16_f32 v81, 0, v65
  v_dot2c_f32_bf16 v16, v180, v80
  v_dot2c_f32_bf16 v17, v180, v81
  v_dot2c_f32_bf16 v18, v181, v80
  v_dot2c_f32_bf16 v19, v181, v81
  v_dot2c_f32_bf16 v20, v182, v80
  v_dot2c_f32_bf16 v21, v182, v81
  v_dot2c_f32_bf16 v22, v183, v80
  v_dot2c_f32_bf16 v23, v183, v81
  v_cvt_pk_bf16_f32 v80, v66, 0
  v_cvt_pk_bf16_f32 v81, 0, v66
  v_dot2c_f32_bf16 v16, v184, v80
  v_dot2c_f32_bf16 v17, v184, v81
  v_dot2c_f32_bf16 v18, v185, v80
  v_dot2c_f32_bf16 v19, v185, v81
  v_dot2c_f32_bf16 v20, v186, v80
  v_dot2c_f32_bf16 v21, v186, v81
  v_dot2c_f32_bf16 v22, v187, v80
  v_dot2c_f32_bf16 v23, v187, v81
  v_cvt_pk_bf16_f32 v80, v67, 0
  v_cvt_pk_bf16_f32 v81, 0, v67
  v_dot2c_f32_bf16 v16, v188, v80
  v_dot2c_f32_bf16 v17, v188, v81
  v_dot2c_f32_bf16 v18, v189, v80
  v_dot2c_f32_bf16 v19, v189, v81
  v_dot2c_f32_bf16 v20, v190, v80
  v_dot2c_f32_bf16 v21, v190, v81
  v_dot2c_f32_bf16 v22, v191, v80
  v_dot2c_f32_bf16 v23, v191, v81
  global_load_dwordx4 v[168:171], v6, s[46:47]
  s_add_u32 s46, s46, 10240
  s_addc_u32 s47, s47, 0
  global_load_dwordx4 v[172:175], v6, s[46:47]
  s_add_u32 s46, s46, 10240
  s_addc_u32 s47, s47, 0
  global_load_dwordx4 v[176:179], v6, s[46:47]
  s_add_u32 s46, s46, 10240
  s_addc_u32 s47, s47, 0
  global_load_dwordx4 v[180:183], v6, s[46:47]
  s_add_u32 s46, s46, 10240
  s_addc_u32 s47, s47, 0
  global_load_dwordx4 v[184:187], v6, s[46:47]
  s_add_u32 s46, s46, 10240
  s_addc_u32 s47, s47, 0
  global_load_dwordx4 v[188:191], v6, s[46:47]
  s_add_u32 s46, s46, 10240
  s_addc_u32 s47, s47, 0
  s_waitcnt vmcnt(30)
  v_cvt_pk_bf16_f32 v80, v68, 0
  v_cvt_pk_bf16_f32 v81, 0, v68
  v_dot2c_f32_bf16 v16, v96, v80
  v_dot2c_f32_bf16 v17, v96, v81
  v_dot2c_f32_bf16 v18, v97, v80
  v_dot2c_f32_bf16 v19, v97, v81
  v_dot2c_f32_bf16 v20, v98, v80
  v_dot2c_f32_bf16 v21, v98, v81
  v_dot2c_f32_bf16 v22, v99, v80
  v_dot2c_f32_bf16 v23, v99, v81
  v_cvt_pk_bf16_f32 v80, v69, 0
  v_cvt_pk_bf16_f32 v81, 0, v69
  v_dot2c_f32_bf16 v16, v100, v80
  v_dot2c_f32_bf16 v17, v100, v81
  v_dot2c_f32_bf16 v18, v101, v80
  v_dot2c_f32_bf16 v19, v101, v81
  v_dot2c_f32_bf16 v20, v102, v80
  v_dot2c_f32_bf16 v21, v102, v81
  v_dot2c_f32_bf16 v22, v103, v80
  v_dot2c_f32_bf16 v23, v103, v81
  v_cvt_pk_bf16_f32 v80, v70, 0
  v_cvt_pk_bf16_f32 v81, 0, v70
  v_dot2c_f32_bf16 v16, v104, v80
  v_dot2c_f32_bf16 v17, v104, v81
  v_dot2c_f32_bf16 v18, v105, v80
  v_dot2c_f32_bf16 v19, v105, v81
  v_dot2c_f32_bf16 v20, v106, v80
  v_dot2c_f32_bf16 v21, v106, v81
  v_dot2c_f32_bf16 v22, v107, v80
  v_dot2c_f32_bf16 v23, v107, v81
  v_cvt_pk_bf16_f32 v80, v71, 0
  v_cvt_pk_bf16_f32 v81, 0, v71
  v_dot2c_f32_bf16 v16, v108, v80
  v_dot2c_f32_bf16 v17, v108, v81
  v_dot2c_f32_bf16 v18, v109, v80
  v_dot2c_f32_bf16 v19, v109, v81
  v_dot2c_f32_bf16 v20, v110, v80
  v_dot2c_f32_bf16 v21, v110, v81
  v_dot2c_f32_bf16 v22, v111, v80
  v_dot2c_f32_bf16 v23, v111, v81
  v_cvt_pk_bf16_f32 v80, v72, 0
  v_cvt_pk_bf16_f32 v81, 0, v72
  v_dot2c_f32_bf16 v16, v112, v80
  v_dot2c_f32_bf16 v17, v112, v81
  v_dot2c_f32_bf16 v18, v113, v80
  v_dot2c_f32_bf16 v19, v113, v81
  v_dot2c_f32_bf16 v20, v114, v80
  v_dot2c_f32_bf16 v21, v114, v81
  v_dot2c_f32_bf16 v22, v115, v80
  v_dot2c_f32_bf16 v23, v115, v81
  v_cvt_pk_bf16_f32 v80, v73, 0
  v_cvt_pk_bf16_f32 v81, 0, v73
  v_dot2c_f32_bf16 v16, v116, v80
  v_dot2c_f32_bf16 v17, v116, v81
  v_dot2c_f32_bf16 v18, v117, v80
  v_dot2c_f32_bf16 v19, v117, v81
  v_dot2c_f32_bf16 v20, v118, v80
  v_dot2c_f32_bf16 v21, v118, v81
  v_dot2c_f32_bf16 v22, v119, v80
  v_dot2c_f32_bf16 v23, v119, v81
  s_add_u32 s46, s42, 1024
  s_addc_u32 s47, s43, 0
  global_load_dwordx4 v[96:99], v6, s[46:47]
  s_add_u32 s46, s46, 10240
  s_addc_u32 s47, s47, 0
  global_load_dwordx4 v[100:103], v6, s[46:47]
  s_add_u32 s46, s46, 10240
  s_addc_u32 s47, s47, 0
  global_load_dwordx4 v[104:107], v6, s[46:47]
  s_add_u32 s46, s46, 10240
  s_addc_u32 s47, s47, 0
  global_load_dwordx4 v[108:111], v6, s[46:47]
  s_add_u32 s46, s46, 10240
  s_addc_u32 s47, s47, 0
  global_load_dwordx4 v[112:115], v6, s[46:47]
  s_add_u32 s46, s46, 10240
  s_addc_u32 s47, s47, 0
  global_load_dwordx4 v[116:119], v6, s[46:47]
  s_add_u32 s46, s46, 10240
  s_addc_u32 s47, s47, 0
  s_waitcnt vmcnt(30)
  v_cvt_pk_bf16_f32 v80, v74, 0
  v_cvt_pk_bf16_f32 v81, 0, v74
  v_dot2c_f32_bf16 v16, v120, v80
  v_dot2c_f32_bf16 v17, v120, v81
  v_dot2c_f32_bf16 v18, v121, v80
  v_dot2c_f32_bf16 v19, v121, v81
  v_dot2c_f32_bf16 v20, v122, v80
  v_dot2c_f32_bf16 v21, v122, v81
  v_dot2c_f32_bf16 v22, v123, v80
  v_dot2c_f32_bf16 v23, v123, v81
  v_cvt_pk_bf16_f32 v80, v75, 0
  v_cvt_pk_bf16_f32 v81, 0, v75
  v_dot2c_f32_bf16 v16, v124, v80
  v_dot2c_f32_bf16 v17, v124, v81
  v_dot2c_f32_bf16 v18, v125, v80
  v_dot2c_f32_bf16 v19, v125, v81
  v_dot2c_f32_bf16 v20, v126, v80
  v_dot2c_f32_bf16 v21, v126, v81
  v_dot2c_f32_bf16 v22, v127, v80
  v_dot2c_f32_bf16 v23, v127, v81
  v_cvt_pk_bf16_f32 v80, v76, 0
  v_cvt_pk_bf16_f32 v81, 0, v76
  v_dot2c_f32_bf16 v16, v128, v80
  v_dot2c_f32_bf16 v17, v128, v81
  v_dot2c_f32_bf16 v18, v129, v80
  v_dot2c_f32_bf16 v19, v129, v81
  v_dot2c_f32_bf16 v20, v130, v80
  v_dot2c_f32_bf16 v21, v130, v81
  v_dot2c_f32_bf16 v22, v131, v80
  v_dot2c_f32_bf16 v23, v131, v81
  v_cvt_pk_bf16_f32 v80, v77, 0
  v_cvt_pk_bf16_f32 v81, 0, v77
  v_dot2c_f32_bf16 v16, v132, v80
  v_dot2c_f32_bf16 v17, v132, v81
  v_dot2c_f32_bf16 v18, v133, v80
  v_dot2c_f32_bf16 v19, v133, v81
  v_dot2c_f32_bf16 v20, v134, v80
  v_dot2c_f32_bf16 v21, v134, v81
  v_dot2c_f32_bf16 v22, v135, v80
  v_dot2c_f32_bf16 v23, v135, v81
  v_cvt_pk_bf16_f32 v80, v78, 0
  v_cvt_pk_bf16_f32 v81, 0, v78
  v_dot2c_f32_bf16 v16, v136, v80
  v_dot2c_f32_bf16 v17, v136, v81
  v_dot2c_f32_bf16 v18, v137, v80
  v_dot2c_f32_bf16 v19, v137, v81
  v_dot2c_f32_bf16 v20, v138, v80
  v_dot2c_f32_bf16 v21, v138, v81
  v_dot2c_f32_bf16 v22, v139, v80
  v_dot2c_f32_bf16 v23, v139, v81
  v_cvt_pk_bf16_f32 v80, v79, 0
  v_cvt_pk_bf16_f32 v81, 0, v79
  v_dot2c_f32_bf16 v16, v140, v80
  v_dot2c_f32_bf16 v17, v140, v81
  v_dot2c_f32_bf16 v18, v141, v80
  v_dot2c_f32_bf16 v19, v141, v81
  v_dot2c_f32_bf16 v20, v142, v80
  v_dot2c_f32_bf16 v21, v142, v81
  v_dot2c_f32_bf16 v22, v143, v80
  v_dot2c_f32_bf16 v23, v143, v81
  s_nop 3
  v_add_f32_dpp v16, v16, v16 row_ror:8 row_mask:0xf bank_mask:0xf
  v_add_f32_dpp v17, v17, v17 row_ror:8 row_mask:0xf bank_mask:0xf
  v_add_f32_dpp v18, v18, v18 row_ror:8 row_mask:0xf bank_mask:0xf
  v_add_f32_dpp v19, v19, v19 row_ror:8 row_mask:0xf bank_mask:0xf
  v_add_f32_dpp v20, v20, v20 row_ror:8 row_mask:0xf bank_mask:0xf
  v_add_f32_dpp v21, v21, v21 row_ror:8 row_mask:0xf bank_mask:0xf
  v_add_f32_dpp v22, v22, v22 row_ror:8 row_mask:0xf bank_mask:0xf
  v_add_f32_dpp v23, v23, v23 row_ror:8 row_mask:0xf bank_mask:0xf
  v_mov_b32 v80, v16
  v_mov_b32 v81, v17
  v_mov_b32 v82, v18
  v_mov_b32 v83, v19
  v_mov_b32 v84, v20
  v_mov_b32 v85, v21
  v_mov_b32 v86, v22
  v_mov_b32 v87, v23
  v_permlane16_swap_b32 v16, v80
  v_permlane16_swap_b32 v17, v81
  v_permlane16_swap_b32 v18, v82
  v_permlane16_swap_b32 v19, v83
  v_permlane16_swap_b32 v20, v84
  v_permlane16_swap_b32 v21, v85
  v_permlane16_swap_b32 v22, v86
  v_permlane16_swap_b32 v23, v87
  v_add_f32 v16, v16, v80
  v_add_f32 v17, v17, v81
  v_add_f32 v18, v18, v82
  v_add_f32 v19, v19, v83
  v_add_f32 v20, v20, v84
  v_add_f32 v21, v21, v85
  v_add_f32 v22, v22, v86
  v_add_f32 v23, v23, v87
  v_mov_b32 v80, v16
  v_mov_b32 v81, v17
  v_mov_b32 v82, v18
  v_mov_b32 v83, v19
  v_mov_b32 v84, v20
  v_mov_b32 v85, v21
  v_mov_b32 v86, v22
  v_mov_b32 v87, v23
  v_permlane32_swap_b32 v16, v80
  v_permlane32_swap_b32 v17, v81
  v_permlane32_swap_b32 v18, v82
  v_permlane32_swap_b32 v19, v83
  v_permlane32_swap_b32 v20, v84
  v_permlane32_swap_b32 v21, v85
  v_permlane32_swap_b32 v22, v86
  v_permlane32_swap_b32 v23, v87
  v_add_f32 v16, v16, v80
  v_add_f32 v17, v17, v81
  v_add_f32 v18, v18, v82
  v_add_f32 v19, v19, v83
  v_add_f32 v20, v20, v84
  v_add_f32 v21, v21, v85
  v_add_f32 v22, v22, v86
  v_add_f32 v23, v23, v87
  v_lshlrev_b32 v80, 8, v3
  v_add_u32 v80, v80, v9
  s_mov_b64 exec, 0xff
  global_store_dwordx4 v80, v[16:19], s[34:35] offset:0
  global_store_dwordx4 v80, v[20:23], s[34:35] offset:16
  s_mov_b64 exec, -1
  global_load_dwordx4 v[120:123], v6, s[46:47]
  s_add_u32 s46, s46, 10240
  s_addc_u32 s47, s47, 0
  global_load_dwordx4 v[124:127], v6, s[46:47]
  s_add_u32 s46, s46, 10240
  s_addc_u32 s47, s47, 0
  global_load_dwordx4 v[128:131], v6, s[46:47]
  s_add_u32 s46, s46, 10240
  s_addc_u32 s47, s47, 0
  global_load_dwordx4 v[132:135], v6, s[46:47]
  s_add_u32 s46, s46, 10240
  s_addc_u32 s47, s47, 0
  global_load_dwordx4 v[136:139], v6, s[46:47]
  s_add_u32 s46, s46, 10240
  s_addc_u32 s47, s47, 0
  global_load_dwordx4 v[140:143], v6, s[46:47]
  s_add_u32 s46, s46, 10240
  s_addc_u32 s47, s47, 0
  s_waitcnt vmcnt(32)
  v_cvt_pk_bf16_f32 v80, v56, 0
  v_cvt_pk_bf16_f32 v81, 0, v56
  v_dot2c_f32_bf16 v24, v192, v80
  v_dot2c_f32_bf16 v25, v192, v81
  v_dot2c_f32_bf16 v26, v193, v80
  v_dot2c_f32_bf16 v27, v193, v81
  v_dot2c_f32_bf16 v28, v194, v80
  v_dot2c_f32_bf16 v29, v194, v81
  v_dot2c_f32_bf16 v30, v195, v80
  v_dot2c_f32_bf16 v31, v195, v81
  v_cvt_pk_bf16_f32 v80, v57, 0
  v_cvt_pk_bf16_f32 v81, 0, v57
  v_dot2c_f32_bf16 v24, v196, v80
  v_dot2c_f32_bf16 v25, v196, v81
  v_dot2c_f32_bf16 v26, v197, v80
  v_dot2c_f32_bf16 v27, v197, v81
  v_dot2c_f32_bf16 v28, v198, v80
  v_dot2c_f32_bf16 v29, v198, v81
  v_dot2c_f32_bf16 v30, v199, v80
  v_dot2c_f32_bf16 v31, v199, v81
  v_cvt_pk_bf16_f32 v80, v58, 0
  v_cvt_pk_bf16_f32 v81, 0, v58
  v_dot2c_f32_bf16 v24, v200, v80
  v_dot2c_f32_bf16 v25, v200, v81
  v_dot2c_f32_bf16 v26, v201, v80
  v_dot2c_f32_bf16 v27, v201, v81
  v_dot2c_f32_bf16 v28, v202, v80
  v_dot2c_f32_bf16 v29, v202, v81
  v_dot2c_f32_bf16 v30, v203, v80
  v_dot2c_f32_bf16 v31, v203, v81
  v_cvt_pk_bf16_f32 v80, v59, 0
  v_cvt_pk_bf16_f32 v81, 0, v59
  v_dot2c_f32_bf16 v24, v204, v80
  v_dot2c_f32_bf16 v25, v204, v81
  v_dot2c_f32_bf16 v26, v205, v80
  v_dot2c_f32_bf16 v27, v205, v81
  v_dot2c_f32_bf16 v28, v206, v80
  v_dot2c_f32_bf16 v29, v206, v81
  v_dot2c_f32_bf16 v30, v207, v80
  v_dot2c_f32_bf16 v31, v207, v81
  v_cvt_pk_bf16_f32 v80, v60, 0
  v_cvt_pk_bf16_f32 v81, 0, v60
  v_dot2c_f32_bf16 v24, v208, v80
  v_dot2c_f32_bf16 v25, v208, v81
  v_dot2c_f32_bf16 v26, v209, v80
  v_dot2c_f32_bf16 v27, v209, v81
  v_dot2c_f32_bf16 v28, v210, v80
  v_dot2c_f32_bf16 v29, v210, v81
  v_dot2c_f32_bf16 v30, v211, v80
  v_dot2c_f32_bf16 v31, v211, v81
  v_cvt_pk_bf16_f32 v80, v61, 0
  v_cvt_pk_bf16_f32 v81, 0, v61
  v_dot2c_f32_bf16 v24, v212, v80
  v_dot2c_f32_bf16 v25, v212, v81
  v_dot2c_f32_bf16 v26, v213, v80
  v_dot2c_f32_bf16 v27, v213, v81
  v_dot2c_f32_bf16 v28, v214, v80
  v_dot2c_f32_bf16 v29, v214, v81
  v_dot2c_f32_bf16 v30, v215, v80
  v_dot2c_f32_bf16 v31, v215, v81
  global_load_dwordx4 v[192:195], v6, s[46:47]
  s_add_u32 s46, s46, 10240
  s_addc_u32 s47, s47, 0
  global_load_dwordx4 v[196:199], v6, s[46:47]
  s_add_u32 s46, s46, 10240
  s_addc_u32 s47, s47, 0
  global_load_dwordx4 v[200:203], v6, s[46:47]
  s_add_u32 s46, s46, 10240
  s_addc_u32 s47, s47, 0
  global_load_dwordx4 v[204:207], v6, s[46:47]
  s_add_u32 s46, s46, 10240
  s_addc_u32 s47, s47, 0
  global_load_dwordx4 v[208:211], v6, s[46:47]
  s_add_u32 s46, s46, 10240
  s_addc_u32 s47, s47, 0
  global_load_dwordx4 v[212:215], v6, s[46:47]
  s_add_u32 s46, s46, 10240
  s_addc_u32 s47, s47, 0
  s_waitcnt vmcnt(32)
  v_cvt_pk_bf16_f32 v80, v62, 0
  v_cvt_pk_bf16_f32 v81, 0, v62
  v_dot2c_f32_bf16 v24, v216, v80
  v_dot2c_f32_bf16 v25, v216, v81
  v_dot2c_f32_bf16 v26, v217, v80
  v_dot2c_f32_bf16 v27, v217, v81
  v_dot2c_f32_bf16 v28, v218, v80
  v_dot2c_f32_bf16 v29, v218, v81
  v_dot2c_f32_bf16 v30, v219, v80
  v_dot2c_f32_bf16 v31, v219, v81
  v_cvt_pk_bf16_f32 v80, v63, 0
  v_cvt_pk_bf16_f32 v81, 0, v63
  v_dot2c_f32_bf16 v24, v220, v80
  v_dot2c_f32_bf16 v25, v220, v81
  v_dot2c_f32_bf16 v26, v221, v80
  v_dot2c_f32_bf16 v27, v221, v81
  v_dot2c_f32_bf16 v28, v222, v80
  v_dot2c_f32_bf16 v29, v222, v81
  v_dot2c_f32_bf16 v30, v223, v80
  v_dot2c_f32_bf16 v31, v223, v81
  v_cvt_pk_bf16_f32 v80, v64, 0
  v_cvt_pk_bf16_f32 v81, 0, v64
  v_dot2c_f32_bf16 v24, v224, v80
  v_dot2c_f32_bf16 v25, v224, v81
  v_dot2c_f32_bf16 v26, v225, v80
  v_dot2c_f32_bf16 v27, v225, v81
  v_dot2c_f32_bf16 v28, v226, v80
  v_dot2c_f32_bf16 v29, v226, v81
  v_dot2c_f32_bf16 v30, v227, v80
  v_dot2c_f32_bf16 v31, v227, v81
  v_cvt_pk_bf16_f32 v80, v65, 0
  v_cvt_pk_bf16_f32 v81, 0, v65
  v_dot2c_f32_bf16 v24, v228, v80
  v_dot2c_f32_bf16 v25, v228, v81
  v_dot2c_f32_bf16 v26, v229, v80
  v_dot2c_f32_bf16 v27, v229, v81
  v_dot2c_f32_bf16 v28, v230, v80
  v_dot2c_f32_bf16 v29, v230, v81
  v_dot2c_f32_bf16 v30, v231, v80
  v_dot2c_f32_bf16 v31, v231, v81
  v_cvt_pk_bf16_f32 v80, v66, 0
  v_cvt_pk_bf16_f32 v81, 0, v66
  v_dot2c_f32_bf16 v24, v232, v80
  v_dot2c_f32_bf16 v25, v232, v81
  v_dot2c_f32_bf16 v26, v233, v80
  v_dot2c_f32_bf16 v27, v233, v81
  v_dot2c_f32_bf16 v28, v234, v80
  v_dot2c_f32_bf16 v29, v234, v81
  v_dot2c_f32_bf16 v30, v235, v80
  v_dot2c_f32_bf16 v31, v235, v81
  v_cvt_pk_bf16_f32 v80, v67, 0
  v_cvt_pk_bf16_f32 v81, 0, v67
  v_dot2c_f32_bf16 v24, v236, v80
  v_dot2c_f32_bf16 v25, v236, v81
  v_dot2c_f32_bf16 v26, v237, v80
  v_dot2c_f32_bf16 v27, v237, v81
  v_dot2c_f32_bf16 v28, v238, v80
  v_dot2c_f32_bf16 v29, v238, v81
  v_dot2c_f32_bf16 v30, v239, v80
  v_dot2c_f32_bf16 v31, v239, v81
  global_load_dwordx4 v[216:219], v6, s[46:47]
  s_add_u32 s46, s46, 10240
  s_addc_u32 s47, s47, 0
  global_load_dwordx4 v[220:223], v6, s[46:47]
  s_add_u32 s46, s46, 10240
  s_addc_u32 s47, s47, 0
  global_load_dwordx4 v[224:227], v6, s[46:47]
  s_add_u32 s46, s46, 10240
  s_addc_u32 s47, s47, 0
  global_load_dwordx4 v[228:231], v6, s[46:47]
  s_add_u32 s46, s46, 10240
  s_addc_u32 s47, s47, 0
  global_load_dwordx4 v[232:235], v6, s[46:47]
  s_add_u32 s46, s46, 10240
  s_addc_u32 s47, s47, 0
  global_load_dwordx4 v[236:239], v6, s[46:47]
  s_add_u32 s46, s46, 10240
  s_addc_u32 s47, s47, 0
  s_waitcnt vmcnt(32)
  v_cvt_pk_bf16_f32 v80, v68, 0
  v_cvt_pk_bf16_f32 v81, 0, v68
  v_dot2c_f32_bf16 v24, v144, v80
  v_dot2c_f32_bf16 v25, v144, v81
  v_dot2c_f32_bf16 v26, v145, v80
  v_dot2c_f32_bf16 v27, v145, v81
  v_dot2c_f32_bf16 v28, v146, v80
  v_dot2c_f32_bf16 v29, v146, v81
  v_dot2c_f32_bf16 v30, v147, v80
  v_dot2c_f32_bf16 v31, v147, v81
  v_cvt_pk_bf16_f32 v80, v69, 0
  v_cvt_pk_bf16_f32 v81, 0, v69
  v_dot2c_f32_bf16 v24, v148, v80
  v_dot2c_f32_bf16 v25, v148, v81
  v_dot2c_f32_bf16 v26, v149, v80
  v_dot2c_f32_bf16 v27, v149, v81
  v_dot2c_f32_bf16 v28, v150, v80
  v_dot2c_f32_bf16 v29, v150, v81
  v_dot2c_f32_bf16 v30, v151, v80
  v_dot2c_f32_bf16 v31, v151, v81
  v_cvt_pk_bf16_f32 v80, v70, 0
  v_cvt_pk_bf16_f32 v81, 0, v70
  v_dot2c_f32_bf16 v24, v152, v80
  v_dot2c_f32_bf16 v25, v152, v81
  v_dot2c_f32_bf16 v26, v153, v80
  v_dot2c_f32_bf16 v27, v153, v81
  v_dot2c_f32_bf16 v28, v154, v80
  v_dot2c_f32_bf16 v29, v154, v81
  v_dot2c_f32_bf16 v30, v155, v80
  v_dot2c_f32_bf16 v31, v155, v81
  v_cvt_pk_bf16_f32 v80, v71, 0
  v_cvt_pk_bf16_f32 v81, 0, v71
  v_dot2c_f32_bf16 v24, v156, v80
  v_dot2c_f32_bf16 v25, v156, v81
  v_dot2c_f32_bf16 v26, v157, v80
  v_dot2c_f32_bf16 v27, v157, v81
  v_dot2c_f32_bf16 v28, v158, v80
  v_dot2c_f32_bf16 v29, v158, v81
  v_dot2c_f32_bf16 v30, v159, v80
  v_dot2c_f32_bf16 v31, v159, v81
  v_cvt_pk_bf16_f32 v80, v72, 0
  v_cvt_pk_bf16_f32 v81, 0, v72
  v_dot2c_f32_bf16 v24, v160, v80
  v_dot2c_f32_bf16 v25, v160, v81
  v_dot2c_f32_bf16 v26, v161, v80
  v_dot2c_f32_bf16 v27, v161, v81
  v_dot2c_f32_bf16 v28, v162, v80
  v_dot2c_f32_bf16 v29, v162, v81
  v_dot2c_f32_bf16 v30, v163, v80
  v_dot2c_f32_bf16 v31, v163, v81
  v_cvt_pk_bf16_f32 v80, v73, 0
  v_cvt_pk_bf16_f32 v81, 0, v73
  v_dot2c_f32_bf16 v24, v164, v80
  v_dot2c_f32_bf16 v25, v164, v81
  v_dot2c_f32_bf16 v26, v165, v80
  v_dot2c_f32_bf16 v27, v165, v81
  v_dot2c_f32_bf16 v28, v166, v80
  v_dot2c_f32_bf16 v29, v166, v81
  v_dot2c_f32_bf16 v30, v167, v80
  v_dot2c_f32_bf16 v31, v167, v81
  s_waitcnt vmcnt(26)
  v_cvt_pk_bf16_f32 v80, v74, 0
  v_cvt_pk_bf16_f32 v81, 0, v74
  v_dot2c_f32_bf16 v24, v168, v80
  v_dot2c_f32_bf16 v25, v168, v81
  v_dot2c_f32_bf16 v26, v169, v80
  v_dot2c_f32_bf16 v27, v169, v81
  v_dot2c_f32_bf16 v28, v170, v80
  v_dot2c_f32_bf16 v29, v170, v81
  v_dot2c_f32_bf16 v30, v171, v80
  v_dot2c_f32_bf16 v31, v171, v81
  v_cvt_pk_bf16_f32 v80, v75, 0
  v_cvt_pk_bf16_f32 v81, 0, v75
  v_dot2c_f32_bf16 v24, v172, v80
  v_dot2c_f32_bf16 v25, v172, v81
  v_dot2c_f32_bf16 v26, v173, v80
  v_dot2c_f32_bf16 v27, v173, v81
  v_dot2c_f32_bf16 v28, v174, v80
  v_dot2c_f32_bf16 v29, v174, v81
  v_dot2c_f32_bf16 v30, v175, v80
  v_dot2c_f32_bf16 v31, v175, v81
  v_cvt_pk_bf16_f32 v80, v76, 0
  v_cvt_pk_bf16_f32 v81, 0, v76
  v_dot2c_f32_bf16 v24, v176, v80
  v_dot2c_f32_bf16 v25, v176, v81
  v_dot2c_f32_bf16 v26, v177, v80
  v_dot2c_f32_bf16 v27, v177, v81
  v_dot2c_f32_bf16 v28, v178, v80
  v_dot2c_f32_bf16 v29, v178, v81
  v_dot2c_f32_bf16 v30, v179, v80
  v_dot2c_f32_bf16 v31, v179, v81
  v_cvt_pk_bf16_f32 v80, v77, 0
  v_cvt_pk_bf16_f32 v81, 0, v77
  v_dot2c_f32_bf16 v24, v180, v80
  v_dot2c_f32_bf16 v25, v180, v81
  v_dot2c_f32_bf16 v26, v181, v80
  v_dot2c_f32_bf16 v27, v181, v81
  v_dot2c_f32_bf16 v28, v182, v80
  v_dot2c_f32_bf16 v29, v182, v81
  v_dot2c_f32_bf16 v30, v183, v80
  v_dot2c_f32_bf16 v31, v183, v81
  v_cvt_pk_bf16_f32 v80, v78, 0
  v_cvt_pk_bf16_f32 v81, 0, v78
  v_dot2c_f32_bf16 v24, v184, v80
  v_dot2c_f32_bf16 v25, v184, v81
  v_dot2c_f32_bf16 v26, v185, v80
  v_dot2c_f32_bf16 v27, v185, v81
  v_dot2c_f32_bf16 v28, v186, v80
  v_dot2c_f32_bf16 v29, v186, v81
  v_dot2c_f32_bf16 v30, v187, v80
  v_dot2c_f32_bf16 v31, v187, v81
  v_cvt_pk_bf16_f32 v80, v79, 0
  v_cvt_pk_bf16_f32 v81, 0, v79
  v_dot2c_f32_bf16 v24, v188, v80
  v_dot2c_f32_bf16 v25, v188, v81
  v_dot2c_f32_bf16 v26, v189, v80
  v_dot2c_f32_bf16 v27, v189, v81
  v_dot2c_f32_bf16 v28, v190, v80
  v_dot2c_f32_bf16 v29, v190, v81
  v_dot2c_f32_bf16 v30, v191, v80
  v_dot2c_f32_bf16 v31, v191, v81
  s_nop 3
  v_add_f32_dpp v24, v24, v24 row_ror:8 row_mask:0xf bank_mask:0xf
  v_add_f32_dpp v25, v25, v25 row_ror:8 row_mask:0xf bank_mask:0xf
  v_add_f32_dpp v26, v26, v26 row_ror:8 row_mask:0xf bank_mask:0xf
  v_add_f32_dpp v27, v27, v27 row_ror:8 row_mask:0xf bank_mask:0xf
  v_add_f32_dpp v28, v28, v28 row_ror:8 row_mask:0xf bank_mask:0xf
  v_add_f32_dpp v29, v29, v29 row_ror:8 row_mask:0xf bank_mask:0xf
  v_add_f32_dpp v30, v30, v30 row_ror:8 row_mask:0xf bank_mask:0xf
  v_add_f32_dpp v31, v31, v31 row_ror:8 row_mask:0xf bank_mask:0xf
  v_mov_b32 v80, v24
  v_mov_b32 v81, v25
  v_mov_b32 v82, v26
  v_mov_b32 v83, v27
  v_mov_b32 v84, v28
  v_mov_b32 v85, v29
  v_mov_b32 v86, v30
  v_mov_b32 v87, v31
  v_permlane16_swap_b32 v24, v80
  v_permlane16_swap_b32 v25, v81
  v_permlane16_swap_b32 v26, v82
  v_permlane16_swap_b32 v27, v83
  v_permlane16_swap_b32 v28, v84
  v_permlane16_swap_b32 v29, v85
  v_permlane16_swap_b32 v30, v86
  v_permlane16_swap_b32 v31, v87
  v_add_f32 v24, v24, v80
  v_add_f32 v25, v25, v81
  v_add_f32 v26, v26, v82
  v_add_f32 v27, v27, v83
  v_add_f32 v28, v28, v84
  v_add_f32 v29, v29, v85
  v_add_f32 v30, v30, v86
  v_add_f32 v31, v31, v87
  v_mov_b32 v80, v24
  v_mov_b32 v81, v25
  v_mov_b32 v82, v26
  v_mov_b32 v83, v27
  v_mov_b32 v84, v28
  v_mov_b32 v85, v29
  v_mov_b32 v86, v30
  v_mov_b32 v87, v31
  v_permlane32_swap_b32 v24, v80
  v_permlane32_swap_b32 v25, v81
  v_permlane32_swap_b32 v26, v82
  v_permlane32_swap_b32 v27, v83
  v_permlane32_swap_b32 v28, v84
  v_permlane32_swap_b32 v29, v85
  v_permlane32_swap_b32 v30, v86
  v_permlane32_swap_b32 v31, v87
  v_add_f32 v24, v24, v80
  v_add_f32 v25, v25, v81
  v_add_f32 v26, v26, v82
  v_add_f32 v27, v27, v83
  v_add_f32 v28, v28, v84
  v_add_f32 v29, v29, v85
  v_add_f32 v30, v30, v86
  v_add_f32 v31, v31, v87
  v_lshlrev_b32 v80, 8, v3
  v_add_u32 v80, v80, v9
  s_mov_b64 exec, 0xff
  global_store_dwordx4 v80, v[24:27], s[34:35] offset:1024
  global_store_dwordx4 v80, v[28:31], s[34:35] offset:1040
  s_mov_b64 exec, -1
  s_waitcnt vmcnt(22)
  v_cvt_pk_bf16_f32 v80, v56, 0
  v_cvt_pk_bf16_f32 v81, 0, v56
  v_dot2c_f32_bf16 v32, v96, v80
  v_dot2c_f32_bf16 v33, v96, v81
  v_dot2c_f32_bf16 v34, v97, v80
  v_dot2c_f32_bf16 v35, v97, v81
  v_dot2c_f32_bf16 v36, v98, v80
  v_dot2c_f32_bf16 v37, v98, v81
  v_dot2c_f32_bf16 v38, v99, v80
  v_dot2c_f32_bf16 v39, v99, v81
  v_cvt_pk_bf16_f32 v80, v57, 0
  v_cvt_pk_bf16_f32 v81, 0, v57
  v_dot2c_f32_bf16 v32, v100, v80
  v_dot2c_f32_bf16 v33, v100, v81
  v_dot2c_f32_bf16 v34, v101, v80
  v_dot2c_f32_bf16 v35, v101, v81
  v_dot2c_f32_bf16 v36, v102, v80
  v_dot2c_f32_bf16 v37, v102, v81
  v_dot2c_f32_bf16 v38, v103, v80
  v_dot2c_f32_bf16 v39, v103, v81
  v_cvt_pk_bf16_f32 v80, v58, 0
  v_cvt_pk_bf16_f32 v81, 0, v58
  v_dot2c_f32_bf16 v32, v104, v80
  v_dot2c_f32_bf16 v33, v104, v81
  v_dot2c_f32_bf16 v34, v105, v80
  v_dot2c_f32_bf16 v35, v105, v81
  v_dot2c_f32_bf16 v36, v106, v80
  v_dot2c_f32_bf16 v37, v106, v81
  v_dot2c_f32_bf16 v38, v107, v80
  v_dot2c_f32_bf16 v39, v107, v81
  v_cvt_pk_bf16_f32 v80, v59, 0
  v_cvt_pk_bf16_f32 v81, 0, v59
  v_dot2c_f32_bf16 v32, v108, v80
  v_dot2c_f32_bf16 v33, v108, v81
  v_dot2c_f32_bf16 v34, v109, v80
  v_dot2c_f32_bf16 v35, v109, v81
  v_dot2c_f32_bf16 v36, v110, v80
  v_dot2c_f32_bf16 v37, v110, v81
  v_dot2c_f32_bf16 v38, v111, v80
  v_dot2c_f32_bf16 v39, v111, v81
  v_cvt_pk_bf16_f32 v80, v60, 0
  v_cvt_pk_bf16_f32 v81, 0, v60
  v_dot2c_f32_bf16 v32, v112, v80
  v_dot2c_f32_bf16 v33, v112, v81
  v_dot2c_f32_bf16 v34, v113, v80
  v_dot2c_f32_bf16 v35, v113, v81
  v_dot2c_f32_bf16 v36, v114, v80
  v_dot2c_f32_bf16 v37, v114, v81
  v_dot2c_f32_bf16 v38, v115, v80
  v_dot2c_f32_bf16 v39, v115, v81
  v_cvt_pk_bf16_f32 v80, v61, 0
  v_cvt_pk_bf16_f32 v81, 0, v61
  v_dot2c_f32_bf16 v32, v116, v80
  v_dot2c_f32_bf16 v33, v116, v81
  v_dot2c_f32_bf16 v34, v117, v80
  v_dot2c_f32_bf16 v35, v117, v81
  v_dot2c_f32_bf16 v36, v118, v80
  v_dot2c_f32_bf16 v37, v118, v81
  v_dot2c_f32_bf16 v38, v119, v80
  v_dot2c_f32_bf16 v39, v119, v81
  s_waitcnt vmcnt(14)
  v_cvt_pk_bf16_f32 v80, v62, 0
  v_cvt_pk_bf16_f32 v81, 0, v62
  v_dot2c_f32_bf16 v32, v120, v80
  v_dot2c_f32_bf16 v33, v120, v81
  v_dot2c_f32_bf16 v34, v121, v80
  v_dot2c_f32_bf16 v35, v121, v81
  v_dot2c_f32_bf16 v36, v122, v80
  v_dot2c_f32_bf16 v37, v122, v81
  v_dot2c_f32_bf16 v38, v123, v80
  v_dot2c_f32_bf16 v39, v123, v81
  v_cvt_pk_bf16_f32 v80, v63, 0
  v_cvt_pk_bf16_f32 v81, 0, v63
  v_dot2c_f32_bf16 v32, v124, v80
  v_dot2c_f32_bf16 v33, v124, v81
  v_dot2c_f32_bf16 v34, v125, v80
  v_dot2c_f32_bf16 v35, v125, v81
  v_dot2c_f32_bf16 v36, v126, v80
  v_dot2c_f32_bf16 v37, v126, v81
  v_dot2c_f32_bf16 v38, v127, v80
  v_dot2c_f32_bf16 v39, v127, v81
  v_cvt_pk_bf16_f32 v80, v64, 0
  v_cvt_pk_bf16_f32 v81, 0, v64
  v_dot2c_f32_bf16 v32, v128, v80
  v_dot2c_f32_bf16 v33, v128, v81
  v_dot2c_f32_bf16 v34, v129, v80
  v_dot2c_f32_bf16 v35, v129, v81
  v_dot2c_f32_bf16 v36, v130, v80
  v_dot2c_f32_bf16 v37, v130, v81
  v_dot2c_f32_bf16 v38, v131, v80
  v_dot2c_f32_bf16 v39, v131, v81
  v_cvt_pk_bf16_f32 v80, v65, 0
  v_cvt_pk_bf16_f32 v81, 0, v65
  v_dot2c_f32_bf16 v32, v132, v80
  v_dot2c_f32_bf16 v33, v132, v81
  v_dot2c_f32_bf16 v34, v133, v80
  v_dot2c_f32_bf16 v35, v133, v81
  v_dot2c_f32_bf16 v36, v134, v80
  v_dot2c_f32_bf16 v37, v134, v81
  v_dot2c_f32_bf16 v38, v135, v80
  v_dot2c_f32_bf16 v39, v135, v81
  v_cvt_pk_bf16_f32 v80, v66, 0
  v_cvt_pk_bf16_f32 v81, 0, v66
  v_dot2c_f32_bf16 v32, v136, v80
  v_dot2c_f32_bf16 v33, v136, v81
  v_dot2c_f32_bf16 v34, v137, v80
  v_dot2c_f32_bf16 v35, v137, v81
  v_dot2c_f32_bf16 v36, v138, v80
  v_dot2c_f32_bf16 v37, v138, v81
  v_dot2c_f32_bf16 v38, v139, v80
  v_dot2c_f32_bf16 v39, v139, v81
  v_cvt_pk_bf16_f32 v80, v67, 0
  v_cvt_pk_bf16_f32 v81, 0, v67
  v_dot2c_f32_bf16 v32, v140, v80
  v_dot2c_f32_bf16 v33, v140, v81
  v_dot2c_f32_bf16 v34, v141, v80
  v_dot2c_f32_bf16 v35, v141, v81
  v_dot2c_f32_bf16 v36, v142, v80
  v_dot2c_f32_bf16 v37, v142, v81
  v_dot2c_f32_bf16 v38, v143, v80
  v_dot2c_f32_bf16 v39, v143, v81
  s_waitcnt vmcnt(8)
  v_cvt_pk_bf16_f32 v80, v68, 0
  v_cvt_pk_bf16_f32 v81, 0, v68
  v_dot2c_f32_bf16 v32, v192, v80
  v_dot2c_f32_bf16 v33, v192, v81
  v_dot2c_f32_bf16 v34, v193, v80
  v_dot2c_f32_bf16 v35, v193, v81
  v_dot2c_f32_bf16 v36, v194, v80
  v_dot2c_f32_bf16 v37, v194, v81
  v_dot2c_f32_bf16 v38, v195, v80
  v_dot2c_f32_bf16 v39, v195, v81
  v_cvt_pk_bf16_f32 v80, v69, 0
  v_cvt_pk_bf16_f32 v81, 0, v69
  v_dot2c_f32_bf16 v32, v196, v80
  v_dot2c_f32_bf16 v33, v196, v81
  v_dot2c_f32_bf16 v34, v197, v80
  v_dot2c_f32_bf16 v35, v197, v81
  v_dot2c_f32_bf16 v36, v198, v80
  v_dot2c_f32_bf16 v37, v198, v81
  v_dot2c_f32_bf16 v38, v199, v80
  v_dot2c_f32_bf16 v39, v199, v81
  v_cvt_pk_bf16_f32 v80, v70, 0
  v_cvt_pk_bf16_f32 v81, 0, v70
  v_dot2c_f32_bf16 v32, v200, v80
  v_dot2c_f32_bf16 v33, v200, v81
  v_dot2c_f32_bf16 v34, v201, v80
  v_dot2c_f32_bf16 v35, v201, v81
  v_dot2c_f32_bf16 v36, v202, v80
  v_dot2c_f32_bf16 v37, v202, v81
  v_dot2c_f32_bf16 v38, v203, v80
  v_dot2c_f32_bf16 v39, v203, v81
  v_cvt_pk_bf16_f32 v80, v71, 0
  v_cvt_pk_bf16_f32 v81, 0, v71
  v_dot2c_f32_bf16 v32, v204, v80
  v_dot2c_f32_bf16 v33, v204, v81
  v_dot2c_f32_bf16 v34, v205, v80
  v_dot2c_f32_bf16 v35, v205, v81
  v_dot2c_f32_bf16 v36, v206, v80
  v_dot2c_f32_bf16 v37, v206, v81
  v_dot2c_f32_bf16 v38, v207, v80
  v_dot2c_f32_bf16 v39, v207, v81
  v_cvt_pk_bf16_f32 v80, v72, 0
  v_cvt_pk_bf16_f32 v81, 0, v72
  v_dot2c_f32_bf16 v32, v208, v80
  v_dot2c_f32_bf16 v33, v208, v81
  v_dot2c_f32_bf16 v34, v209, v80
  v_dot2c_f32_bf16 v35, v209, v81
  v_dot2c_f32_bf16 v36, v210, v80
  v_dot2c_f32_bf16 v37, v210, v81
  v_dot2c_f32_bf16 v38, v211, v80
  v_dot2c_f32_bf16 v39, v211, v81
  v_cvt_pk_bf16_f32 v80, v73, 0
  v_cvt_pk_bf16_f32 v81, 0, v73
  v_dot2c_f32_bf16 v32, v212, v80
  v_dot2c_f32_bf16 v33, v212, v81
  v_dot2c_f32_bf16 v34, v213, v80
  v_dot2c_f32_bf16 v35, v213, v81
  v_dot2c_f32_bf16 v36, v214, v80
  v_dot2c_f32_bf16 v37, v214, v81
  v_dot2c_f32_bf16 v38, v215, v80
  v_dot2c_f32_bf16 v39, v215, v81
  s_waitcnt vmcnt(2)
  v_cvt_pk_bf16_f32 v80, v74, 0
  v_cvt_pk_bf16_f32 v81, 0, v74
  v_dot2c_f32_bf16 v32, v216, v80
  v_dot2c_f32_bf16 v33, v216, v81
  v_dot2c_f32_bf16 v34, v217, v80
  v_dot2c_f32_bf16 v35, v217, v81
  v_dot2c_f32_bf16 v36, v218, v80
  v_dot2c_f32_bf16 v37, v218, v81
  v_dot2c_f32_bf16 v38, v219, v80
  v_dot2c_f32_bf16 v39, v219, v81
  v_cvt_pk_bf16_f32 v80, v75, 0
  v_cvt_pk_bf16_f32 v81, 0, v75
  v_dot2c_f32_bf16 v32, v220, v80
  v_dot2c_f32_bf16 v33, v220, v81
  v_dot2c_f32_bf16 v34, v221, v80
  v_dot2c_f32_bf16 v35, v221, v81
  v_dot2c_f32_bf16 v36, v222, v80
  v_dot2c_f32_bf16 v37, v222, v81
  v_dot2c_f32_bf16 v38, v223, v80
  v_dot2c_f32_bf16 v39, v223, v81
  v_cvt_pk_bf16_f32 v80, v76, 0
  v_cvt_pk_bf16_f32 v81, 0, v76
  v_dot2c_f32_bf16 v32, v224, v80
  v_dot2c_f32_bf16 v33, v224, v81
  v_dot2c_f32_bf16 v34, v225, v80
  v_dot2c_f32_bf16 v35, v225, v81
  v_dot2c_f32_bf16 v36, v226, v80
  v_dot2c_f32_bf16 v37, v226, v81
  v_dot2c_f32_bf16 v38, v227, v80
  v_dot2c_f32_bf16 v39, v227, v81
  v_cvt_pk_bf16_f32 v80, v77, 0
  v_cvt_pk_bf16_f32 v81, 0, v77
  v_dot2c_f32_bf16 v32, v228, v80
  v_dot2c_f32_bf16 v33, v228, v81
  v_dot2c_f32_bf16 v34, v229, v80
  v_dot2c_f32_bf16 v35, v229, v81
  v_dot2c_f32_bf16 v36, v230, v80
  v_dot2c_f32_bf16 v37, v230, v81
  v_dot2c_f32_bf16 v38, v231, v80
  v_dot2c_f32_bf16 v39, v231, v81
  v_cvt_pk_bf16_f32 v80, v78, 0
  v_cvt_pk_bf16_f32 v81, 0, v78
  v_dot2c_f32_bf16 v32, v232, v80
  v_dot2c_f32_bf16 v33, v232, v81
  v_dot2c_f32_bf16 v34, v233, v80
  v_dot2c_f32_bf16 v35, v233, v81
  v_dot2c_f32_bf16 v36, v234, v80
  v_dot2c_f32_bf16 v37, v234, v81
  v_dot2c_f32_bf16 v38, v235, v80
  v_dot2c_f32_bf16 v39, v235, v81
  v_cvt_pk_bf16_f32 v80, v79, 0
  v_cvt_pk_bf16_f32 v81, 0, v79
  v_dot2c_f32_bf16 v32, v236, v80
  v_dot2c_f32_bf16 v33, v236, v81
  v_dot2c_f32_bf16 v34, v237, v80
  v_dot2c_f32_bf16 v35, v237, v81
  v_dot2c_f32_bf16 v36, v238, v80
  v_dot2c_f32_bf16 v37, v238, v81
  v_dot2c_f32_bf16 v38, v239, v80
  v_dot2c_f32_bf16 v39, v239, v81
  s_nop 3
  v_add_f32_dpp v32, v32, v32 row_ror:8 row_mask:0xf bank_mask:0xf
  v_add_f32_dpp v33, v33, v33 row_ror:8 row_mask:0xf bank_mask:0xf
  v_add_f32_dpp v34, v34, v34 row_ror:8 row_mask:0xf bank_mask:0xf
  v_add_f32_dpp v35, v35, v35 row_ror:8 row_mask:0xf bank_mask:0xf
  v_add_f32_dpp v36, v36, v36 row_ror:8 row_mask:0xf bank_mask:0xf
  v_add_f32_dpp v37, v37, v37 row_ror:8 row_mask:0xf bank_mask:0xf
  v_add_f32_dpp v38, v38, v38 row_ror:8 row_mask:0xf bank_mask:0xf
  v_add_f32_dpp v39, v39, v39 row_ror:8 row_mask:0xf bank_mask:0xf
  v_mov_b32 v80, v32
  v_mov_b32 v81, v33
  v_mov_b32 v82, v34
  v_mov_b32 v83, v35
  v_mov_b32 v84, v36
  v_mov_b32 v85, v37
  v_mov_b32 v86, v38
  v_mov_b32 v87, v39
  v_permlane16_swap_b32 v32, v80
  v_permlane16_swap_b32 v33, v81
  v_permlane16_swap_b32 v34, v82
  v_permlane16_swap_b32 v35, v83
  v_permlane16_swap_b32 v36, v84
  v_permlane16_swap_b32 v37, v85
  v_permlane16_swap_b32 v38, v86
  v_permlane16_swap_b32 v39, v87
  v_add_f32 v32, v32, v80
  v_add_f32 v33, v33, v81
  v_add_f32 v34, v34, v82
  v_add_f32 v35, v35, v83
  v_add_f32 v36, v36, v84
  v_add_f32 v37, v37, v85
  v_add_f32 v38, v38, v86
  v_add_f32 v39, v39, v87
  v_mov_b32 v80, v32
  v_mov_b32 v81, v33
  v_mov_b32 v82, v34
  v_mov_b32 v83, v35
  v_mov_b32 v84, v36
  v_mov_b32 v85, v37
  v_mov_b32 v86, v38
  v_mov_b32 v87, v39
  v_permlane32_swap_b32 v32, v80
  v_permlane32_swap_b32 v33, v81
  v_permlane32_swap_b32 v34, v82
  v_permlane32_swap_b32 v35, v83
  v_permlane32_swap_b32 v36, v84
  v_permlane32_swap_b32 v37, v85
  v_permlane32_swap_b32 v38, v86
  v_permlane32_swap_b32 v39, v87
  v_add_f32 v32, v32, v80
  v_add_f32 v33, v33, v81
  v_add_f32 v34, v34, v82
  v_add_f32 v35, v35, v83
  v_add_f32 v36, v36, v84
  v_add_f32 v37, v37, v85
  v_add_f32 v38, v38, v86
  v_add_f32 v39, v39, v87
  v_lshlrev_b32 v80, 8, v3
  v_add_u32 v80, v80, v9
  s_mov_b64 exec, 0xff
  global_store_dwordx4 v80, v[32:35], s[34:35] offset:2048
  global_store_dwordx4 v80, v[36:39], s[34:35] offset:2064
  s_mov_b64 exec, -1
  s_branch L_end
L_att_b:
  s_waitcnt vmcnt(30)
  v_cvt_pk_bf16_f32 v80, v56, 0
  v_cvt_pk_bf16_f32 v81, 0, v56
  v_dot2c_f32_bf16 v16, v144, v80
  v_dot2c_f32_bf16 v17, v144, v81
  v_dot2c_f32_bf16 v18, v145, v80
  v_dot2c_f32_bf16 v19, v145, v81
  v_dot2c_f32_bf16 v20, v146, v80
  v_dot2c_f32_bf16 v21, v146, v81
  v_dot2c_f32_bf16 v22, v147, v80
  v_dot2c_f32_bf16 v23, v147, v81
  v_cvt_pk_bf16_f32 v80, v57, 0
  v_cvt_pk_bf16_f32 v81, 0, v57
  v_dot2c_f32_bf16 v16, v148, v80
  v_dot2c_f32_bf16 v17, v148, v81
  v_dot2c_f32_bf16 v18, v149, v80
  v_dot2c_f32_bf16 v19, v149, v81
  v_dot2c_f32_bf16 v20, v150, v80
  v_dot2c_f32_bf16 v21, v150, v81
  v_dot2c_f32_bf16 v22, v151, v80
  v_dot2c_f32_bf16 v23, v151, v81
  v_cvt_pk_bf16_f32 v80, v58, 0
  v_cvt_pk_bf16_f32 v81, 0, v58
  v_dot2c_f32_bf16 v16, v152, v80
  v_dot2c_f32_bf16 v17, v152, v81
  v_dot2c_f32_bf16 v18, v153, v80
  v_dot2c_f32_bf16 v19, v153, v81
  v_dot2c_f32_bf16 v20, v154, v80
  v_dot2c_f32_bf16 v21, v154, v81
  v_dot2c_f32_bf16 v22, v155, v80
  v_dot2c_f32_bf16 v23, v155, v81
  v_cvt_pk_bf16_f32 v80, v59, 0
  v_cvt_pk_bf16_f32 v81, 0, v59
  v_dot2c_f32_bf16 v16, v156, v80
  v_dot2c_f32_bf16 v17, v156, v81
  v_dot2c_f32_bf16 v18, v157, v80
  v_dot2c_f32_bf16 v19, v157, v81
  v_dot2c_f32_bf16 v20, v158, v80
  v_dot2c_f32_bf16 v21, v158, v81
  v_dot2c_f32_bf16 v22, v159, v80
  v_dot2c_f32_bf16 v23, v159, v81
  v_cvt_pk_bf16_f32 v80, v60, 0
  v_cvt_pk_bf16_f32 v81, 0, v60
  v_dot2c_f32_bf16 v16, v160, v80
  v_dot2c_f32_bf16 v17, v160, v81
  v_dot2c_f32_bf16 v18, v161, v80
  v_dot2c_f32_bf16 v19, v161, v81
  v_dot2c_f32_bf16 v20, v162, v80
  v_dot2c_f32_bf16 v21, v162, v81
  v_dot2c_f32_bf16 v22, v163, v80
  v_dot2c_f32_bf16 v23, v163, v81
  v_cvt_pk_bf16_f32 v80, v61, 0
  v_cvt_pk_bf16_f32 v81, 0, v61
  v_dot2c_f32_bf16 v16, v164, v80
  v_dot2c_f32_bf16 v17, v164, v81
  v_dot2c_f32_bf16 v18, v165, v80
  v_dot2c_f32_bf16 v19, v165, v81
  v_dot2c_f32_bf16 v20, v166, v80
  v_dot2c_f32_bf16 v21, v166, v81
  v_dot2c_f32_bf16 v22, v167, v80
  v_dot2c_f32_bf16 v23, v167, v81
  global_load_dwordx4 v[144:147], v6, s[46:47]
  s_add_u32 s46, s46, 10240
  s_addc_u32 s47, s47, 0
  global_load_dwordx4 v[148:151], v6, s[46:47]
  s_add_u32 s46, s46, 10240
  s_addc_u32 s47, s47, 0
  global_load_dwordx4 v[152:155], v6, s[46:47]
  s_add_u32 s46, s46, 10240
  s_addc_u32 s47, s47, 0
  global_load_dwordx4 v[156:159], v6, s[46:47]
  s_add_u32 s46, s46, 10240
  s_addc_u32 s47, s47, 0
  global_load_dwordx4 v[160:163], v6, s[46:47]
  s_add_u32 s46, s46, 10240
  s_addc_u32 s47, s47, 0
  global_load_dwordx4 v[164:167], v6, s[46:47]
  s_add_u32 s46, s46, 10240
  s_addc_u32 s47, s47, 0
  s_waitcnt vmcnt(30)
  v_cvt_pk_bf16_f32 v80, v62, 0
  v_cvt_pk_bf16_f32 v81, 0, v62
  v_dot2c_f32_bf16 v16, v168, v80
  v_dot2c_f32_bf16 v17, v168, v81
  v_dot2c_f32_bf16 v18, v169, v80
  v_dot2c_f32_bf16 v19, v169, v81
  v_dot2c_f32_bf16 v20, v170, v80
  v_dot2c_f32_bf16 v21, v170, v81
  v_dot2c_f32_bf16 v22, v171, v80
  v_dot2c_f32_bf16 v23, v171, v81
  v_cvt_pk_bf16_f32 v80, v63, 0
  v_cvt_pk_bf16_f32 v81, 0, v63
  v_dot2c_f32_bf16 v16, v172, v80
  v_dot2c_f32_bf16 v17, v172, v81
  v_dot2c_f32_bf16 v18, v173, v80
  v_dot2c_f32_bf16 v19, v173, v81
  v_dot2c_f32_bf16 v20, v174, v80
  v_dot2c_f32_bf16 v21, v174, v81
  v_dot2c_f32_bf16 v22, v175, v80
  v_dot2c_f32_bf16 v23, v175, v81
  v_cvt_pk_bf16_f32 v80, v64, 0
  v_cvt_pk_bf16_f32 v81, 0, v64
  v_dot2c_f32_bf16 v16, v176, v80
  v_dot2c_f32_bf16 v17, v176, v81
  v_dot2c_f32_bf16 v18, v177, v80
  v_dot2c_f32_bf16 v19, v177, v81
  v_dot2c_f32_bf16 v20, v178, v80
  v_dot2c_f32_bf16 v21, v178, v81
  v_dot2c_f32_bf16 v22, v179, v80
  v_dot2c_f32_bf16 v23, v179, v81
  v_cvt_pk_bf16_f32 v80, v65, 0
  v_cvt_pk_bf16_f32 v81, 0, v65
  v_dot2c_f32_bf16 v16, v180, v80
  v_dot2c_f32_bf16 v17, v180, v81
  v_dot2c_f32_bf16 v18, v181, v80
  v_dot2c_f32_bf16 v19, v181, v81
  v_dot2c_f32_bf16 v20, v182, v80
  v_dot2c_f32_bf16 v21, v182, v81
  v_dot2c_f32_bf16 v22, v183, v80
  v_dot2c_f32_bf16 v23, v183, v81
  v_cvt_pk_bf16_f32 v80, v66, 0
  v_cvt_pk_bf16_f32 v81, 0, v66
  v_dot2c_f32_bf16 v16, v184, v80
  v_dot2c_f32_bf16 v17, v184, v81
  v_dot2c_f32_bf16 v18, v185, v80
  v_dot2c_f32_bf16 v19, v185, v81
  v_dot2c_f32_bf16 v20, v186, v80
  v_dot2c_f32_bf16 v21, v186, v81
  v_dot2c_f32_bf16 v22, v187, v80
  v_dot2c_f32_bf16 v23, v187, v81
  v_cvt_pk_bf16_f32 v80, v67, 0
  v_cvt_pk_bf16_f32 v81, 0, v67
  v_dot2c_f32_bf16 v16, v188, v80
  v_dot2c_f32_bf16 v17, v188, v81
  v_dot2c_f32_bf16 v18, v189, v80
  v_dot2c_f32_bf16 v19, v189, v81
  v_dot2c_f32_bf16 v20, v190, v80
  v_dot2c_f32_bf16 v21, v190, v81
  v_dot2c_f32_bf16 v22, v191, v80
  v_dot2c_f32_bf16 v23, v191, v81
  global_load_dwordx4 v[168:171], v6, s[46:47]
  s_add_u32 s46, s46, 10240
  s_addc_u32 s47, s47, 0
  global_load_dwordx4 v[172:175], v6, s[46:47]
  s_add_u32 s46, s46, 10240
  s_addc_u32 s47, s47, 0
  global_load_dwordx4 v[176:179], v6, s[46:47]
  s_add_u32 s46, s46, 10240
  s_addc_u32 s47, s47, 0
  global_load_dwordx4 v[180:183], v6, s[46:47]
  s_add_u32 s46, s46, 10240
  s_addc_u32 s47, s47, 0
  global_load_dwordx4 v[184:187], v6, s[46:47]
  s_add_u32 s46, s46, 10240
  s_addc_u32 s47, s47, 0
  global_load_dwordx4 v[188:191], v6, s[46:47]
  s_add_u32 s46, s46, 10240
  s_addc_u32 s47, s47, 0
  s_waitcnt vmcnt(30)
  v_cvt_pk_bf16_f32 v80, v68, 0
  v_cvt_pk_bf16_f32 v81, 0, v68
  v_dot2c_f32_bf16 v16, v96, v80
  v_dot2c_f32_bf16 v17, v96, v81
  v_dot2c_f32_bf16 v18, v97, v80
  v_dot2c_f32_bf16 v19, v97, v81
  v_dot2c_f32_bf16 v20, v98, v80
  v_dot2c_f32_bf16 v21, v98, v81
  v_dot2c_f32_bf16 v22, v99, v80
  v_dot2c_f32_bf16 v23, v99, v81
  v_cvt_pk_bf16_f32 v80, v69, 0
  v_cvt_pk_bf16_f32 v81, 0, v69
  v_dot2c_f32_bf16 v16, v100, v80
  v_dot2c_f32_bf16 v17, v100, v81
  v_dot2c_f32_bf16 v18, v101, v80
  v_dot2c_f32_bf16 v19, v101, v81
  v_dot2c_f32_bf16 v20, v102, v80
  v_dot2c_f32_bf16 v21, v102, v81
  v_dot2c_f32_bf16 v22, v103, v80
  v_dot2c_f32_bf16 v23, v103, v81
  v_cvt_pk_bf16_f32 v80, v70, 0
  v_cvt_pk_bf16_f32 v81, 0, v70
  v_dot2c_f32_bf16 v16, v104, v80
  v_dot2c_f32_bf16 v17, v104, v81
  v_dot2c_f32_bf16 v18, v105, v80
  v_dot2c_f32_bf16 v19, v105, v81
  v_dot2c_f32_bf16 v20, v106, v80
  v_dot2c_f32_bf16 v21, v106, v81
  v_dot2c_f32_bf16 v22, v107, v80
  v_dot2c_f32_bf16 v23, v107, v81
  v_cvt_pk_bf16_f32 v80, v71, 0
  v_cvt_pk_bf16_f32 v81, 0, v71
  v_dot2c_f32_bf16 v16, v108, v80
  v_dot2c_f32_bf16 v17, v108, v81
  v_dot2c_f32_bf16 v18, v109, v80
  v_dot2c_f32_bf16 v19, v109, v81
  v_dot2c_f32_bf16 v20, v110, v80
  v_dot2c_f32_bf16 v21, v110, v81
  v_dot2c_f32_bf16 v22, v111, v80
  v_dot2c_f32_bf16 v23, v111, v81
  v_cvt_pk_bf16_f32 v80, v72, 0
  v_cvt_pk_bf16_f32 v81, 0, v72
  v_dot2c_f32_bf16 v16, v112, v80
  v_dot2c_f32_bf16 v17, v112, v81
  v_dot2c_f32_bf16 v18, v113, v80
  v_dot2c_f32_bf16 v19, v113, v81
  v_dot2c_f32_bf16 v20, v114, v80
  v_dot2c_f32_bf16 v21, v114, v81
  v_dot2c_f32_bf16 v22, v115, v80
  v_dot2c_f32_bf16 v23, v115, v81
  v_cvt_pk_bf16_f32 v80, v73, 0
  v_cvt_pk_bf16_f32 v81, 0, v73
  v_dot2c_f32_bf16 v16, v116, v80
  v_dot2c_f32_bf16 v17, v116, v81
  v_dot2c_f32_bf16 v18, v117, v80
  v_dot2c_f32_bf16 v19, v117, v81
  v_dot2c_f32_bf16 v20, v118, v80
  v_dot2c_f32_bf16 v21, v118, v81
  v_dot2c_f32_bf16 v22, v119, v80
  v_dot2c_f32_bf16 v23, v119, v81
  s_waitcnt vmcnt(24)
  v_cvt_pk_bf16_f32 v80, v74, 0
  v_cvt_pk_bf16_f32 v81, 0, v74
  v_dot2c_f32_bf16 v16, v120, v80
  v_dot2c_f32_bf16 v17, v120, v81
  v_dot2c_f32_bf16 v18, v121, v80
  v_dot2c_f32_bf16 v19, v121, v81
  v_dot2c_f32_bf16 v20, v122, v80
  v_dot2c_f32_bf16 v21, v122, v81
  v_dot2c_f32_bf16 v22, v123, v80
  v_dot2c_f32_bf16 v23, v123, v81
  v_cvt_pk_bf16_f32 v80, v75, 0
  v_cvt_pk_bf16_f32 v81, 0, v75
  v_dot2c_f32_bf16 v16, v124, v80
  v_dot2c_f32_bf16 v17, v124, v81
  v_dot2c_f32_bf16 v18, v125, v80
  v_dot2c_f32_bf16 v19, v125, v81
  v_dot2c_f32_bf16 v20, v126, v80
  v_dot2c_f32_bf16 v21, v126, v81
  v_dot2c_f32_bf16 v22, v127, v80
  v_dot2c_f32_bf16 v23, v127, v81
  v_cvt_pk_bf16_f32 v80, v76, 0
  v_cvt_pk_bf16_f32 v81, 0, v76
  v_dot2c_f32_bf16 v16, v128, v80
  v_dot2c_f32_bf16 v17, v128, v81
  v_dot2c_f32_bf16 v18, v129, v80
  v_dot2c_f32_bf16 v19, v129, v81
  v_dot2c_f32_bf16 v20, v130, v80
  v_dot2c_f32_bf16 v21, v130, v81
  v_dot2c_f32_bf16 v22, v131, v80
  v_dot2c_f32_bf16 v23, v131, v81
  v_cvt_pk_bf16_f32 v80, v77, 0
  v_cvt_pk_bf16_f32 v81, 0, v77
  v_dot2c_f32_bf16 v16, v132, v80
  v_dot2c_f32_bf16 v17, v132, v81
  v_dot2c_f32_bf16 v18, v133, v80
  v_dot2c_f32_bf16 v19, v133, v81
  v_dot2c_f32_bf16 v20, v134, v80
  v_dot2c_f32_bf16 v21, v134, v81
  v_dot2c_f32_bf16 v22, v135, v80
  v_dot2c_f32_bf16 v23, v135, v81
  v_cvt_pk_bf16_f32 v80, v78, 0
  v_cvt_pk_bf16_f32 v81, 0, v78
  v_dot2c_f32_bf16 v16, v136, v80
  v_dot2c_f32_bf16 v17, v136, v81
  v_dot2c_f32_bf16 v18, v137, v80
  v_dot2c_f32_bf16 v19, v137, v81
  v_dot2c_f32_bf16 v20, v138, v80
  v_dot2c_f32_bf16 v21, v138, v81
  v_dot2c_f32_bf16 v22, v139, v80
  v_dot2c_f32_bf16 v23, v139, v81
  v_cvt_pk_bf16_f32 v80, v79, 0
  v_cvt_pk_bf16_f32 v81, 0, v79
  v_dot2c_f32_bf16 v16, v140, v80
  v_dot2c_f32_bf16 v17, v140, v81
  v_dot2c_f32_bf16 v18, v141, v80
  v_dot2c_f32_bf16 v19, v141, v81
  v_dot2c_f32_bf16 v20, v142, v80
  v_dot2c_f32_bf16 v21, v142, v81
  v_dot2c_f32_bf16 v22, v143, v80
  v_dot2c_f32_bf16 v23, v143, v81
  s_nop 3
  v_add_f32_dpp v16, v16, v16 row_ror:8 row_mask:0xf bank_mask:0xf
  v_add_f32_dpp v17, v17, v17 row_ror:8 row_mask:0xf bank_mask:0xf
  v_add_f32_dpp v18, v18, v18 row_ror:8 row_mask:0xf bank_mask:0xf
  v_add_f32_dpp v19, v19, v19 row_ror:8 row_mask:0xf bank_mask:0xf
  v_add_f32_dpp v20, v20, v20 row_ror:8 row_mask:0xf bank_mask:0xf
  v_add_f32_dpp v21, v21, v21 row_ror:8 row_mask:0xf bank_mask:0xf
  v_add_f32_dpp v22, v22, v22 row_ror:8 row_mask:0xf bank_mask:0xf
  v_add_f32_dpp v23, v23, v23 row_ror:8 row_mask:0xf bank_mask:0xf
  v_mov_b32 v80, v16
  v_mov_b32 v81, v17
  v_mov_b32 v82, v18
  v_mov_b32 v83, v19
  v_mov_b32 v84, v20
  v_mov_b32 v85, v21
  v_mov_b32 v86, v22
  v_mov_b32 v87, v23
  v_permlane16_swap_b32 v16, v80
  v_permlane16_swap_b32 v17, v81
  v_permlane16_swap_b32 v18, v82
  v_permlane16_swap_b32 v19, v83
  v_permlane16_swap_b32 v20, v84
  v_permlane16_swap_b32 v21, v85
  v_permlane16_swap_b32 v22, v86
  v_permlane16_swap_b32 v23, v87
  v_add_f32 v16, v16, v80
  v_add_f32 v17, v17, v81
  v_add_f32 v18, v18, v82
  v_add_f32 v19, v19, v83
  v_add_f32 v20, v20, v84
  v_add_f32 v21, v21, v85
  v_add_f32 v22, v22, v86
  v_add_f32 v23, v23, v87
  v_mov_b32 v80, v16
  v_mov_b32 v81, v17
  v_mov_b32 v82, v18
  v_mov_b32 v83, v19
  v_mov_b32 v84, v20
  v_mov_b32 v85, v21
  v_mov_b32 v86, v22
  v_mov_b32 v87, v23
  v_permlane32_swap_b32 v16, v80
  v_permlane32_swap_b32 v17, v81
  v_permlane32_swap_b32 v18, v82
  v_permlane32_swap_b32 v19, v83
  v_permlane32_swap_b32 v20, v84
  v_permlane32_swap_b32 v21, v85
  v_permlane32_swap_b32 v22, v86
  v_permlane32_swap_b32 v23, v87
  v_add_f32 v16, v16, v80
  v_add_f32 v17, v17, v81
  v_add_f32 v18, v18, v82
  v_add_f32 v19, v19, v83
  v_add_f32 v20, v20, v84
  v_add_f32 v21, v21, v85
  v_add_f32 v22, v22, v86
  v_add_f32 v23, v23, v87
  v_lshlrev_b32 v80, 8, v3
  v_add_u32 v80, v80, v9
  s_mov_b64 exec, 0xff
  global_store_dwordx4 v80, v[16:19], s[34:35] offset:0
  global_store_dwordx4 v80, v[20:23], s[34:35] offset:16
  s_mov_b64 exec, -1
  s_waitcnt vmcnt(20)
  v_cvt_pk_bf16_f32 v80, v56, 0
  v_cvt_pk_bf16_f32 v81, 0, v56
  v_dot2c_f32_bf16 v24, v192, v80
  v_dot2c_f32_bf16 v25, v192, v81
  v_dot2c_f32_bf16 v26, v193, v80
  v_dot2c_f32_bf16 v27, v193, v81
  v_dot2c_f32_bf16 v28, v194, v80
  v_dot2c_f32_bf16 v29, v194, v81
  v_dot2c_f32_bf16 v30, v195, v80
  v_dot2c_f32_bf16 v31, v195, v81
  v_cvt_pk_bf16_f32 v80, v57, 0
  v_cvt_pk_bf16_f32 v81, 0, v57
  v_dot2c_f32_bf16 v24, v196, v80
  v_dot2c_f32_bf16 v25, v196, v81
  v_dot2c_f32_bf16 v26, v197, v80
  v_dot2c_f32_bf16 v27, v197, v81
  v_dot2c_f32_bf16 v28, v198, v80
  v_dot2c_f32_bf16 v29, v198, v81
  v_dot2c_f32_bf16 v30, v199, v80
  v_dot2c_f32_bf16 v31, v199, v81
  v_cvt_pk_bf16_f32 v80, v58, 0
  v_cvt_pk_bf16_f32 v81, 0, v58
  v_dot2c_f32_bf16 v24, v200, v80
  v_dot2c_f32_bf16 v25, v200, v81
  v_dot2c_f32_bf16 v26, v201, v80
  v_dot2c_f32_bf16 v27, v201, v81
  v_dot2c_f32_bf16 v28, v202, v80
  v_dot2c_f32_bf16 v29, v202, v81
  v_dot2c_f32_bf16 v30, v203, v80
  v_dot2c_f32_bf16 v31, v203, v81
  v_cvt_pk_bf16_f32 v80, v59, 0
  v_cvt_pk_bf16_f32 v81, 0, v59
  v_dot2c_f32_bf16 v24, v204, v80
  v_dot2c_f32_bf16 v25, v204, v81
  v_dot2c_f32_bf16 v26, v205, v80
  v_dot2c_f32_bf16 v27, v205, v81
  v_dot2c_f32_bf16 v28, v206, v80
  v_dot2c_f32_bf16 v29, v206, v81
  v_dot2c_f32_bf16 v30, v207, v80
  v_dot2c_f32_bf16 v31, v207, v81
  v_cvt_pk_bf16_f32 v80, v60, 0
  v_cvt_pk_bf16_f32 v81, 0, v60
  v_dot2c_f32_bf16 v24, v208, v80
  v_dot2c_f32_bf16 v25, v208, v81
  v_dot2c_f32_bf16 v26, v209, v80
  v_dot2c_f32_bf16 v27, v209, v81
  v_dot2c_f32_bf16 v28, v210, v80
  v_dot2c_f32_bf16 v29, v210, v81
  v_dot2c_f32_bf16 v30, v211, v80
  v_dot2c_f32_bf16 v31, v211, v81
  v_cvt_pk_bf16_f32 v80, v61, 0
  v_cvt_pk_bf16_f32 v81, 0, v61
  v_dot2c_f32_bf16 v24, v212, v80
  v_dot2c_f32_bf16 v25, v212, v81
  v_dot2c_f32_bf16 v26, v213, v80
  v_dot2c_f32_bf16 v27, v213, v81
  v_dot2c_f32_bf16 v28, v214, v80
  v_dot2c_f32_bf16 v29, v214, v81
  v_dot2c_f32_bf16 v30, v215, v80
  v_dot2c_f32_bf16 v31, v215, v81
  s_waitcnt vmcnt(14)
  v_cvt_pk_bf16_f32 v80, v62, 0
  v_cvt_pk_bf16_f32 v81, 0, v62
  v_dot2c_f32_bf16 v24, v216, v80
  v_dot2c_f32_bf16 v25, v216, v81
  v_dot2c_f32_bf16 v26, v217, v80
  v_dot2c_f32_bf16 v27, v217, v81
  v_dot2c_f32_bf16 v28, v218, v80
  v_dot2c_f32_bf16 v29, v218, v81
  v_dot2c_f32_bf16 v30, v219, v80
  v_dot2c_f32_bf16 v31, v219, v81
  v_cvt_pk_bf16_f32 v80, v63, 0
  v_cvt_pk_bf16_f32 v81, 0, v63
  v_dot2c_f32_bf16 v24, v220, v80
  v_dot2c_f32_bf16 v25, v220, v81
  v_dot2c_f32_bf16 v26, v221, v80
  v_dot2c_f32_bf16 v27, v221, v81
  v_dot2c_f32_bf16 v28, v222, v80
  v_dot2c_f32_bf16 v29, v222, v81
  v_dot2c_f32_bf16 v30, v223, v80
  v_dot2c_f32_bf16 v31, v223, v81
  v_cvt_pk_bf16_f32 v80, v64, 0
  v_cvt_pk_bf16_f32 v81, 0, v64
  v_dot2c_f32_bf16 v24, v224, v80
  v_dot2c_f32_bf16 v25, v224, v81
  v_dot2c_f32_bf16 v26, v225, v80
  v_dot2c_f32_bf16 v27, v225, v81
  v_dot2c_f32_bf16 v28, v226, v80
  v_dot2c_f32_bf16 v29, v226, v81
  v_dot2c_f32_bf16 v30, v227, v80
  v_dot2c_f32_bf16 v31, v227, v81
  v_cvt_pk_bf16_f32 v80, v65, 0
  v_cvt_pk_bf16_f32 v81, 0, v65
  v_dot2c_f32_bf16 v24, v228, v80
  v_dot2c_f32_bf16 v25, v228, v81
  v_dot2c_f32_bf16 v26, v229, v80
  v_dot2c_f32_bf16 v27, v229, v81
  v_dot2c_f32_bf16 v28, v230, v80
  v_dot2c_f32_bf16 v29, v230, v81
  v_dot2c_f32_bf16 v30, v231, v80
  v_dot2c_f32_bf16 v31, v231, v81
  v_cvt_pk_bf16_f32 v80, v66, 0
  v_cvt_pk_bf16_f32 v81, 0, v66
  v_dot2c_f32_bf16 v24, v232, v80
  v_dot2c_f32_bf16 v25, v232, v81
  v_dot2c_f32_bf16 v26, v233, v80
  v_dot2c_f32_bf16 v27, v233, v81
  v_dot2c_f32_bf16 v28, v234, v80
  v_dot2c_f32_bf16 v29, v234, v81
  v_dot2c_f32_bf16 v30, v235, v80
  v_dot2c_f32_bf16 v31, v235, v81
  v_cvt_pk_bf16_f32 v80, v67, 0
  v_cvt_pk_bf16_f32 v81, 0, v67
  v_dot2c_f32_bf16 v24, v236, v80
  v_dot2c_f32_bf16 v25, v236, v81
  v_dot2c_f32_bf16 v26, v237, v80
  v_dot2c_f32_bf16 v27, v237, v81
  v_dot2c_f32_bf16 v28, v238, v80
  v_dot2c_f32_bf16 v29, v238, v81
  v_dot2c_f32_bf16 v30, v239, v80
  v_dot2c_f32_bf16 v31, v239, v81
  s_waitcnt vmcnt(8)
  v_cvt_pk_bf16_f32 v80, v68, 0
  v_cvt_pk_bf16_f32 v81, 0, v68
  v_dot2c_f32_bf16 v24, v144, v80
  v_dot2c_f32_bf16 v25, v144, v81
  v_dot2c_f32_bf16 v26, v145, v80
  v_dot2c_f32_bf16 v27, v145, v81
  v_dot2c_f32_bf16 v28, v146, v80
  v_dot2c_f32_bf16 v29, v146, v81
  v_dot2c_f32_bf16 v30, v147, v80
  v_dot2c_f32_bf16 v31, v147, v81
  v_cvt_pk_bf16_f32 v80, v69, 0
  v_cvt_pk_bf16_f32 v81, 0, v69
  v_dot2c_f32_bf16 v24, v148, v80
  v_dot2c_f32_bf16 v25, v148, v81
  v_dot2c_f32_bf16 v26, v149, v80
  v_dot2c_f32_bf16 v27, v149, v81
  v_dot2c_f32_bf16 v28, v150, v80
  v_dot2c_f32_bf16 v29, v150, v81
  v_dot2c_f32_bf16 v30, v151, v80
  v_dot2c_f32_bf16 v31, v151, v81
  v_cvt_pk_bf16_f32 v80, v70, 0
  v_cvt_pk_bf16_f32 v81, 0, v70
  v_dot2c_f32_bf16 v24, v152, v80
  v_dot2c_f32_bf16 v25, v152, v81
  v_dot2c_f32_bf16 v26, v153, v80
  v_dot2c_f32_bf16 v27, v153, v81
  v_dot2c_f32_bf16 v28, v154, v80
  v_dot2c_f32_bf16 v29, v154, v81
  v_dot2c_f32_bf16 v30, v155, v80
  v_dot2c_f32_bf16 v31, v155, v81
  v_cvt_pk_bf16_f32 v80, v71, 0
  v_cvt_pk_bf16_f32 v81, 0, v71
  v_dot2c_f32_bf16 v24, v156, v80
  v_dot2c_f32_bf16 v25, v156, v81
  v_dot2c_f32_bf16 v26, v157, v80
  v_dot2c_f32_bf16 v27, v157, v81
  v_dot2c_f32_bf16 v28, v158, v80
  v_dot2c_f32_bf16 v29, v158, v81
  v_dot2c_f32_bf16 v30, v159, v80
  v_dot2c_f32_bf16 v31, v159, v81
  v_cvt_pk_bf16_f32 v80, v72, 0
  v_cvt_pk_bf16_f32 v81, 0, v72
  v_dot2c_f32_bf16 v24, v160, v80
  v_dot2c_f32_bf16 v25, v160, v81
  v_dot2c_f32_bf16 v26, v161, v80
  v_dot2c_f32_bf16 v27, v161, v81
  v_dot2c_f32_bf16 v28, v162, v80
  v_dot2c_f32_bf16 v29, v162, v81
  v_dot2c_f32_bf16 v30, v163, v80
  v_dot2c_f32_bf16 v31, v163, v81
  v_cvt_pk_bf16_f32 v80, v73, 0
  v_cvt_pk_bf16_f32 v81, 0, v73
  v_dot2c_f32_bf16 v24, v164, v80
  v_dot2c_f32_bf16 v25, v164, v81
  v_dot2c_f32_bf16 v26, v165, v80
  v_dot2c_f32_bf16 v27, v165, v81
  v_dot2c_f32_bf16 v28, v166, v80
  v_dot2c_f32_bf16 v29, v166, v81
  v_dot2c_f32_bf16 v30, v167, v80
  v_dot2c_f32_bf16 v31, v167, v81
  s_waitcnt vmcnt(2)
  v_cvt_pk_bf16_f32 v80, v74, 0
  v_cvt_pk_bf16_f32 v81, 0, v74
  v_dot2c_f32_bf16 v24, v168, v80
  v_dot2c_f32_bf16 v25, v168, v81
  v_dot2c_f32_bf16 v26, v169, v80
  v_dot2c_f32_bf16 v27, v169, v81
  v_dot2c_f32_bf16 v28, v170, v80
  v_dot2c_f32_bf16 v29, v170, v81
  v_dot2c_f32_bf16 v30, v171, v80
  v_dot2c_f32_bf16 v31, v171, v81
  v_cvt_pk_bf16_f32 v80, v75, 0
  v_cvt_pk_bf16_f32 v81, 0, v75
  v_dot2c_f32_bf16 v24, v172, v80
  v_dot2c_f32_bf16 v25, v172, v81
  v_dot2c_f32_bf16 v26, v173, v80
  v_dot2c_f32_bf16 v27, v173, v81
  v_dot2c_f32_bf16 v28, v174, v80
  v_dot2c_f32_bf16 v29, v174, v81
  v_dot2c_f32_bf16 v30, v175, v80
  v_dot2c_f32_bf16 v31, v175, v81
  v_cvt_pk_bf16_f32 v80, v76, 0
  v_cvt_pk_bf16_f32 v81, 0, v76
  v_dot2c_f32_bf16 v24, v176, v80
  v_dot2c_f32_bf16 v25, v176, v81
  v_dot2c_f32_bf16 v26, v177, v80
  v_dot2c_f32_bf16 v27, v177, v81
  v_dot2c_f32_bf16 v28, v178, v80
  v_dot2c_f32_bf16 v29, v178, v81
  v_dot2c_f32_bf16 v30, v179, v80
  v_dot2c_f32_bf16 v31, v179, v81
  v_cvt_pk_bf16_f32 v80, v77, 0
  v_cvt_pk_bf16_f32 v81, 0, v77
  v_dot2c_f32_bf16 v24, v180, v80
  v_dot2c_f32_bf16 v25, v180, v81
  v_dot2c_f32_bf16 v26, v181, v80
  v_dot2c_f32_bf16 v27, v181, v81
  v_dot2c_f32_bf16 v28, v182, v80
  v_dot2c_f32_bf16 v29, v182, v81
  v_dot2c_f32_bf16 v30, v183, v80
  v_dot2c_f32_bf16 v31, v183, v81
  v_cvt_pk_bf16_f32 v80, v78, 0
  v_cvt_pk_bf16_f32 v81, 0, v78
  v_dot2c_f32_bf16 v24, v184, v80
  v_dot2c_f32_bf16 v25, v184, v81
  v_dot2c_f32_bf16 v26, v185, v80
  v_dot2c_f32_bf16 v27, v185, v81
  v_dot2c_f32_bf16 v28, v186, v80
  v_dot2c_f32_bf16 v29, v186, v81
  v_dot2c_f32_bf16 v30, v187, v80
  v_dot2c_f32_bf16 v31, v187, v81
  v_cvt_pk_bf16_f32 v80, v79, 0
  v_cvt_pk_bf16_f32 v81, 0, v79
  v_dot2c_f32_bf16 v24, v188, v80
  v_dot2c_f32_bf16 v25, v188, v81
  v_dot2c_f32_bf16 v26, v189, v80
  v_dot2c_f32_bf16 v27, v189, v81
  v_dot2c_f32_bf16 v28, v190, v80
  v_dot2c_f32_bf16 v29, v190, v81
  v_dot2c_f32_bf16 v30, v191, v80
  v_dot2c_f32_bf16 v31, v191, v81
  s_nop 3
  v_add_f32_dpp v24, v24, v24 row_ror:8 row_mask:0xf bank_mask:0xf
  v_add_f32_dpp v25, v25, v25 row_ror:8 row_mask:0xf bank_mask:0xf
  v_add_f32_dpp v26, v26, v26 row_ror:8 row_mask:0xf bank_mask:0xf
  v_add_f32_dpp v27, v27, v27 row_ror:8 row_mask:0xf bank_mask:0xf
  v_add_f32_dpp v28, v28, v28 row_ror:8 row_mask:0xf bank_mask:0xf
  v_add_f32_dpp v29, v29, v29 row_ror:8 row_mask:0xf bank_mask:0xf
  v_add_f32_dpp v30, v30, v30 row_ror:8 row_mask:0xf bank_mask:0xf
  v_add_f32_dpp v31, v31, v31 row_ror:8 row_mask:0xf bank_mask:0xf
  v_mov_b32 v80, v24
  v_mov_b32 v81, v25
  v_mov_b32 v82, v26
  v_mov_b32 v83, v27
  v_mov_b32 v84, v28
  v_mov_b32 v85, v29
  v_mov_b32 v86, v30
  v_mov_b32 v87, v31
  v_permlane16_swap_b32 v24, v80
  v_permlane16_swap_b32 v25, v81
  v_permlane16_swap_b32 v26, v82
  v_permlane16_swap_b32 v27, v83
  v_permlane16_swap_b32 v28, v84
  v_permlane16_swap_b32 v29, v85
  v_permlane16_swap_b32 v30, v86
  v_permlane16_swap_b32 v31, v87
  v_add_f32 v24, v24, v80
  v_add_f32 v25, v25, v81
  v_add_f32 v26, v26, v82
  v_add_f32 v27, v27, v83
  v_add_f32 v28, v28, v84
  v_add_f32 v29, v29, v85
  v_add_f32 v30, v30, v86
  v_add_f32 v31, v31, v87
  v_mov_b32 v80, v24
  v_mov_b32 v81, v25
  v_mov_b32 v82, v26
  v_mov_b32 v83, v27
  v_mov_b32 v84, v28
  v_mov_b32 v85, v29
  v_mov_b32 v86, v30
  v_mov_b32 v87, v31
  v_permlane32_swap_b32 v24, v80
  v_permlane32_swap_b32 v25, v81
  v_permlane32_swap_b32 v26, v82
  v_permlane32_swap_b32 v27, v83
  v_permlane32_swap_b32 v28, v84
  v_permlane32_swap_b32 v29, v85
  v_permlane32_swap_b32 v30, v86
  v_permlane32_swap_b32 v31, v87
  v_add_f32 v24, v24, v80
  v_add_f32 v25, v25, v81
  v_add_f32 v26, v26, v82
  v_add_f32 v27, v27, v83
  v_add_f32 v28, v28, v84
  v_add_f32 v29, v29, v85
  v_add_f32 v30, v30, v86
  v_add_f32 v31, v31, v87
  v_lshlrev_b32 v80, 8, v3
  v_add_u32 v80, v80, v9
  s_mov_b64 exec, 0xff
  global_store_dwordx4 v80, v[24:27], s[34:35] offset:1024
  global_store_dwordx4 v80, v[28:31], s[34:35] offset:1040
  s_mov_b64 exec, -1
  s_branch L_end
L_ffn:
  s_setprio 2
  v_mov_b32 v61, v81
  v_mov_b32 v62, v82
  s_sub_u32 s32, s2, 256
  s_mul_i32 s30, s32, 43691
  s_lshr_b32 s30, s30, 20
  s_mul_i32 s33, s30, 24
  s_sub_u32 s31, s32, s33
  s_mul_i32 s32, s30, 1280
  s_add_u32 s44, s4, s32
  s_addc_u32 s45, s5, 0
  s_mul_i32 s32, s31, 128
  s_add_u32 s34, s16, s32
  s_addc_u32 s35, s17, 0
  s_add_u32 s36, s18, s32
  s_addc_u32 s37, s19, 0
  s_mul_i32 s32, s31, 81920
  s_add_u32 s42, s20, s32
  s_addc_u32 s43, s21, 0
  v_mul_u32_u24 v4, 3072, v61
  v_add_u32 v4, v4, v62
  v_mul_u32_u24 v8, 256, v3
  v_add_u32 v8, v8, v9
  global_load_ushort v40, v7, s[44:45] offset:0
  global_load_ushort v41, v7, s[44:45] offset:16
  global_load_ushort v42, v7, s[44:45] offset:32
  global_load_ushort v43, v7, s[44:45] offset:48
  global_load_ushort v44, v7, s[44:45] offset:64
  global_load_ushort v45, v7, s[44:45] offset:80
  global_load_ushort v46, v7, s[44:45] offset:96
  global_load_ushort v47, v7, s[44:45] offset:112
  global_load_ushort v48, v7, s[44:45] offset:128
  global_load_ushort v49, v7, s[44:45] offset:144
  global_load_ushort v50, v7, s[44:45] offset:160
  global_load_ushort v51, v7, s[44:45] offset:176
  global_load_ushort v52, v7, s[44:45] offset:192
  global_load_ushort v53, v7, s[44:45] offset:208
  global_load_ushort v54, v7, s[44:45] offset:224
  global_load_ushort v55, v7, s[44:45] offset:240
  global_load_ushort v56, v7, s[44:45] offset:256
  global_load_ushort v57, v7, s[44:45] offset:272
  global_load_ushort v58, v7, s[44:45] offset:288
  global_load_ushort v59, v7, s[44:45] offset:304
  s_lshl_b32 s32, s31, 3
  s_add_u32 s32, s32, s30
  s_mul_i32 s32, s32, 2560
  s_add_u32 s32, s32, 655360
  s_add_u32 s38, s28, s32
  s_addc_u32 s39, s29, 0
  global_load_dwordx4 v[80:83], v4, s[34:35]
  global_load_dwordx4 v[88:91], v4, s[36:37]
  s_add_u32 s34, s34, 24576
  s_addc_u32 s35, s35, 0
  s_add_u32 s36, s36, 24576
  s_addc_u32 s37, s37, 0
  global_load_dwordx4 v[84:87], v4, s[34:35]
  global_load_dwordx4 v[92:95], v4, s[36:37]
  s_add_u32 s34, s34, 24576
  s_addc_u32 s35, s35, 0
  s_add_u32 s36, s36, 24576
  s_addc_u32 s37, s37, 0
  global_load_dwordx4 v[96:99], v4, s[34:35]
  global_load_dwordx4 v[104:107], v4, s[36:37]
  s_add_u32 s34, s34, 24576
  s_addc_u32 s35, s35, 0
  s_add_u32 s36, s36, 24576
  s_addc_u32 s37, s37, 0
  global_load_dwordx4 v[100:103], v4, s[34:35]
  global_load_dwordx4 v[108:111], v4, s[36:37]
  s_add_u32 s34, s34, 24576
  s_addc_u32 s35, s35, 0
  s_add_u32 s36, s36, 24576
  s_addc_u32 s37, s37, 0
  global_load_dwordx4 v[112:115], v4, s[34:35]
  global_load_dwordx4 v[120:123], v4, s[36:37]
  s_add_u32 s34, s34, 24576
  s_addc_u32 s35, s35, 0
  s_add_u32 s36, s36, 24576
  s_addc_u32 s37, s37, 0
  global_load_dwordx4 v[116:119], v4, s[34:35]
  global_load_dwordx4 v[124:127], v4, s[36:37]
  s_add_u32 s34, s34, 24576
  s_addc_u32 s35, s35, 0
  s_add_u32 s36, s36, 24576
  s_addc_u32 s37, s37, 0
  global_load_dwordx4 v[128:131], v4, s[34:35]
  global_load_dwordx4 v[136:139], v4, s[36:37]
  s_add_u32 s34, s34, 24576
  s_addc_u32 s35, s35, 0
  s_add_u32 s36, s36, 24576
  s_addc_u32 s37, s37, 0
  global_load_dwordx4 v[132:135], v4, s[34:35]
  global_load_dwordx4 v[140:143], v4, s[36:37]
  s_add_u32 s34, s34, 24576
  s_addc_u32 s35, s35, 0
  s_add_u32 s36, s36, 24576
  s_addc_u32 s37, s37, 0
  global_load_dwordx4 v[144:147], v4, s[34:35]
  global_load_dwordx4 v[152:155], v4, s[36:37]
  s_add_u32 s34, s34, 24576
  s_addc_u32 s35, s35, 0
  s_add_u32 s36, s36, 24576
  s_addc_u32 s37, s37, 0
  global_load_dwordx4 v[148:151], v4, s[34:35]
  global_load_dwordx4 v[156:159], v4, s[36:37]
  s_add_u32 s34, s34, 24576
  s_addc_u32 s35, s35, 0
  s_add_u32 s36, s36, 24576
  s_addc_u32 s37, s37, 0
  global_load_dwordx4 v[160:163], v4, s[34:35]
  global_load_dwordx4 v[168:171], v4, s[36:37]
  s_add_u32 s34, s34, 24576
  s_addc_u32 s35, s35, 0
  s_add_u32 s36, s36, 24576
  s_addc_u32 s37, s37, 0
  global_load_dwordx4 v[164:167], v4, s[34:35]
  global_load_dwordx4 v[172:175], v4, s[36:37]
  s_add_u32 s34, s34, 24576
  s_addc_u32 s35, s35, 0
  s_add_u32 s36, s36, 24576
  s_addc_u32 s37, s37, 0
  global_load_dwordx4 v[176:179], v4, s[34:35]
  global_load_dwordx4 v[184:187], v4, s[36:37]
  s_add_u32 s34, s34, 24576
  s_addc_u32 s35, s35, 0
  s_add_u32 s36, s36, 24576
  s_addc_u32 s37, s37, 0
  global_load_dwordx4 v[180:183], v4, s[34:35]
  global_load_dwordx4 v[188:191], v4, s[36:37]
  s_add_u32 s34, s34, 24576
  s_addc_u32 s35, s35, 0
  s_add_u32 s36, s36, 24576
  s_addc_u32 s37, s37, 0
  global_load_dwordx4 v[192:195], v4, s[34:35]
  global_load_dwordx4 v[200:203], v4, s[36:37]
  s_add_u32 s34, s34, 24576
  s_addc_u32 s35, s35, 0
  s_add_u32 s36, s36, 24576
  s_addc_u32 s37, s37, 0
  global_load_dwordx4 v[196:199], v4, s[34:35]
  global_load_dwordx4 v[204:207], v4, s[36:37]
  s_add_u32 s34, s34, 24576
  s_addc_u32 s35, s35, 0
  s_add_u32 s36, s36, 24576
  s_addc_u32 s37, s37, 0
  global_load_dwordx4 v[208:211], v4, s[34:35]
  global_load_dwordx4 v[216:219], v4, s[36:37]
  s_add_u32 s34, s34, 24576
  s_addc_u32 s35, s35, 0
  s_add_u32 s36, s36, 24576
  s_addc_u32 s37, s37, 0
  global_load_dwordx4 v[212:215], v4, s[34:35]
  global_load_dwordx4 v[220:223], v4, s[36:37]
  s_add_u32 s34, s34, 24576
  s_addc_u32 s35, s35, 0
  s_add_u32 s36, s36, 24576
  s_addc_u32 s37, s37, 0
  global_load_dwordx4 v[224:227], v4, s[34:35]
  global_load_dwordx4 v[232:235], v4, s[36:37]
  s_add_u32 s34, s34, 24576
  s_addc_u32 s35, s35, 0
  s_add_u32 s36, s36, 24576
  s_addc_u32 s37, s37, 0
  global_load_dwordx4 v[228:231], v4, s[34:35]
  global_load_dwordx4 v[236:239], v4, s[36:37]
  s_add_u32 s34, s34, 24576
  s_addc_u32 s35, s35, 0
  s_add_u32 s36, s36, 24576
  s_addc_u32 s37, s37, 0
  s_waitcnt vmcnt(36)
  v_lshlrev_b32 v60, 16, v40
  v_dot2c_f32_bf16 v16, v80, v40
  v_dot2c_f32_bf16 v17, v80, v60
  v_dot2c_f32_bf16 v18, v81, v40
  v_dot2c_f32_bf16 v19, v81, v60
  v_dot2c_f32_bf16 v20, v82, v40
  v_dot2c_f32_bf16 v21, v82, v60
  v_dot2c_f32_bf16 v22, v83, v40
  v_dot2c_f32_bf16 v23, v83, v60
  v_dot2c_f32_bf16 v24, v88, v40
  v_dot2c_f32_bf16 v25, v88, v60
  v_dot2c_f32_bf16 v26, v89, v40
  v_dot2c_f32_bf16 v27, v89, v60
  v_dot2c_f32_bf16 v28, v90, v40
  v_dot2c_f32_bf16 v29, v90, v60
  v_dot2c_f32_bf16 v30, v91, v40
  v_dot2c_f32_bf16 v31, v91, v60
  v_lshlrev_b32 v60, 16, v41
  v_dot2c_f32_bf16 v16, v84, v41
  v_dot2c_f32_bf16 v17, v84, v60
  v_dot2c_f32_bf16 v18, v85, v41
  v_dot2c_f32_bf16 v19, v85, v60
  v_dot2c_f32_bf16 v20, v86, v41
  v_dot2c_f32_bf16 v21, v86, v60
  v_dot2c_f32_bf16 v22, v87, v41
  v_dot2c_f32_bf16 v23, v87, v60
  v_dot2c_f32_bf16 v24, v92, v41
  v_dot2c_f32_bf16 v25, v92, v60
  v_dot2c_f32_bf16 v26, v93, v41
  v_dot2c_f32_bf16 v27, v93, v60
  v_dot2c_f32_bf16 v28, v94, v41
  v_dot2c_f32_bf16 v29, v94, v60
  v_dot2c_f32_bf16 v30, v95, v41
  v_dot2c_f32_bf16 v31, v95, v60
  s_add_u32 s46, s42, 0
  s_addc_u32 s47, s43, 0
  global_load_dwordx4 v[80:83], v6, s[46:47]
  s_add_u32 s46, s46, 10240
  s_addc_u32 s47, s47, 0
  global_load_dwordx4 v[84:87], v6, s[46:47]
  s_add_u32 s46, s46, 10240
  s_addc_u32 s47, s47, 0
  global_load_dwordx4 v[88:91], v6, s[46:47]
  s_add_u32 s46, s46, 10240
  s_addc_u32 s47, s47, 0
  global_load_dwordx4 v[92:95], v6, s[46:47]
  s_add_u32 s46, s46, 10240
  s_addc_u32 s47, s47, 0
  s_waitcnt vmcnt(36)
  v_lshlrev_b32 v60, 16, v42
  v_dot2c_f32_bf16 v16, v96, v42
  v_dot2c_f32_bf16 v17, v96, v60
  v_dot2c_f32_bf16 v18, v97, v42
  v_dot2c_f32_bf16 v19, v97, v60
  v_dot2c_f32_bf16 v20, v98, v42
  v_dot2c_f32_bf16 v21, v98, v60
  v_dot2c_f32_bf16 v22, v99, v42
  v_dot2c_f32_bf16 v23, v99, v60
  v_dot2c_f32_bf16 v24, v104, v42
  v_dot2c_f32_bf16 v25, v104, v60
  v_dot2c_f32_bf16 v26, v105, v42
  v_dot2c_f32_bf16 v27, v105, v60
  v_dot2c_f32_bf16 v28, v106, v42
  v_dot2c_f32_bf16 v29, v106, v60
  v_dot2c_f32_bf16 v30, v107, v42
  v_dot2c_f32_bf16 v31, v107, v60
  v_lshlrev_b32 v60, 16, v43
  v_dot2c_f32_bf16 v16, v100, v43
  v_dot2c_f32_bf16 v17, v100, v60
  v_dot2c_f32_bf16 v18, v101, v43
  v_dot2c_f32_bf16 v19, v101, v60
  v_dot2c_f32_bf16 v20, v102, v43
  v_dot2c_f32_bf16 v21, v102, v60
  v_dot2c_f32_bf16 v22, v103, v43
  v_dot2c_f32_bf16 v23, v103, v60
  v_dot2c_f32_bf16 v24, v108, v43
  v_dot2c_f32_bf16 v25, v108, v60
  v_dot2c_f32_bf16 v26, v109, v43
  v_dot2c_f32_bf16 v27, v109, v60
  v_dot2c_f32_bf16 v28, v110, v43
  v_dot2c_f32_bf16 v29, v110, v60
  v_dot2c_f32_bf16 v30, v111, v43
  v_dot2c_f32_bf16 v31, v111, v60
  global_load_dwordx4 v[96:99], v6, s[46:47]
  s_add_u32 s46, s46, 10240
  s_addc_u32 s47, s47, 0
  global_load_dwordx4 v[100:103], v6, s[46:47]
  s_add_u32 s46, s46, 10240
  s_addc_u32 s47, s47, 0
  global_load_dwordx4 v[104:107], v6, s[46:47]
  s_add_u32 s46, s46, 10240
  s_addc_u32 s47, s47, 0
  global_load_dwordx4 v[108:111], v6, s[46:47]
  s_add_u32 s46, s46, 10240
  s_addc_u32 s47, s47, 0
  s_waitcnt vmcnt(36)
  v_lshlrev_b32 v60, 16, v44
  v_dot2c_f32_bf16 v16, v112, v44
  v_dot2c_f32_bf16 v17, v112, v60
  v_dot2c_f32_bf16 v18, v113, v44
  v_dot2c_f32_bf16 v19, v113, v60
  v_dot2c_f32_bf16 v20, v114, v44
  v_dot2c_f32_bf16 v21, v114, v60
  v_dot2c_f32_bf16 v22, v115, v44
  v_dot2c_f32_bf16 v23, v115, v60
  v_dot2c_f32_bf16 v24, v120, v44
  v_dot2c_f32_bf16 v25, v120, v60
  v_dot2c_f32_bf16 v26, v121, v44
  v_dot2c_f32_bf16 v27, v121, v60
  v_dot2c_f32_bf16 v28, v122, v44
  v_dot2c_f32_bf16 v29, v122, v60
  v_dot2c_f32_bf16 v30, v123, v44
  v_dot2c_f32_bf16 v31, v123, v60
  v_lshlrev_b32 v60, 16, v45
  v_dot2c_f32_bf16 v16, v116, v45
  v_dot2c_f32_bf16 v17, v116, v60
  v_dot2c_f32_bf16 v18, v117, v45
  v_dot2c_f32_bf16 v19, v117, v60
  v_dot2c_f32_bf16 v20, v118, v45
  v_dot2c_f32_bf16 v21, v118, v60
  v_dot2c_f32_bf16 v22, v119, v45
  v_dot2c_f32_bf16 v23, v119, v60
  v_dot2c_f32_bf16 v24, v124, v45
  v_dot2c_f32_bf16 v25, v124, v60
  v_dot2c_f32_bf16 v26, v125, v45
  v_dot2c_f32_bf16 v27, v125, v60
  v_dot2c_f32_bf16 v28, v126, v45
  v_dot2c_f32_bf16 v29, v126, v60
  v_dot2c_f32_bf16 v30, v127, v45
  v_dot2c_f32_bf16 v31, v127, v60
  s_add_u32 s46, s42, 512
  s_addc_u32 s47, s43, 0
  global_load_dwordx4 v[112:115], v6, s[46:47]
  s_add_u32 s46, s46, 10240
  s_addc_u32 s47, s47, 0
  global_load_dwordx4 v[116:119], v6, s[46:47]
  s_add_u32 s46, s46, 10240
  s_addc_u32 s47, s47, 0
  global_load_dwordx4 v[120:123], v6, s[46:47]
  s_add_u32 s46, s46, 10240
  s_addc_u32 s47, s47, 0
  global_load_dwordx4 v[124:127], v6, s[46:47]
  s_add_u32 s46, s46, 10240
  s_addc_u32 s47, s47, 0
  s_waitcnt vmcnt(36)
  v_lshlrev_b32 v60, 16, v46
  v_dot2c_f32_bf16 v16, v128, v46
  v_dot2c_f32_bf16 v17, v128, v60
  v_dot2c_f32_bf16 v18, v129, v46
  v_dot2c_f32_bf16 v19, v129, v60
  v_dot2c_f32_bf16 v20, v130, v46
  v_dot2c_f32_bf16 v21, v130, v60
  v_dot2c_f32_bf16 v22, v131, v46
  v_dot2c_f32_bf16 v23, v131, v60
  v_dot2c_f32_bf16 v24, v136, v46
  v_dot2c_f32_bf16 v25, v136, v60
  v_dot2c_f32_bf16 v26, v137, v46
  v_dot2c_f32_bf16 v27, v137, v60
  v_dot2c_f32_bf16 v28, v138, v46
  v_dot2c_f32_bf16 v29, v138, v60
  v_dot2c_f32_bf16 v30, v139, v46
  v_dot2c_f32_bf16 v31, v139, v60
  v_lshlrev_b32 v60, 16, v47
  v_dot2c_f32_bf16 v16, v132, v47
  v_dot2c_f32_bf16 v17, v132, v60
  v_dot2c_f32_bf16 v18, v133, v47
  v_dot2c_f32_bf16 v19, v133, v60
  v_dot2c_f32_bf16 v20, v134, v47
  v_dot2c_f32_bf16 v21, v134, v60
  v_dot2c_f32_bf16 v22, v135, v47
  v_dot2c_f32_bf16 v23, v135, v60
  v_dot2c_f32_bf16 v24, v140, v47
  v_dot2c_f32_bf16 v25, v140, v60
  v_dot2c_f32_bf16 v26, v141, v47
  v_dot2c_f32_bf16 v27, v141, v60
  v_dot2c_f32_bf16 v28, v142, v47
  v_dot2c_f32_bf16 v29, v142, v60
  v_dot2c_f32_bf16 v30, v143, v47
  v_dot2c_f32_bf16 v31, v143, v60
  global_load_dwordx4 v[128:131], v6, s[46:47]
  s_add_u32 s46, s46, 10240
  s_addc_u32 s47, s47, 0
  global_load_dwordx4 v[132:135], v6, s[46:47]
  s_add_u32 s46, s46, 10240
  s_addc_u32 s47, s47, 0
  global_load_dwordx4 v[136:139], v6, s[46:47]
  s_add_u32 s46, s46, 10240
  s_addc_u32 s47, s47, 0
  global_load_dwordx4 v[140:143], v6, s[46:47]
  s_add_u32 s46, s46, 10240
  s_addc_u32 s47, s47, 0
  s_waitcnt vmcnt(36)
  v_lshlrev_b32 v60, 16, v48
  v_dot2c_f32_bf16 v16, v144, v48
  v_dot2c_f32_bf16 v17, v144, v60
  v_dot2c_f32_bf16 v18, v145, v48
  v_dot2c_f32_bf16 v19, v145, v60
  v_dot2c_f32_bf16 v20, v146, v48
  v_dot2c_f32_bf16 v21, v146, v60
  v_dot2c_f32_bf16 v22, v147, v48
  v_dot2c_f32_bf16 v23, v147, v60
  v_dot2c_f32_bf16 v24, v152, v48
  v_dot2c_f32_bf16 v25, v152, v60
  v_dot2c_f32_bf16 v26, v153, v48
  v_dot2c_f32_bf16 v27, v153, v60
  v_dot2c_f32_bf16 v28, v154, v48
  v_dot2c_f32_bf16 v29, v154, v60
  v_dot2c_f32_bf16 v30, v155, v48
  v_dot2c_f32_bf16 v31, v155, v60
  v_lshlrev_b32 v60, 16, v49
  v_dot2c_f32_bf16 v16, v148, v49
  v_dot2c_f32_bf16 v17, v148, v60
  v_dot2c_f32_bf16 v18, v149, v49
  v_dot2c_f32_bf16 v19, v149, v60
  v_dot2c_f32_bf16 v20, v150, v49
  v_dot2c_f32_bf16 v21, v150, v60
  v_dot2c_f32_bf16 v22, v151, v49
  v_dot2c_f32_bf16 v23, v151, v60
  v_dot2c_f32_bf16 v24, v156, v49
  v_dot2c_f32_bf16 v25, v156, v60
  v_dot2c_f32_bf16 v26, v157, v49
  v_dot2c_f32_bf16 v27, v157, v60
  v_dot2c_f32_bf16 v28, v158, v49
  v_dot2c_f32_bf16 v29, v158, v60
  v_dot2c_f32_bf16 v30, v159, v49
  v_dot2c_f32_bf16 v31, v159, v60
  s_waitcnt vmcnt(32)
  v_lshlrev_b32 v60, 16, v50
  v_dot2c_f32_bf16 v16, v160, v50
  v_dot2c_f32_bf16 v17, v160, v60
  v_dot2c_f32_bf16 v18, v161, v50
  v_dot2c_f32_bf16 v19, v161, v60
  v_dot2c_f32_bf16 v20, v162, v50
  v_dot2c_f32_bf16 v21, v162, v60
  v_dot2c_f32_bf16 v22, v163, v50
  v_dot2c_f32_bf16 v23, v163, v60
  v_dot2c_f32_bf16 v24, v168, v50
  v_dot2c_f32_bf16 v25, v168, v60
  v_dot2c_f32_bf16 v26, v169, v50
  v_dot2c_f32_bf16 v27, v169, v60
  v_dot2c_f32_bf16 v28, v170, v50
  v_dot2c_f32_bf16 v29, v170, v60
  v_dot2c_f32_bf16 v30, v171, v50
  v_dot2c_f32_bf16 v31, v171, v60
  v_lshlrev_b32 v60, 16, v51
  v_dot2c_f32_bf16 v16, v164, v51
  v_dot2c_f32_bf16 v17, v164, v60
  v_dot2c_f32_bf16 v18, v165, v51
  v_dot2c_f32_bf16 v19, v165, v60
  v_dot2c_f32_bf16 v20, v166, v51
  v_dot2c_f32_bf16 v21, v166, v60
  v_dot2c_f32_bf16 v22, v167, v51
  v_dot2c_f32_bf16 v23, v167, v60
  v_dot2c_f32_bf16 v24, v172, v51
  v_dot2c_f32_bf16 v25, v172, v60
  v_dot2c_f32_bf16 v26, v173, v51
  v_dot2c_f32_bf16 v27, v173, v60
  v_dot2c_f32_bf16 v28, v174, v51
  v_dot2c_f32_bf16 v29, v174, v60
  v_dot2c_f32_bf16 v30, v175, v51
  v_dot2c_f32_bf16 v31, v175, v60
  s_waitcnt vmcnt(28)
  v_lshlrev_b32 v60, 16, v52
  v_dot2c_f32_bf16 v16, v176, v52
  v_dot2c_f32_bf16 v17, v176, v60
  v_dot2c_f32_bf16 v18, v177, v52
  v_dot2c_f32_bf16 v19, v177, v60
  v_dot2c_f32_bf16 v20, v178, v52
  v_dot2c_f32_bf16 v21, v178, v60
  v_dot2c_f32_bf16 v22, v179, v52
  v_dot2c_f32_bf16 v23, v179, v60
  v_dot2c_f32_bf16 v24, v184, v52
  v_dot2c_f32_bf16 v25, v184, v60
  v_dot2c_f32_bf16 v26, v185, v52
  v_dot2c_f32_bf16 v27, v185, v60
  v_dot2c_f32_bf16 v28, v186, v52
  v_dot2c_f32_bf16 v29, v186, v60
  v_dot2c_f32_bf16 v30, v187, v52
  v_dot2c_f32_bf16 v31, v187, v60
  v_lshlrev_b32 v60, 16, v53
  v_dot2c_f32_bf16 v16, v180, v53
  v_dot2c_f32_bf16 v17, v180, v60
  v_dot2c_f32_bf16 v18, v181, v53
  v_dot2c_f32_bf16 v19, v181, v60
  v_dot2c_f32_bf16 v20, v182, v53
  v_dot2c_f32_bf16 v21, v182, v60
  v_dot2c_f32_bf16 v22, v183, v53
  v_dot2c_f32_bf16 v23, v183, v60
  v_dot2c_f32_bf16 v24, v188, v53
  v_dot2c_f32_bf16 v25, v188, v60
  v_dot2c_f32_bf16 v26, v189, v53
  v_dot2c_f32_bf16 v27, v189, v60
  v_dot2c_f32_bf16 v28, v190, v53
  v_dot2c_f32_bf16 v29, v190, v60
  v_dot2c_f32_bf16 v30, v191, v53
  v_dot2c_f32_bf16 v31, v191, v60
  s_waitcnt vmcnt(24)
  v_lshlrev_b32 v60, 16, v54
  v_dot2c_f32_bf16 v16, v192, v54
  v_dot2c_f32_bf16 v17, v192, v60
  v_dot2c_f32_bf16 v18, v193, v54
  v_dot2c_f32_bf16 v19, v193, v60
  v_dot2c_f32_bf16 v20, v194, v54
  v_dot2c_f32_bf16 v21, v194, v60
  v_dot2c_f32_bf16 v22, v195, v54
  v_dot2c_f32_bf16 v23, v195, v60
  v_dot2c_f32_bf16 v24, v200, v54
  v_dot2c_f32_bf16 v25, v200, v60
  v_dot2c_f32_bf16 v26, v201, v54
  v_dot2c_f32_bf16 v27, v201, v60
  v_dot2c_f32_bf16 v28, v202, v54
  v_dot2c_f32_bf16 v29, v202, v60
  v_dot2c_f32_bf16 v30, v203, v54
  v_dot2c_f32_bf16 v31, v203, v60
  v_lshlrev_b32 v60, 16, v55
  v_dot2c_f32_bf16 v16, v196, v55
  v_dot2c_f32_bf16 v17, v196, v60
  v_dot2c_f32_bf16 v18, v197, v55
  v_dot2c_f32_bf16 v19, v197, v60
  v_dot2c_f32_bf16 v20, v198, v55
  v_dot2c_f32_bf16 v21, v198, v60
  v_dot2c_f32_bf16 v22, v199, v55
  v_dot2c_f32_bf16 v23, v199, v60
  v_dot2c_f32_bf16 v24, v204, v55
  v_dot2c_f32_bf16 v25, v204, v60
  v_dot2c_f32_bf16 v26, v205, v55
  v_dot2c_f32_bf16 v27, v205, v60
  v_dot2c_f32_bf16 v28, v206, v55
  v_dot2c_f32_bf16 v29, v206, v60
  v_dot2c_f32_bf16 v30, v207, v55
  v_dot2c_f32_bf16 v31, v207, v60
  s_waitcnt vmcnt(20)
  v_lshlrev_b32 v60, 16, v56
  v_dot2c_f32_bf16 v16, v208, v56
  v_dot2c_f32_bf16 v17, v208, v60
  v_dot2c_f32_bf16 v18, v209, v56
  v_dot2c_f32_bf16 v19, v209, v60
  v_dot2c_f32_bf16 v20, v210, v56
  v_dot2c_f32_bf16 v21, v210, v60
  v_dot2c_f32_bf16 v22, v211, v56
  v_dot2c_f32_bf16 v23, v211, v60
  v_dot2c_f32_bf16 v24, v216, v56
  v_dot2c_f32_bf16 v25, v216, v60
  v_dot2c_f32_bf16 v26, v217, v56
  v_dot2c_f32_bf16 v27, v217, v60
  v_dot2c_f32_bf16 v28, v218, v56
  v_dot2c_f32_bf16 v29, v218, v60
  v_dot2c_f32_bf16 v30, v219, v56
  v_dot2c_f32_bf16 v31, v219, v60
  v_lshlrev_b32 v60, 16, v57
  v_dot2c_f32_bf16 v16, v212, v57
  v_dot2c_f32_bf16 v17, v212, v60
  v_dot2c_f32_bf16 v18, v213, v57
  v_dot2c_f32_bf16 v19, v213, v60
  v_dot2c_f32_bf16 v20, v214, v57
  v_dot2c_f32_bf16 v21, v214, v60
  v_dot2c_f32_bf16 v22, v215, v57
  v_dot2c_f32_bf16 v23, v215, v60
  v_dot2c_f32_bf16 v24, v220, v57
  v_dot2c_f32_bf16 v25, v220, v60
  v_dot2c_f32_bf16 v26, v221, v57
  v_dot2c_f32_bf16 v27, v221, v60
  v_dot2c_f32_bf16 v28, v222, v57
  v_dot2c_f32_bf16 v29, v222, v60
  v_dot2c_f32_bf16 v30, v223, v57
  v_dot2c_f32_bf16 v31, v223, v60
  s_waitcnt vmcnt(16)
  v_lshlrev_b32 v60, 16, v58
  v_dot2c_f32_bf16 v16, v224, v58
  v_dot2c_f32_bf16 v17, v224, v60
  v_dot2c_f32_bf16 v18, v225, v58
  v_dot2c_f32_bf16 v19, v225, v60
  v_dot2c_f32_bf16 v20, v226, v58
  v_dot2c_f32_bf16 v21, v226, v60
  v_dot2c_f32_bf16 v22, v227, v58
  v_dot2c_f32_bf16 v23, v227, v60
  v_dot2c_f32_bf16 v24, v232, v58
  v_dot2c_f32_bf16 v25, v232, v60
  v_dot2c_f32_bf16 v26, v233, v58
  v_dot2c_f32_bf16 v27, v233, v60
  v_dot2c_f32_bf16 v28, v234, v58
  v_dot2c_f32_bf16 v29, v234, v60
  v_dot2c_f32_bf16 v30, v235, v58
  v_dot2c_f32_bf16 v31, v235, v60
  v_lshlrev_b32 v60, 16, v59
  v_dot2c_f32_bf16 v16, v228, v59
  v_dot2c_f32_bf16 v17, v228, v60
  v_dot2c_f32_bf16 v18, v229, v59
  v_dot2c_f32_bf16 v19, v229, v60
  v_dot2c_f32_bf16 v20, v230, v59
  v_dot2c_f32_bf16 v21, v230, v60
  v_dot2c_f32_bf16 v22, v231, v59
  v_dot2c_f32_bf16 v23, v231, v60
  v_dot2c_f32_bf16 v24, v236, v59
  v_dot2c_f32_bf16 v25, v236, v60
  v_dot2c_f32_bf16 v26, v237, v59
  v_dot2c_f32_bf16 v27, v237, v60
  v_dot2c_f32_bf16 v28, v238, v59
  v_dot2c_f32_bf16 v29, v238, v60
  v_dot2c_f32_bf16 v30, v239, v59
  v_dot2c_f32_bf16 v31, v239, v60
  s_nop 3
  v_add_f32_dpp v16, v16, v16 row_ror:8 row_mask:0xf bank_mask:0xf
  v_add_f32_dpp v17, v17, v17 row_ror:8 row_mask:0xf bank_mask:0xf
  v_add_f32_dpp v18, v18, v18 row_ror:8 row_mask:0xf bank_mask:0xf
  v_add_f32_dpp v19, v19, v19 row_ror:8 row_mask:0xf bank_mask:0xf
  v_add_f32_dpp v20, v20, v20 row_ror:8 row_mask:0xf bank_mask:0xf
  v_add_f32_dpp v21, v21, v21 row_ror:8 row_mask:0xf bank_mask:0xf
  v_add_f32_dpp v22, v22, v22 row_ror:8 row_mask:0xf bank_mask:0xf
  v_add_f32_dpp v23, v23, v23 row_ror:8 row_mask:0xf bank_mask:0xf
  v_add_f32_dpp v24, v24, v24 row_ror:8 row_mask:0xf bank_mask:0xf
  v_add_f32_dpp v25, v25, v25 row_ror:8 row_mask:0xf bank_mask:0xf
  v_add_f32_dpp v26, v26, v26 row_ror:8 row_mask:0xf bank_mask:0xf
  v_add_f32_dpp v27, v27, v27 row_ror:8 row_mask:0xf bank_mask:0xf
  v_add_f32_dpp v28, v28, v28 row_ror:8 row_mask:0xf bank_mask:0xf
  v_add_f32_dpp v29, v29, v29 row_ror:8 row_mask:0xf bank_mask:0xf
  v_add_f32_dpp v30, v30, v30 row_ror:8 row_mask:0xf bank_mask:0xf
  v_add_f32_dpp v31, v31, v31 row_ror:8 row_mask:0xf bank_mask:0xf
  v_mov_b32 v60, v16
  v_mov_b32 v61, v17
  v_mov_b32 v62, v18
  v_mov_b32 v63, v19
  v_mov_b32 v64, v20
  v_mov_b32 v65, v21
  v_mov_b32 v66, v22
  v_mov_b32 v67, v23
  v_permlane16_swap_b32 v16, v60
  v_permlane16_swap_b32 v17, v61
  v_permlane16_swap_b32 v18, v62
  v_permlane16_swap_b32 v19, v63
  v_permlane16_swap_b32 v20, v64
  v_permlane16_swap_b32 v21, v65
  v_permlane16_swap_b32 v22, v66
  v_permlane16_swap_b32 v23, v67
  v_add_f32 v16, v16, v60
  v_add_f32 v17, v17, v61
  v_add_f32 v18, v18, v62
  v_add_f32 v19, v19, v63
  v_add_f32 v20, v20, v64
  v_add_f32 v21, v21, v65
  v_add_f32 v22, v22, v66
  v_add_f32 v23, v23, v67
  v_mov_b32 v60, v24
  v_mov_b32 v61, v25
  v_mov_b32 v62, v26
  v_mov_b32 v63, v27
  v_mov_b32 v64, v28
  v_mov_b32 v65, v29
  v_mov_b32 v66, v30
  v_mov_b32 v67, v31
  v_permlane16_swap_b32 v24, v60
  v_permlane16_swap_b32 v25, v61
  v_permlane16_swap_b32 v26, v62
  v_permlane16_swap_b32 v27, v63
  v_permlane16_swap_b32 v28, v64
  v_permlane16_swap_b32 v29, v65
  v_permlane16_swap_b32 v30, v66
  v_permlane16_swap_b32 v31, v67
  v_add_f32 v24, v24, v60
  v_add_f32 v25, v25, v61
  v_add_f32 v26, v26, v62
  v_add_f32 v27, v27, v63
  v_add_f32 v28, v28, v64
  v_add_f32 v29, v29, v65
  v_add_f32 v30, v30, v66
  v_add_f32 v31, v31, v67
  v_mov_b32 v60, v16
  v_mov_b32 v61, v17
  v_mov_b32 v62, v18
  v_mov_b32 v63, v19
  v_mov_b32 v64, v20
  v_mov_b32 v65, v21
  v_mov_b32 v66, v22
  v_mov_b32 v67, v23
  v_permlane32_swap_b32 v16, v60
  v_permlane32_swap_b32 v17, v61
  v_permlane32_swap_b32 v18, v62
  v_permlane32_swap_b32 v19, v63
  v_permlane32_swap_b32 v20, v64
  v_permlane32_swap_b32 v21, v65
  v_permlane32_swap_b32 v22, v66
  v_permlane32_swap_b32 v23, v67
  v_add_f32 v16, v16, v60
  v_add_f32 v17, v17, v61
  v_add_f32 v18, v18, v62
  v_add_f32 v19, v19, v63
  v_add_f32 v20, v20, v64
  v_add_f32 v21, v21, v65
  v_add_f32 v22, v22, v66
  v_add_f32 v23, v23, v67
  v_mov_b32 v60, v24
  v_mov_b32 v61, v25
  v_mov_b32 v62, v26
  v_mov_b32 v63, v27
  v_mov_b32 v64, v28
  v_mov_b32 v65, v29
  v_mov_b32 v66, v30
  v_mov_b32 v67, v31
  v_permlane32_swap_b32 v24, v60
  v_permlane32_swap_b32 v25, v61
  v_permlane32_swap_b32 v26, v62
  v_permlane32_swap_b32 v27, v63
  v_permlane32_swap_b32 v28, v64
  v_permlane32_swap_b32 v29, v65
  v_permlane32_swap_b32 v30, v66
  v_permlane32_swap_b32 v31, v67
  v_add_f32 v24, v24, v60
  v_add_f32 v25, v25, v61
  v_add_f32 v26, v26, v62
  v_add_f32 v27, v27, v63
  v_add_f32 v28, v28, v64
  v_add_f32 v29, v29, v65
  v_add_f32 v30, v30, v66
  v_add_f32 v31, v31, v67
  s_mov_b64 exec, 0xff
  ds_write_b128 v8, v[16:19] offset:0
  ds_write_b128 v8, v[24:27] offset:1024
  ds_write_b128 v8, v[20:23] offset:16
  ds_write_b128 v8, v[28:31] offset:1040
  s_mov_b64 exec, -1
  s_waitcnt lgkmcnt(0)
  s_barrier
  v_lshlrev_b32 v60, 2, v0
  v_cmp_gt_u32 vcc, 64, v0
  s_and_saveexec_b64 s[52:53], vcc
  ds_read_b32 v61, v60 offset:0
  ds_read_b32 v65, v60 offset:1024
  ds_read_b32 v62, v60 offset:256
  ds_read_b32 v66, v60 offset:1280
  ds_read_b32 v63, v60 offset:512
  ds_read_b32 v67, v60 offset:1536
  ds_read_b32 v64, v60 offset:768
  ds_read_b32 v68, v60 offset:1792
  s_waitcnt lgkmcnt(0)
  v_add_f32 v61, v61, v62
  v_add_f32 v63, v63, v64
  v_add_f32 v65, v65, v66
  v_add_f32 v67, v67, v68
  v_add_f32 v61, v61, v63
  v_add_f32 v65, v65, v67
  v_cvt_pk_bf16_f32 v62, v61, v65
  v_lshlrev_b32 v61, 16, v62
  v_and_b32 v65, 0xffff0000, v62
  v_mul_f32 v62, v61, v61
  v_mul_f32 v62, v62, v61
  v_mov_b32 v63, 0x3d372713
  v_fma_f32 v62, v63, v62, v61
  v_mul_f32 v62, 0x3f4c422a, v62
  v_mul_f32 v62, 0x4038aa3b, v62
  v_exp_f32 v62, v62
  s_nop 0
  v_add_f32 v62, 1.0, v62
  v_rcp_f32 v62, v62
  s_nop 0
  v_fma_f32 v62, -2.0, v62, 2.0
  v_mul_f32 v63, 0.5, v61
  v_mul_f32 v62, v63, v62
  v_cvt_pk_bf16_f32 v62, v62, v62
  v_lshlrev_b32 v62, 16, v62
  v_mul_f32 v62, v62, v65
  v_cvt_pk_bf16_f32 v62, v62, v62
  v_lshlrev_b32 v62, 16, v62
  ds_write_b32 v60, v62 offset:2048
  s_mov_b64 exec, s[52:53]
  s_waitcnt lgkmcnt(0)
  s_barrier
  ds_read_b32 v40, v10 offset:2048
  ds_read_b32 v41, v10 offset:2080
  ds_read_b32 v42, v10 offset:2112
  ds_read_b32 v43, v10 offset:2144
  ds_read_b32 v44, v10 offset:2176
  ds_read_b32 v45, v10 offset:2208
  ds_read_b32 v46, v10 offset:2240
  ds_read_b32 v47, v10 offset:2272
  v_mov_b32 v16, 0
  v_mov_b32 v17, 0
  v_mov_b32 v18, 0
  v_mov_b32 v19, 0
  v_mov_b32 v20, 0
  v_mov_b32 v21, 0
  v_mov_b32 v22, 0
  v_mov_b32 v23, 0
  v_mov_b32 v24, 0
  v_mov_b32 v25, 0
  v_mov_b32 v26, 0
  v_mov_b32 v27, 0
  v_mov_b32 v28, 0
  v_mov_b32 v29, 0
  v_mov_b32 v30, 0
  v_mov_b32 v31, 0
  v_mov_b32 v32, 0
  v_mov_b32 v33, 0
  v_mov_b32 v34, 0
  v_mov_b32 v35, 0
  v_mov_b32 v36, 0
  v_mov_b32 v37, 0
  v_mov_b32 v38, 0
  v_mov_b32 v39, 0
  s_waitcnt lgkmcnt(0)
  v_readfirstlane_b32 s48, v3
  s_nop 3
  s_cmp_ge_u32 s48, 2
  s_cbranch_scc1 L_ffn_b
  s_add_u32 s46, s42, 1024
  s_addc_u32 s47, s43, 0
  global_load_dwordx4 v[144:147], v6, s[46:47]
  s_add_u32 s46, s46, 10240
  s_addc_u32 s47, s47, 0
  global_load_dwordx4 v[148:151], v6, s[46:47]
  s_add_u32 s46, s46, 10240
  s_addc_u32 s47, s47, 0
  global_load_dwordx4 v[152:155], v6, s[46:47]
  s_add_u32 s46, s46, 10240
  s_addc_u32 s47, s47, 0
  global_load_dwordx4 v[156:159], v6, s[46:47]
  s_add_u32 s46, s46, 10240
  s_addc_u32 s47, s47, 0
  global_load_dwordx4 v[160:163], v6, s[46:47]
  s_add_u32 s46, s46, 10240
  s_addc_u32 s47, s47, 0
  global_load_dwordx4 v[164:167], v6, s[46:47]
  s_add_u32 s46, s46, 10240
  s_addc_u32 s47, s47, 0
  global_load_dwordx4 v[168:171], v6, s[46:47]
  s_add_u32 s46, s46, 10240
  s_addc_u32 s47, s47, 0
  global_load_dwordx4 v[172:175], v6, s[46:47]
  s_add_u32 s46, s46, 10240
  s_addc_u32 s47, s47, 0
  s_waitcnt vmcnt(20)
  v_cvt_pk_bf16_f32 v60, v40, 0
  v_cvt_pk_bf16_f32 v61, 0, v40
  v_dot2c_f32_bf16 v16, v80, v60
  v_dot2c_f32_bf16 v17, v80, v61
  v_dot2c_f32_bf16 v18, v81, v60
  v_dot2c_f32_bf16 v19, v81, v61
  v_dot2c_f32_bf16 v20, v82, v60
  v_dot2c_f32_bf16 v21, v82, v61
  v_dot2c_f32_bf16 v22, v83, v60
  v_dot2c_f32_bf16 v23, v83, v61
  v_cvt_pk_bf16_f32 v60, v41, 0
  v_cvt_pk_bf16_f32 v61, 0, v41
  v_dot2c_f32_bf16 v16, v84, v60
  v_dot2c_f32_bf16 v17, v84, v61
  v_dot2c_f32_bf16 v18, v85, v60
  v_dot2c_f32_bf16 v19, v85, v61
  v_dot2c_f32_bf16 v20, v86, v60
  v_dot2c_f32_bf16 v21, v86, v61
  v_dot2c_f32_bf16 v22, v87, v60
  v_dot2c_f32_bf16 v23, v87, v61
  v_cvt_pk_bf16_f32 v60, v42, 0
  v_cvt_pk_bf16_f32 v61, 0, v42
  v_dot2c_f32_bf16 v16, v88, v60
  v_dot2c_f32_bf16 v17, v88, v61
  v_dot2c_f32_bf16 v18, v89, v60
  v_dot2c_f32_bf16 v19, v89, v61
  v_dot2c_f32_bf16 v20, v90, v60
  v_dot2c_f32_bf16 v21, v90, v61
  v_dot2c_f32_bf16 v22, v91, v60
  v_dot2c_f32_bf16 v23, v91, v61
  v_cvt_pk_bf16_f32 v60, v43, 0
  v_cvt_pk_bf16_f32 v61, 0, v43
  v_dot2c_f32_bf16 v16, v92, v60
  v_dot2c_f32_bf16 v17, v92, v61
  v_dot2c_f32_bf16 v18, v93, v60
  v_dot2c_f32_bf16 v19, v93, v61
  v_dot2c_f32_bf16 v20, v94, v60
  v_dot2c_f32_bf16 v21, v94, v61
  v_dot2c_f32_bf16 v22, v95, v60
  v_dot2c_f32_bf16 v23, v95, v61
  s_waitcnt vmcnt(16)
  v_cvt_pk_bf16_f32 v60, v44, 0
  v_cvt_pk_bf16_f32 v61, 0, v44
  v_dot2c_f32_bf16 v16, v96, v60
  v_dot2c_f32_bf16 v17, v96, v61
  v_dot2c_f32_bf16 v18, v97, v60
  v_dot2c_f32_bf16 v19, v97, v61
  v_dot2c_f32_bf16 v20, v98, v60
  v_dot2c_f32_bf16 v21, v98, v61
  v_dot2c_f32_bf16 v22, v99, v60
  v_dot2c_f32_bf16 v23, v99, v61
  v_cvt_pk_bf16_f32 v60, v45, 0
  v_cvt_pk_bf16_f32 v61, 0, v45
  v_dot2c_f32_bf16 v16, v100, v60
  v_dot2c_f32_bf16 v17, v100, v61
  v_dot2c_f32_bf16 v18, v101, v60
  v_dot2c_f32_bf16 v19, v101, v61
  v_dot2c_f32_bf16 v20, v102, v60
  v_dot2c_f32_bf16 v21, v102, v61
  v_dot2c_f32_bf16 v22, v103, v60
  v_dot2c_f32_bf16 v23, v103, v61
  v_cvt_pk_bf16_f32 v60, v46, 0
  v_cvt_pk_bf16_f32 v61, 0, v46
  v_dot2c_f32_bf16 v16, v104, v60
  v_dot2c_f32_bf16 v17, v104, v61
  v_dot2c_f32_bf16 v18, v105, v60
  v_dot2c_f32_bf16 v19, v105, v61
  v_dot2c_f32_bf16 v20, v106, v60
  v_dot2c_f32_bf16 v21, v106, v61
  v_dot2c_f32_bf16 v22, v107, v60
  v_dot2c_f32_bf16 v23, v107, v61
  v_cvt_pk_bf16_f32 v60, v47, 0
  v_cvt_pk_bf16_f32 v61, 0, v47
  v_dot2c_f32_bf16 v16, v108, v60
  v_dot2c_f32_bf16 v17, v108, v61
  v_dot2c_f32_bf16 v18, v109, v60
  v_dot2c_f32_bf16 v19, v109, v61
  v_dot2c_f32_bf16 v20, v110, v60
  v_dot2c_f32_bf16 v21, v110, v61
  v_dot2c_f32_bf16 v22, v111, v60
  v_dot2c_f32_bf16 v23, v111, v61
  s_nop 3
  v_add_f32_dpp v16, v16, v16 row_ror:8 row_mask:0xf bank_mask:0xf
  v_add_f32_dpp v17, v17, v17 row_ror:8 row_mask:0xf bank_mask:0xf
  v_add_f32_dpp v18, v18, v18 row_ror:8 row_mask:0xf bank_mask:0xf
  v_add_f32_dpp v19, v19, v19 row_ror:8 row_mask:0xf bank_mask:0xf
  v_add_f32_dpp v20, v20, v20 row_ror:8 row_mask:0xf bank_mask:0xf
  v_add_f32_dpp v21, v21, v21 row_ror:8 row_mask:0xf bank_mask:0xf
  v_add_f32_dpp v22, v22, v22 row_ror:8 row_mask:0xf bank_mask:0xf
  v_add_f32_dpp v23, v23, v23 row_ror:8 row_mask:0xf bank_mask:0xf
  v_mov_b32 v60, v16
  v_mov_b32 v61, v17
  v_mov_b32 v62, v18
  v_mov_b32 v63, v19
  v_mov_b32 v64, v20
  v_mov_b32 v65, v21
  v_mov_b32 v66, v22
  v_mov_b32 v67, v23
  v_permlane16_swap_b32 v16, v60
  v_permlane16_swap_b32 v17, v61
  v_permlane16_swap_b32 v18, v62
  v_permlane16_swap_b32 v19, v63
  v_permlane16_swap_b32 v20, v64
  v_permlane16_swap_b32 v21, v65
  v_permlane16_swap_b32 v22, v66
  v_permlane16_swap_b32 v23, v67
  v_add_f32 v16, v16, v60
  v_add_f32 v17, v17, v61
  v_add_f32 v18, v18, v62
  v_add_f32 v19, v19, v63
  v_add_f32 v20, v20, v64
  v_add_f32 v21, v21, v65
  v_add_f32 v22, v22, v66
  v_add_f32 v23, v23, v67
  v_mov_b32 v60, v16
  v_mov_b32 v61, v17
  v_mov_b32 v62, v18
  v_mov_b32 v63, v19
  v_mov_b32 v64, v20
  v_mov_b32 v65, v21
  v_mov_b32 v66, v22
  v_mov_b32 v67, v23
  v_permlane32_swap_b32 v16, v60
  v_permlane32_swap_b32 v17, v61
  v_permlane32_swap_b32 v18, v62
  v_permlane32_swap_b32 v19, v63
  v_permlane32_swap_b32 v20, v64
  v_permlane32_swap_b32 v21, v65
  v_permlane32_swap_b32 v22, v66
  v_permlane32_swap_b32 v23, v67
  v_add_f32 v16, v16, v60
  v_add_f32 v17, v17, v61
  v_add_f32 v18, v18, v62
  v_add_f32 v19, v19, v63
  v_add_f32 v20, v20, v64
  v_add_f32 v21, v21, v65
  v_add_f32 v22, v22, v66
  v_add_f32 v23, v23, v67
  v_lshlrev_b32 v60, 8, v3
  v_add_u32 v60, v60, v9
  s_mov_b64 exec, 0xff
  global_store_dwordx4 v60, v[16:19], s[38:39] offset:0
  global_store_dwordx4 v60, v[20:23], s[38:39] offset:16
  s_mov_b64 exec, -1
  s_waitcnt vmcnt(14)
  v_cvt_pk_bf16_f32 v60, v40, 0
  v_cvt_pk_bf16_f32 v61, 0, v40
  v_dot2c_f32_bf16 v24, v112, v60
  v_dot2c_f32_bf16 v25, v112, v61
  v_dot2c_f32_bf16 v26, v113, v60
  v_dot2c_f32_bf16 v27, v113, v61
  v_dot2c_f32_bf16 v28, v114, v60
  v_dot2c_f32_bf16 v29, v114, v61
  v_dot2c_f32_bf16 v30, v115, v60
  v_dot2c_f32_bf16 v31, v115, v61
  v_cvt_pk_bf16_f32 v60, v41, 0
  v_cvt_pk_bf16_f32 v61, 0, v41
  v_dot2c_f32_bf16 v24, v116, v60
  v_dot2c_f32_bf16 v25, v116, v61
  v_dot2c_f32_bf16 v26, v117, v60
  v_dot2c_f32_bf16 v27, v117, v61
  v_dot2c_f32_bf16 v28, v118, v60
  v_dot2c_f32_bf16 v29, v118, v61
  v_dot2c_f32_bf16 v30, v119, v60
  v_dot2c_f32_bf16 v31, v119, v61
  v_cvt_pk_bf16_f32 v60, v42, 0
  v_cvt_pk_bf16_f32 v61, 0, v42
  v_dot2c_f32_bf16 v24, v120, v60
  v_dot2c_f32_bf16 v25, v120, v61
  v_dot2c_f32_bf16 v26, v121, v60
  v_dot2c_f32_bf16 v27, v121, v61
  v_dot2c_f32_bf16 v28, v122, v60
  v_dot2c_f32_bf16 v29, v122, v61
  v_dot2c_f32_bf16 v30, v123, v60
  v_dot2c_f32_bf16 v31, v123, v61
  v_cvt_pk_bf16_f32 v60, v43, 0
  v_cvt_pk_bf16_f32 v61, 0, v43
  v_dot2c_f32_bf16 v24, v124, v60
  v_dot2c_f32_bf16 v25, v124, v61
  v_dot2c_f32_bf16 v26, v125, v60
  v_dot2c_f32_bf16 v27, v125, v61
  v_dot2c_f32_bf16 v28, v126, v60
  v_dot2c_f32_bf16 v29, v126, v61
  v_dot2c_f32_bf16 v30, v127, v60
  v_dot2c_f32_bf16 v31, v127, v61
  s_waitcnt vmcnt(10)
  v_cvt_pk_bf16_f32 v60, v44, 0
  v_cvt_pk_bf16_f32 v61, 0, v44
  v_dot2c_f32_bf16 v24, v128, v60
  v_dot2c_f32_bf16 v25, v128, v61
  v_dot2c_f32_bf16 v26, v129, v60
  v_dot2c_f32_bf16 v27, v129, v61
  v_dot2c_f32_bf16 v28, v130, v60
  v_dot2c_f32_bf16 v29, v130, v61
  v_dot2c_f32_bf16 v30, v131, v60
  v_dot2c_f32_bf16 v31, v131, v61
  v_cvt_pk_bf16_f32 v60, v45, 0
  v_cvt_pk_bf16_f32 v61, 0, v45
  v_dot2c_f32_bf16 v24, v132, v60
  v_dot2c_f32_bf16 v25, v132, v61
  v_dot2c_f32_bf16 v26, v133, v60
  v_dot2c_f32_bf16 v27, v133, v61
  v_dot2c_f32_bf16 v28, v134, v60
  v_dot2c_f32_bf16 v29, v134, v61
  v_dot2c_f32_bf16 v30, v135, v60
  v_dot2c_f32_bf16 v31, v135, v61
  v_cvt_pk_bf16_f32 v60, v46, 0
  v_cvt_pk_bf16_f32 v61, 0, v46
  v_dot2c_f32_bf16 v24, v136, v60
  v_dot2c_f32_bf16 v25, v136, v61
  v_dot2c_f32_bf16 v26, v137, v60
  v_dot2c_f32_bf16 v27, v137, v61
  v_dot2c_f32_bf16 v28, v138, v60
  v_dot2c_f32_bf16 v29, v138, v61
  v_dot2c_f32_bf16 v30, v139, v60
  v_dot2c_f32_bf16 v31, v139, v61
  v_cvt_pk_bf16_f32 v60, v47, 0
  v_cvt_pk_bf16_f32 v61, 0, v47
  v_dot2c_f32_bf16 v24, v140, v60
  v_dot2c_f32_bf16 v25, v140, v61
  v_dot2c_f32_bf16 v26, v141, v60
  v_dot2c_f32_bf16 v27, v141, v61
  v_dot2c_f32_bf16 v28, v142, v60
  v_dot2c_f32_bf16 v29, v142, v61
  v_dot2c_f32_bf16 v30, v143, v60
  v_dot2c_f32_bf16 v31, v143, v61
  s_nop 3
  v_add_f32_dpp v24, v24, v24 row_ror:8 row_mask:0xf bank_mask:0xf
  v_add_f32_dpp v25, v25, v25 row_ror:8 row_mask:0xf bank_mask:0xf
  v_add_f32_dpp v26, v26, v26 row_ror:8 row_mask:0xf bank_mask:0xf
  v_add_f32_dpp v27, v27, v27 row_ror:8 row_mask:0xf bank_mask:0xf
  v_add_f32_dpp v28, v28, v28 row_ror:8 row_mask:0xf bank_mask:0xf
  v_add_f32_dpp v29, v29, v29 row_ror:8 row_mask:0xf bank_mask:0xf
  v_add_f32_dpp v30, v30, v30 row_ror:8 row_mask:0xf bank_mask:0xf
  v_add_f32_dpp v31, v31, v31 row_ror:8 row_mask:0xf bank_mask:0xf
  v_mov_b32 v60, v24
  v_mov_b32 v61, v25
  v_mov_b32 v62, v26
  v_mov_b32 v63, v27
  v_mov_b32 v64, v28
  v_mov_b32 v65, v29
  v_mov_b32 v66, v30
  v_mov_b32 v67, v31
  v_permlane16_swap_b32 v24, v60
  v_permlane16_swap_b32 v25, v61
  v_permlane16_swap_b32 v26, v62
  v_permlane16_swap_b32 v27, v63
  v_permlane16_swap_b32 v28, v64
  v_permlane16_swap_b32 v29, v65
  v_permlane16_swap_b32 v30, v66
  v_permlane16_swap_b32 v31, v67
  v_add_f32 v24, v24, v60
  v_add_f32 v25, v25, v61
  v_add_f32 v26, v26, v62
  v_add_f32 v27, v27, v63
  v_add_f32 v28, v28, v64
  v_add_f32 v29, v29, v65
  v_add_f32 v30, v30, v66
  v_add_f32 v31, v31, v67
  v_mov_b32 v60, v24
  v_mov_b32 v61, v25
  v_mov_b32 v62, v26
  v_mov_b32 v63, v27
  v_mov_b32 v64, v28
  v_mov_b32 v65, v29
  v_mov_b32 v66, v30
  v_mov_b32 v67, v31
  v_permlane32_swap_b32 v24, v60
  v_permlane32_swap_b32 v25, v61
  v_permlane32_swap_b32 v26, v62
  v_permlane32_swap_b32 v27, v63
  v_permlane32_swap_b32 v28, v64
  v_permlane32_swap_b32 v29, v65
  v_permlane32_swap_b32 v30, v66
  v_permlane32_swap_b32 v31, v67
  v_add_f32 v24, v24, v60
  v_add_f32 v25, v25, v61
  v_add_f32 v26, v26, v62
  v_add_f32 v27, v27, v63
  v_add_f32 v28, v28, v64
  v_add_f32 v29, v29, v65
  v_add_f32 v30, v30, v66
  v_add_f32 v31, v31, v67
  v_lshlrev_b32 v60, 8, v3
  v_add_u32 v60, v60, v9
  s_mov_b64 exec, 0xff
  global_store_dwordx4 v60, v[24:27], s[38:39] offset:1024
  global_store_dwordx4 v60, v[28:31], s[38:39] offset:1040
  s_mov_b64 exec, -1
  s_waitcnt vmcnt(8)
  v_cvt_pk_bf16_f32 v60, v40, 0
  v_cvt_pk_bf16_f32 v61, 0, v40
  v_dot2c_f32_bf16 v32, v144, v60
  v_dot2c_f32_bf16 v33, v144, v61
  v_dot2c_f32_bf16 v34, v145, v60
  v_dot2c_f32_bf16 v35, v145, v61
  v_dot2c_f32_bf16 v36, v146, v60
  v_dot2c_f32_bf16 v37, v146, v61
  v_dot2c_f32_bf16 v38, v147, v60
  v_dot2c_f32_bf16 v39, v147, v61
  v_cvt_pk_bf16_f32 v60, v41, 0
  v_cvt_pk_bf16_f32 v61, 0, v41
  v_dot2c_f32_bf16 v32, v148, v60
  v_dot2c_f32_bf16 v33, v148, v61
  v_dot2c_f32_bf16 v34, v149, v60
  v_dot2c_f32_bf16 v35, v149, v61
  v_dot2c_f32_bf16 v36, v150, v60
  v_dot2c_f32_bf16 v37, v150, v61
  v_dot2c_f32_bf16 v38, v151, v60
  v_dot2c_f32_bf16 v39, v151, v61
  v_cvt_pk_bf16_f32 v60, v42, 0
  v_cvt_pk_bf16_f32 v61, 0, v42
  v_dot2c_f32_bf16 v32, v152, v60
  v_dot2c_f32_bf16 v33, v152, v61
  v_dot2c_f32_bf16 v34, v153, v60
  v_dot2c_f32_bf16 v35, v153, v61
  v_dot2c_f32_bf16 v36, v154, v60
  v_dot2c_f32_bf16 v37, v154, v61
  v_dot2c_f32_bf16 v38, v155, v60
  v_dot2c_f32_bf16 v39, v155, v61
  v_cvt_pk_bf16_f32 v60, v43, 0
  v_cvt_pk_bf16_f32 v61, 0, v43
  v_dot2c_f32_bf16 v32, v156, v60
  v_dot2c_f32_bf16 v33, v156, v61
  v_dot2c_f32_bf16 v34, v157, v60
  v_dot2c_f32_bf16 v35, v157, v61
  v_dot2c_f32_bf16 v36, v158, v60
  v_dot2c_f32_bf16 v37, v158, v61
  v_dot2c_f32_bf16 v38, v159, v60
  v_dot2c_f32_bf16 v39, v159, v61
  s_waitcnt vmcnt(4)
  v_cvt_pk_bf16_f32 v60, v44, 0
  v_cvt_pk_bf16_f32 v61, 0, v44
  v_dot2c_f32_bf16 v32, v160, v60
  v_dot2c_f32_bf16 v33, v160, v61
  v_dot2c_f32_bf16 v34, v161, v60
  v_dot2c_f32_bf16 v35, v161, v61
  v_dot2c_f32_bf16 v36, v162, v60
  v_dot2c_f32_bf16 v37, v162, v61
  v_dot2c_f32_bf16 v38, v163, v60
  v_dot2c_f32_bf16 v39, v163, v61
  v_cvt_pk_bf16_f32 v60, v45, 0
  v_cvt_pk_bf16_f32 v61, 0, v45
  v_dot2c_f32_bf16 v32, v164, v60
  v_dot2c_f32_bf16 v33, v164, v61
  v_dot2c_f32_bf16 v34, v165, v60
  v_dot2c_f32_bf16 v35, v165, v61
  v_dot2c_f32_bf16 v36, v166, v60
  v_dot2c_f32_bf16 v37, v166, v61
  v_dot2c_f32_bf16 v38, v167, v60
  v_dot2c_f32_bf16 v39, v167, v61
  v_cvt_pk_bf16_f32 v60, v46, 0
  v_cvt_pk_bf16_f32 v61, 0, v46
  v_dot2c_f32_bf16 v32, v168, v60
  v_dot2c_f32_bf16 v33, v168, v61
  v_dot2c_f32_bf16 v34, v169, v60
  v_dot2c_f32_bf16 v35, v169, v61
  v_dot2c_f32_bf16 v36, v170, v60
  v_dot2c_f32_bf16 v37, v170, v61
  v_dot2c_f32_bf16 v38, v171, v60
  v_dot2c_f32_bf16 v39, v171, v61
  v_cvt_pk_bf16_f32 v60, v47, 0
  v_cvt_pk_bf16_f32 v61, 0, v47
  v_dot2c_f32_bf16 v32, v172, v60
  v_dot2c_f32_bf16 v33, v172, v61
  v_dot2c_f32_bf16 v34, v173, v60
  v_dot2c_f32_bf16 v35, v173, v61
  v_dot2c_f32_bf16 v36, v174, v60
  v_dot2c_f32_bf16 v37, v174, v61
  v_dot2c_f32_bf16 v38, v175, v60
  v_dot2c_f32_bf16 v39, v175, v61
  s_nop 3
  v_add_f32_dpp v32, v32, v32 row_ror:8 row_mask:0xf bank_mask:0xf
  v_add_f32_dpp v33, v33, v33 row_ror:8 row_mask:0xf bank_mask:0xf
  v_add_f32_dpp v34, v34, v34 row_ror:8 row_mask:0xf bank_mask:0xf
  v_add_f32_dpp v35, v35, v35 row_ror:8 row_mask:0xf bank_mask:0xf
  v_add_f32_dpp v36, v36, v36 row_ror:8 row_mask:0xf bank_mask:0xf
  v_add_f32_dpp v37, v37, v37 row_ror:8 row_mask:0xf bank_mask:0xf
  v_add_f32_dpp v38, v38, v38 row_ror:8 row_mask:0xf bank_mask:0xf
  v_add_f32_dpp v39, v39, v39 row_ror:8 row_mask:0xf bank_mask:0xf
  v_mov_b32 v60, v32
  v_mov_b32 v61, v33
  v_mov_b32 v62, v34
  v_mov_b32 v63, v35
  v_mov_b32 v64, v36
  v_mov_b32 v65, v37
  v_mov_b32 v66, v38
  v_mov_b32 v67, v39
  v_permlane16_swap_b32 v32, v60
  v_permlane16_swap_b32 v33, v61
  v_permlane16_swap_b32 v34, v62
  v_permlane16_swap_b32 v35, v63
  v_permlane16_swap_b32 v36, v64
  v_permlane16_swap_b32 v37, v65
  v_permlane16_swap_b32 v38, v66
  v_permlane16_swap_b32 v39, v67
  v_add_f32 v32, v32, v60
  v_add_f32 v33, v33, v61
  v_add_f32 v34, v34, v62
  v_add_f32 v35, v35, v63
  v_add_f32 v36, v36, v64
  v_add_f32 v37, v37, v65
  v_add_f32 v38, v38, v66
  v_add_f32 v39, v39, v67
  v_mov_b32 v60, v32
  v_mov_b32 v61, v33
  v_mov_b32 v62, v34
  v_mov_b32 v63, v35
  v_mov_b32 v64, v36
  v_mov_b32 v65, v37
  v_mov_b32 v66, v38
  v_mov_b32 v67, v39
  v_permlane32_swap_b32 v32, v60
  v_permlane32_swap_b32 v33, v61
  v_permlane32_swap_b32 v34, v62
  v_permlane32_swap_b32 v35, v63
  v_permlane32_swap_b32 v36, v64
  v_permlane32_swap_b32 v37, v65
  v_permlane32_swap_b32 v38, v66
  v_permlane32_swap_b32 v39, v67
  v_add_f32 v32, v32, v60
  v_add_f32 v33, v33, v61
  v_add_f32 v34, v34, v62
  v_add_f32 v35, v35, v63
  v_add_f32 v36, v36, v64
  v_add_f32 v37, v37, v65
  v_add_f32 v38, v38, v66
  v_add_f32 v39, v39, v67
  v_lshlrev_b32 v60, 8, v3
  v_add_u32 v60, v60, v9
  s_mov_b64 exec, 0xff
  global_store_dwordx4 v60, v[32:35], s[38:39] offset:2048
  global_store_dwordx4 v60, v[36:39], s[38:39] offset:2064
  s_mov_b64 exec, -1
  s_branch L_end
L_ffn_b:
  s_waitcnt vmcnt(12)
  v_cvt_pk_bf16_f32 v60, v40, 0
  v_cvt_pk_bf16_f32 v61, 0, v40
  v_dot2c_f32_bf16 v16, v80, v60
  v_dot2c_f32_bf16 v17, v80, v61
  v_dot2c_f32_bf16 v18, v81, v60
  v_dot2c_f32_bf16 v19, v81, v61
  v_dot2c_f32_bf16 v20, v82, v60
  v_dot2c_f32_bf16 v21, v82, v61
  v_dot2c_f32_bf16 v22, v83, v60
  v_dot2c_f32_bf16 v23, v83, v61
  v_cvt_pk_bf16_f32 v60, v41, 0
  v_cvt_pk_bf16_f32 v61, 0, v41
  v_dot2c_f32_bf16 v16, v84, v60
  v_dot2c_f32_bf16 v17, v84, v61
  v_dot2c_f32_bf16 v18, v85, v60
  v_dot2c_f32_bf16 v19, v85, v61
  v_dot2c_f32_bf16 v20, v86, v60
  v_dot2c_f32_bf16 v21, v86, v61
  v_dot2c_f32_bf16 v22, v87, v60
  v_dot2c_f32_bf16 v23, v87, v61
  v_cvt_pk_bf16_f32 v60, v42, 0
  v_cvt_pk_bf16_f32 v61, 0, v42
  v_dot2c_f32_bf16 v16, v88, v60
  v_dot2c_f32_bf16 v17, v88, v61
  v_dot2c_f32_bf16 v18, v89, v60
  v_dot2c_f32_bf16 v19, v89, v61
  v_dot2c_f32_bf16 v20, v90, v60
  v_dot2c_f32_bf16 v21, v90, v61
  v_dot2c_f32_bf16 v22, v91, v60
  v_dot2c_f32_bf16 v23, v91, v61
  v_cvt_pk_bf16_f32 v60, v43, 0
  v_cvt_pk_bf16_f32 v61, 0, v43
  v_dot2c_f32_bf16 v16, v92, v60
  v_dot2c_f32_bf16 v17, v92, v61
  v_dot2c_f32_bf16 v18, v93, v60
  v_dot2c_f32_bf16 v19, v93, v61
  v_dot2c_f32_bf16 v20, v94, v60
  v_dot2c_f32_bf16 v21, v94, v61
  v_dot2c_f32_bf16 v22, v95, v60
  v_dot2c_f32_bf16 v23, v95, v61
  s_waitcnt vmcnt(8)
  v_cvt_pk_bf16_f32 v60, v44, 0
  v_cvt_pk_bf16_f32 v61, 0, v44
  v_dot2c_f32_bf16 v16, v96, v60
  v_dot2c_f32_bf16 v17, v96, v61
  v_dot2c_f32_bf16 v18, v97, v60
  v_dot2c_f32_bf16 v19, v97, v61
  v_dot2c_f32_bf16 v20, v98, v60
  v_dot2c_f32_bf16 v21, v98, v61
  v_dot2c_f32_bf16 v22, v99, v60
  v_dot2c_f32_bf16 v23, v99, v61
  v_cvt_pk_bf16_f32 v60, v45, 0
  v_cvt_pk_bf16_f32 v61, 0, v45
  v_dot2c_f32_bf16 v16, v100, v60
  v_dot2c_f32_bf16 v17, v100, v61
  v_dot2c_f32_bf16 v18, v101, v60
  v_dot2c_f32_bf16 v19, v101, v61
  v_dot2c_f32_bf16 v20, v102, v60
  v_dot2c_f32_bf16 v21, v102, v61
  v_dot2c_f32_bf16 v22, v103, v60
  v_dot2c_f32_bf16 v23, v103, v61
  v_cvt_pk_bf16_f32 v60, v46, 0
  v_cvt_pk_bf16_f32 v61, 0, v46
  v_dot2c_f32_bf16 v16, v104, v60
  v_dot2c_f32_bf16 v17, v104, v61
  v_dot2c_f32_bf16 v18, v105, v60
  v_dot2c_f32_bf16 v19, v105, v61
  v_dot2c_f32_bf16 v20, v106, v60
  v_dot2c_f32_bf16 v21, v106, v61
  v_dot2c_f32_bf16 v22, v107, v60
  v_dot2c_f32_bf16 v23, v107, v61
  v_cvt_pk_bf16_f32 v60, v47, 0
  v_cvt_pk_bf16_f32 v61, 0, v47
  v_dot2c_f32_bf16 v16, v108, v60
  v_dot2c_f32_bf16 v17, v108, v61
  v_dot2c_f32_bf16 v18, v109, v60
  v_dot2c_f32_bf16 v19, v109, v61
  v_dot2c_f32_bf16 v20, v110, v60
  v_dot2c_f32_bf16 v21, v110, v61
  v_dot2c_f32_bf16 v22, v111, v60
  v_dot2c_f32_bf16 v23, v111, v61
  s_nop 3
  v_add_f32_dpp v16, v16, v16 row_ror:8 row_mask:0xf bank_mask:0xf
  v_add_f32_dpp v17, v17, v17 row_ror:8 row_mask:0xf bank_mask:0xf
  v_add_f32_dpp v18, v18, v18 row_ror:8 row_mask:0xf bank_mask:0xf
  v_add_f32_dpp v19, v19, v19 row_ror:8 row_mask:0xf bank_mask:0xf
  v_add_f32_dpp v20, v20, v20 row_ror:8 row_mask:0xf bank_mask:0xf
  v_add_f32_dpp v21, v21, v21 row_ror:8 row_mask:0xf bank_mask:0xf
  v_add_f32_dpp v22, v22, v22 row_ror:8 row_mask:0xf bank_mask:0xf
  v_add_f32_dpp v23, v23, v23 row_ror:8 row_mask:0xf bank_mask:0xf
  v_mov_b32 v60, v16
  v_mov_b32 v61, v17
  v_mov_b32 v62, v18
  v_mov_b32 v63, v19
  v_mov_b32 v64, v20
  v_mov_b32 v65, v21
  v_mov_b32 v66, v22
  v_mov_b32 v67, v23
  v_permlane16_swap_b32 v16, v60
  v_permlane16_swap_b32 v17, v61
  v_permlane16_swap_b32 v18, v62
  v_permlane16_swap_b32 v19, v63
  v_permlane16_swap_b32 v20, v64
  v_permlane16_swap_b32 v21, v65
  v_permlane16_swap_b32 v22, v66
  v_permlane16_swap_b32 v23, v67
  v_add_f32 v16, v16, v60
  v_add_f32 v17, v17, v61
  v_add_f32 v18, v18, v62
  v_add_f32 v19, v19, v63
  v_add_f32 v20, v20, v64
  v_add_f32 v21, v21, v65
  v_add_f32 v22, v22, v66
  v_add_f32 v23, v23, v67
  v_mov_b32 v60, v16
  v_mov_b32 v61, v17
  v_mov_b32 v62, v18
  v_mov_b32 v63, v19
  v_mov_b32 v64, v20
  v_mov_b32 v65, v21
  v_mov_b32 v66, v22
  v_mov_b32 v67, v23
  v_permlane32_swap_b32 v16, v60
  v_permlane32_swap_b32 v17, v61
  v_permlane32_swap_b32 v18, v62
  v_permlane32_swap_b32 v19, v63
  v_permlane32_swap_b32 v20, v64
  v_permlane32_swap_b32 v21, v65
  v_permlane32_swap_b32 v22, v66
  v_permlane32_swap_b32 v23, v67
  v_add_f32 v16, v16, v60
  v_add_f32 v17, v17, v61
  v_add_f32 v18, v18, v62
  v_add_f32 v19, v19, v63
  v_add_f32 v20, v20, v64
  v_add_f32 v21, v21, v65
  v_add_f32 v22, v22, v66
  v_add_f32 v23, v23, v67
  v_lshlrev_b32 v60, 8, v3
  v_add_u32 v60, v60, v9
  s_mov_b64 exec, 0xff
  global_store_dwordx4 v60, v[16:19], s[38:39] offset:0
  global_store_dwordx4 v60, v[20:23], s[38:39] offset:16
  s_mov_b64 exec, -1
  s_waitcnt vmcnt(6)
  v_cvt_pk_bf16_f32 v60, v40, 0
  v_cvt_pk_bf16_f32 v61, 0, v40
  v_dot2c_f32_bf16 v24, v112, v60
  v_dot2c_f32_bf16 v25, v112, v61
  v_dot2c_f32_bf16 v26, v113, v60
  v_dot2c_f32_bf16 v27, v113, v61
  v_dot2c_f32_bf16 v28, v114, v60
  v_dot2c_f32_bf16 v29, v114, v61
  v_dot2c_f32_bf16 v30, v115, v60
  v_dot2c_f32_bf16 v31, v115, v61
  v_cvt_pk_bf16_f32 v60, v41, 0
  v_cvt_pk_bf16_f32 v61, 0, v41
  v_dot2c_f32_bf16 v24, v116, v60
  v_dot2c_f32_bf16 v25, v116, v61
  v_dot2c_f32_bf16 v26, v117, v60
  v_dot2c_f32_bf16 v27, v117, v61
  v_dot2c_f32_bf16 v28, v118, v60
  v_dot2c_f32_bf16 v29, v118, v61
  v_dot2c_f32_bf16 v30, v119, v60
  v_dot2c_f32_bf16 v31, v119, v61
  v_cvt_pk_bf16_f32 v60, v42, 0
  v_cvt_pk_bf16_f32 v61, 0, v42
  v_dot2c_f32_bf16 v24, v120, v60
  v_dot2c_f32_bf16 v25, v120, v61
  v_dot2c_f32_bf16 v26, v121, v60
  v_dot2c_f32_bf16 v27, v121, v61
  v_dot2c_f32_bf16 v28, v122, v60
  v_dot2c_f32_bf16 v29, v122, v61
  v_dot2c_f32_bf16 v30, v123, v60
  v_dot2c_f32_bf16 v31, v123, v61
  v_cvt_pk_bf16_f32 v60, v43, 0
  v_cvt_pk_bf16_f32 v61, 0, v43
  v_dot2c_f32_bf16 v24, v124, v60
  v_dot2c_f32_bf16 v25, v124, v61
  v_dot2c_f32_bf16 v26, v125, v60
  v_dot2c_f32_bf16 v27, v125, v61
  v_dot2c_f32_bf16 v28, v126, v60
  v_dot2c_f32_bf16 v29, v126, v61
  v_dot2c_f32_bf16 v30, v127, v60
  v_dot2c_f32_bf16 v31, v127, v61
  s_waitcnt vmcnt(2)
  v_cvt_pk_bf16_f32 v60, v44, 0
  v_cvt_pk_bf16_f32 v61, 0, v44
  v_dot2c_f32_bf16 v24, v128, v60
  v_dot2c_f32_bf16 v25, v128, v61
  v_dot2c_f32_bf16 v26, v129, v60
  v_dot2c_f32_bf16 v27, v129, v61
  v_dot2c_f32_bf16 v28, v130, v60
  v_dot2c_f32_bf16 v29, v130, v61
  v_dot2c_f32_bf16 v30, v131, v60
  v_dot2c_f32_bf16 v31, v131, v61
  v_cvt_pk_bf16_f32 v60, v45, 0
  v_cvt_pk_bf16_f32 v61, 0, v45
  v_dot2c_f32_bf16 v24, v132, v60
  v_dot2c_f32_bf16 v25, v132, v61
  v_dot2c_f32_bf16 v26, v133, v60
  v_dot2c_f32_bf16 v27, v133, v61
  v_dot2c_f32_bf16 v28, v134, v60
  v_dot2c_f32_bf16 v29, v134, v61
  v_dot2c_f32_bf16 v30, v135, v60
  v_dot2c_f32_bf16 v31, v135, v61
  v_cvt_pk_bf16_f32 v60, v46, 0
  v_cvt_pk_bf16_f32 v61, 0, v46
  v_dot2c_f32_bf16 v24, v136, v60
  v_dot2c_f32_bf16 v25, v136, v61
  v_dot2c_f32_bf16 v26, v137, v60
  v_dot2c_f32_bf16 v27, v137, v61
  v_dot2c_f32_bf16 v28, v138, v60
  v_dot2c_f32_bf16 v29, v138, v61
  v_dot2c_f32_bf16 v30, v139, v60
  v_dot2c_f32_bf16 v31, v139, v61
  v_cvt_pk_bf16_f32 v60, v47, 0
  v_cvt_pk_bf16_f32 v61, 0, v47
  v_dot2c_f32_bf16 v24, v140, v60
  v_dot2c_f32_bf16 v25, v140, v61
  v_dot2c_f32_bf16 v26, v141, v60
  v_dot2c_f32_bf16 v27, v141, v61
  v_dot2c_f32_bf16 v28, v142, v60
  v_dot2c_f32_bf16 v29, v142, v61
  v_dot2c_f32_bf16 v30, v143, v60
  v_dot2c_f32_bf16 v31, v143, v61
  s_nop 3
  v_add_f32_dpp v24, v24, v24 row_ror:8 row_mask:0xf bank_mask:0xf
  v_add_f32_dpp v25, v25, v25 row_ror:8 row_mask:0xf bank_mask:0xf
  v_add_f32_dpp v26, v26, v26 row_ror:8 row_mask:0xf bank_mask:0xf
  v_add_f32_dpp v27, v27, v27 row_ror:8 row_mask:0xf bank_mask:0xf
  v_add_f32_dpp v28, v28, v28 row_ror:8 row_mask:0xf bank_mask:0xf
  v_add_f32_dpp v29, v29, v29 row_ror:8 row_mask:0xf bank_mask:0xf
  v_add_f32_dpp v30, v30, v30 row_ror:8 row_mask:0xf bank_mask:0xf
  v_add_f32_dpp v31, v31, v31 row_ror:8 row_mask:0xf bank_mask:0xf
  v_mov_b32 v60, v24
  v_mov_b32 v61, v25
  v_mov_b32 v62, v26
  v_mov_b32 v63, v27
  v_mov_b32 v64, v28
  v_mov_b32 v65, v29
  v_mov_b32 v66, v30
  v_mov_b32 v67, v31
  v_permlane16_swap_b32 v24, v60
  v_permlane16_swap_b32 v25, v61
  v_permlane16_swap_b32 v26, v62
  v_permlane16_swap_b32 v27, v63
  v_permlane16_swap_b32 v28, v64
  v_permlane16_swap_b32 v29, v65
  v_permlane16_swap_b32 v30, v66
  v_permlane16_swap_b32 v31, v67
  v_add_f32 v24, v24, v60
  v_add_f32 v25, v25, v61
  v_add_f32 v26, v26, v62
  v_add_f32 v27, v27, v63
  v_add_f32 v28, v28, v64
  v_add_f32 v29, v29, v65
  v_add_f32 v30, v30, v66
  v_add_f32 v31, v31, v67
  v_mov_b32 v60, v24
  v_mov_b32 v61, v25
  v_mov_b32 v62, v26
  v_mov_b32 v63, v27
  v_mov_b32 v64, v28
  v_mov_b32 v65, v29
  v_mov_b32 v66, v30
  v_mov_b32 v67, v31
  v_permlane32_swap_b32 v24, v60
  v_permlane32_swap_b32 v25, v61
  v_permlane32_swap_b32 v26, v62
  v_permlane32_swap_b32 v27, v63
  v_permlane32_swap_b32 v28, v64
  v_permlane32_swap_b32 v29, v65
  v_permlane32_swap_b32 v30, v66
  v_permlane32_swap_b32 v31, v67
  v_add_f32 v24, v24, v60
  v_add_f32 v25, v25, v61
  v_add_f32 v26, v26, v62
  v_add_f32 v27, v27, v63
  v_add_f32 v28, v28, v64
  v_add_f32 v29, v29, v65
  v_add_f32 v30, v30, v66
  v_add_f32 v31, v31, v67
  v_lshlrev_b32 v60, 8, v3
  v_add_u32 v60, v60, v9
  s_mov_b64 exec, 0xff
  global_store_dwordx4 v60, v[24:27], s[38:39] offset:1024
  global_store_dwordx4 v60, v[28:31], s[38:39] offset:1040
  s_mov_b64 exec, -1
L_end:
  s_endpgm
.globl gm_final_kernel
.p2align 8
.type gm_final_kernel,@function
gm_final_kernel:
  s_load_dwordx2 s[4:5], s[0:1], 0
  s_load_dwordx2 s[6:7], s[0:1], 72
  s_load_dwordx2 s[8:9], s[0:1], 80
  s_load_dwordx2 s[10:11], s[0:1], 96
  s_cmp_ge_u32 s2, 40
  s_cbranch_scc1 L_fend
  s_mul_i32 s12, s2, 52429
  s_lshr_b32 s12, s12, 18
  s_mul_i32 s13, s12, 5
  s_sub_u32 s13, s2, s13
  v_and_b32 v1, 31, v0
  v_lshrrev_b32 v2, 5, v0
  v_and_b32 v3, 63, v0
  s_waitcnt lgkmcnt(0)
  s_mul_i32 s14, s12, 1280
  s_add_u32 s4, s4, s14
  s_addc_u32 s5, s5, 0
  v_lshlrev_b32 v4, 5, v3
  v_mov_b32 v20, 0
  v_cmp_gt_u32 vcc, 40, v3
  s_and_saveexec_b64 s[16:17], vcc
  global_load_dwordx4 v[8:11], v4, s[4:5]
  global_load_dwordx4 v[12:15], v4, s[4:5] offset:16
  global_load_dwordx4 v[16:19], v4, s[6:7]
  global_load_dwordx4 v[24:27], v4, s[6:7] offset:16
  s_mov_b64 exec, s[16:17]
  s_mul_i32 s14, s12, 81920
  s_lshl_b32 s15, s13, 9
  s_add_u32 s14, s14, s15
  s_add_u32 s18, s10, s14
  s_addc_u32 s19, s11, 0
  v_mul_u32_u24 v5, 10240, v2
  v_lshlrev_b32 v6, 4, v1
  v_add_u32 v5, v5, v6
  global_load_dwordx4 v[32:35], v5, s[18:19]
  global_load_dwordx4 v[36:39], v5, s[18:19] offset:2560
  v_add_u32 v7, 5120, v5
  global_load_dwordx4 v[40:43], v7, s[18:19]
  global_load_dwordx4 v[44:47], v7, s[18:19] offset:2560
  s_mul_i32 s14, s12, 2560
  s_add_u32 s14, s14, s15
  s_add_u32 s14, s14, 655360
  s_add_u32 s20, s10, s14
  s_addc_u32 s21, s11, 0
  v_mul_u32_u24 v5, 61440, v2
  v_add_u32 v5, v5, v6
  global_load_dwordx4 v[48:51], v5, s[20:21]
  v_add_u32 v7, 20480, v5
  global_load_dwordx4 v[52:55], v7, s[20:21]
  v_add_u32 v7, 40960, v5
  global_load_dwordx4 v[56:59], v7, s[20:21]
  s_waitcnt vmcnt(7)
  s_and_saveexec_b64 s[16:17], vcc
  v_lshlrev_b32 v21, 16, v8
  v_lshlrev_b32 v22, 16, v16
  v_mul_f32 v21, v21, v22
  v_and_b32 v22, 0xffff0000, v8
  v_and_b32 v23, 0xffff0000, v16
  v_mul_f32 v22, v22, v23
  v_cvt_pk_bf16_f32 v21, v21, v22
  v_lshlrev_b32 v22, 16, v21
  v_and_b32 v21, 0xffff0000, v21
  v_add_f32 v20, v20, v22
  v_add_f32 v20, v20, v21
  v_lshlrev_b32 v21, 16, v9
  v_lshlrev_b32 v22, 16, v17
  v_mul_f32 v21, v21, v22
  v_and_b32 v22, 0xffff0000, v9
  v_and_b32 v23, 0xffff0000, v17
  v_mul_f32 v22, v22, v23
  v_cvt_pk_bf16_f32 v21, v21, v22
  v_lshlrev_b32 v22, 16, v21
  v_and_b32 v21, 0xffff0000, v21
  v_add_f32 v20, v20, v22
  v_add_f32 v20, v20, v21
  v_lshlrev_b32 v21, 16, v10
  v_lshlrev_b32 v22, 16, v18
  v_mul_f32 v21, v21, v22
  v_and_b32 v22, 0xffff0000, v10
  v_and_b32 v23, 0xffff0000, v18
  v_mul_f32 v22, v22, v23
  v_cvt_pk_bf16_f32 v21, v21, v22
  v_lshlrev_b32 v22, 16, v21
  v_and_b32 v21, 0xffff0000, v21
  v_add_f32 v20, v20, v22
  v_add_f32 v20, v20, v21
  v_lshlrev_b32 v21, 16, v11
  v_lshlrev_b32 v22, 16, v19
  v_mul_f32 v21, v21, v22
  v_and_b32 v22, 0xffff0000, v11
  v_and_b32 v23, 0xffff0000, v19
  v_mul_f32 v22, v22, v23
  v_cvt_pk_bf16_f32 v21, v21, v22
  v_lshlrev_b32 v22, 16, v21
  v_and_b32 v21, 0xffff0000, v21
  v_add_f32 v20, v20, v22
  v_add_f32 v20, v20, v21
  v_lshlrev_b32 v21, 16, v12
  v_lshlrev_b32 v22, 16, v24
  v_mul_f32 v21, v21, v22
  v_and_b32 v22, 0xffff0000, v12
  v_and_b32 v23, 0xffff0000, v24
  v_mul_f32 v22, v22, v23
  v_cvt_pk_bf16_f32 v21, v21, v22
  v_lshlrev_b32 v22, 16, v21
  v_and_b32 v21, 0xffff0000, v21
  v_add_f32 v20, v20, v22
  v_add_f32 v20, v20, v21
  v_lshlrev_b32 v21, 16, v13
  v_lshlrev_b32 v22, 16, v25
  v_mul_f32 v21, v21, v22
  v_and_b32 v22, 0xffff0000, v13
  v_and_b32 v23, 0xffff0000, v25
  v_mul_f32 v22, v22, v23
  v_cvt_pk_bf16_f32 v21, v21, v22
  v_lshlrev_b32 v22, 16, v21
  v_and_b32 v21, 0xffff0000, v21
  v_add_f32 v20, v20, v22
  v_add_f32 v20, v20, v21
  v_lshlrev_b32 v21, 16, v14
  v_lshlrev_b32 v22, 16, v26
  v_mul_f32 v21, v21, v22
  v_and_b32 v22, 0xffff0000, v14
  v_and_b32 v23, 0xffff0000, v26
  v_mul_f32 v22, v22, v23
  v_cvt_pk_bf16_f32 v21, v21, v22
  v_lshlrev_b32 v22, 16, v21
  v_and_b32 v21, 0xffff0000, v21
  v_add_f32 v20, v20, v22
  v_add_f32 v20, v20, v21
  v_lshlrev_b32 v21, 16, v15
  v_lshlrev_b32 v22, 16, v27
  v_mul_f32 v21, v21, v22
  v_and_b32 v22, 0xffff0000, v15
  v_and_b32 v23, 0xffff0000, v27
  v_mul_f32 v22, v22, v23
  v_cvt_pk_bf16_f32 v21, v21, v22
  v_lshlrev_b32 v22, 16, v21
  v_and_b32 v21, 0xffff0000, v21
  v_add_f32 v20, v20, v22
  v_add_f32 v20, v20, v21
  s_mov_b64 exec, s[16:17]
  s_nop 1
  v_add_f32_dpp v20, v20, v20 row_ror:8 row_mask:0xf bank_mask:0xf
  s_nop 1
  v_add_f32_dpp v20, v20, v20 row_ror:4 row_mask:0xf bank_mask:0xf
  s_nop 1
  v_add_f32_dpp v20, v20, v20 row_ror:2 row_mask:0xf bank_mask:0xf
  s_nop 1
  v_add_f32_dpp v20, v20, v20 row_ror:1 row_mask:0xf bank_mask:0xf
  s_nop 1
  v_readlane_b32 s22, v20, 0
  v_readlane_b32 s23, v20, 16
  v_readlane_b32 s24, v20, 32
  v_readlane_b32 s25, v20, 48
  s_nop 1
  v_mov_b32 v20, s22
  v_add_f32 v20, s23, v20
  v_add_f32 v20, s24, v20
  v_add_f32 v20, s25, v20
  v_cvt_pk_bf16_f32 v20, v20, v20
  v_lshlrev_b32 v20, 16, v20
  v_mul_f32 v21, 0xbfb8aa3b, v20
  v_exp_f32 v21, v21
  s_nop 0
  v_add_f32 v21, 1.0, v21
  v_rcp_f32 v21, v21
  s_nop 0
  v_cvt_pk_bf16_f32 v21, v21, v21
  v_lshlrev_b32 v28, 16, v21
  v_sub_f32 v21, 1.0, v28
  v_cvt_pk_bf16_f32 v21, v21, v21
  v_lshlrev_b32 v29, 16, v21
  s_waitcnt vmcnt(0)
  v_add_f32 v32, v32, v36
  v_add_f32 v40, v40, v44
  v_add_f32 v48, v48, v52
  v_add_f32 v33, v33, v37
  v_add_f32 v41, v41, v45
  v_add_f32 v49, v49, v53
  v_add_f32 v34, v34, v38
  v_add_f32 v42, v42, v46
  v_add_f32 v50, v50, v54
  v_add_f32 v35, v35, v39
  v_add_f32 v43, v43, v47
  v_add_f32 v51, v51, v55
  v_add_f32 v32, v32, v40
  v_add_f32 v48, v48, v56
  v_add_f32 v33, v33, v41
  v_add_f32 v49, v49, v57
  v_add_f32 v34, v34, v42
  v_add_f32 v50, v50, v58
  v_add_f32 v35, v35, v43
  v_add_f32 v51, v51, v59
  v_lshlrev_b32 v5, 9, v2
  v_add_u32 v5, v5, v6
  ds_write_b128 v5, v[32:35]
  ds_write_b128 v5, v[48:51] offset:4096
  s_waitcnt lgkmcnt(0)
  s_barrier
  v_cmp_gt_u32 vcc, 128, v0
  s_and_saveexec_b64 s[16:17], vcc
  s_cbranch_execz L_fend
  v_lshlrev_b32 v5, 2, v0
  ds_read_b32 v32, v5 offset:0
  ds_read_b32 v40, v5 offset:4096
  ds_read_b32 v33, v5 offset:512
  ds_read_b32 v41, v5 offset:4608
  ds_read_b32 v34, v5 offset:1024
  ds_read_b32 v42, v5 offset:5120
  ds_read_b32 v35, v5 offset:1536
  ds_read_b32 v43, v5 offset:5632
  ds_read_b32 v36, v5 offset:2048
  ds_read_b32 v44, v5 offset:6144
  ds_read_b32 v37, v5 offset:2560
  ds_read_b32 v45, v5 offset:6656
  ds_read_b32 v38, v5 offset:3072
  ds_read_b32 v46, v5 offset:7168
  ds_read_b32 v39, v5 offset:3584
  ds_read_b32 v47, v5 offset:7680
  s_waitcnt lgkmcnt(0)
  v_add_f32 v32, v32, v33
  v_add_f32 v34, v34, v35
  v_add_f32 v36, v36, v37
  v_add_f32 v38, v38, v39
  v_add_f32 v32, v32, v34
  v_add_f32 v36, v36, v38
  v_add_f32 v32, v32, v36
  v_add_f32 v40, v40, v41
  v_add_f32 v42, v42, v43
  v_add_f32 v44, v44, v45
  v_add_f32 v46, v46, v47
  v_add_f32 v40, v40, v42
  v_add_f32 v44, v44, v46
  v_add_f32 v40, v40, v44
  v_cvt_pk_bf16_f32 v33, v32, v40
  v_lshlrev_b32 v32, 16, v33
  v_and_b32 v40, 0xffff0000, v33
  v_mul_f32 v32, v28, v32
  v_mul_f32 v40, v29, v40
  v_cvt_pk_bf16_f32 v33, v32, v40
  v_lshlrev_b32 v32, 16, v33
  v_and_b32 v40, 0xffff0000, v33
  v_add_f32 v32, v32, v40
  v_cvt_pk_bf16_f32 v32, v32, v32
  s_mul_i32 s14, s12, 1280
  s_lshl_b32 s15, s13, 8
  s_add_u32 s14, s14, s15
  s_add_u32 s8, s8, s14
  s_addc_u32 s9, s9, 0
  v_lshlrev_b32 v5, 1, v0
  global_store_short v5, v32, s[8:9]
L_fend:
  s_endpgm
.section .rodata,"a"
.p2align 6
.amdhsa_kernel gated_mix__sliding_block_cached__geglu_ffn__decode_kernel
  .amdhsa_next_free_vgpr 240
  .amdhsa_next_free_sgpr 84
  .amdhsa_accum_offset 240
  .amdhsa_group_segment_fixed_size 0
  .amdhsa_kernarg_size 104
  .amdhsa_user_sgpr_count 2
  .amdhsa_user_sgpr_kernarg_segment_ptr 1
  .amdhsa_system_sgpr_workgroup_id_x 1
  .amdhsa_float_denorm_mode_32 3
  .amdhsa_float_denorm_mode_16_64 3
.end_amdhsa_kernel
.p2align 6
.amdhsa_kernel gm_final_kernel
  .amdhsa_next_free_vgpr 64
  .amdhsa_next_free_sgpr 32
  .amdhsa_accum_offset 64
  .amdhsa_group_segment_fixed_size 0
  .amdhsa_kernarg_size 104
  .amdhsa_user_sgpr_count 2
  .amdhsa_user_sgpr_kernarg_segment_ptr 1
  .amdhsa_system_sgpr_workgroup_id_x 1
  .amdhsa_float_denorm_mode_32 3
  .amdhsa_float_denorm_mode_16_64 3
.end_amdhsa_kernel
```
